```python
import torch

def _softmax(x, axis=-1):
    return torch.softmax(x, dim=axis)
def _gelu(x):
    return torch.nn.functional.gelu(x, approximate="tanh")
def _silu(x):
    return torch.nn.functional.silu(x)
def _sigmoid(x):
    return torch.sigmoid(x)
def _layernorm(x, axis=-1, eps=1e-5):
    m = x.mean(dim=axis, keepdim=True)
    v = x.var(dim=axis, keepdim=True, unbiased=False)
    return (x - m) / torch.sqrt(v + eps)
def _scatter_add(tgt, idx, src, axis=0):
    return tgt.clone().index_add_(axis, idx, src)
def _segment_sum(src, seg, n):
    out = torch.zeros((n,) + src.shape[1:], dtype=src.dtype)
    return out.index_add_(0, seg, src)
def _pad(x, pw):
    flat = tuple(v for pair in reversed(pw) for v in pair)
    return torch.nn.functional.pad(x, flat)

kernel_name = 'recurrent_scan__linear_kernel_hedgehog__glu_gated_geglu__prompt'

def setup_inputs():

    _w = (lambda a: (lambda t: t.to(torch.bfloat16) if t.is_floating_point() else t)(torch.as_tensor(a)))
    def _A_setup():
        B, S, D, H = 1, 2048, 640, 32
        Dh = D // H
        return {
            "x": _w((lambda *s: torch.randn(*s, dtype=torch.bfloat16) * 0.05)(B, S, D)),
            "wqkv": _w((lambda *s: torch.randn(*s, dtype=torch.bfloat16) * 0.8)(D, 3 * D)),
            "w_phi": _w((lambda *s: torch.randn(*s, dtype=torch.bfloat16) * 0.8)(H, Dh, Dh) * (Dh ** -0.5)),
            "wo": _w((lambda *s: torch.randn(*s, dtype=torch.bfloat16) * 0.8)(D, D)),
        }
    _A_in = _A_setup()

    def _B_setup():
        B, S, Dm, Df = 1, 2048, 640, 1728
        return {
            "x": _w((lambda *s: torch.randn(*s, dtype=torch.bfloat16) * 0.05)(B, S, Dm)),
            "w_gate": _w((lambda *s: torch.randn(*s, dtype=torch.bfloat16) * 0.2)(Dm, Df) * (Dm ** -0.5)),
            "w_up": _w((lambda *s: torch.randn(*s, dtype=torch.bfloat16) * 0.2)(Dm, Df) * (Dm ** -0.5)),
            "w_down": _w((lambda *s: torch.randn(*s, dtype=torch.bfloat16) * 0.2)(Df, Dm) * (Df ** -0.5)),
        }
    _B_in = _B_setup()

    return {
        "A_x": _A_in["x"],
        "A_wqkv": _A_in["wqkv"],
        "A_w_phi": _A_in["w_phi"],
        "A_wo": _A_in["wo"],
        "B_x": _B_in["x"],
        "B_w_gate": _B_in["w_gate"],
        "B_w_up": _B_in["w_up"],
        "B_w_down": _B_in["w_down"],
    }

def reference(A_x, A_wqkv, A_w_phi, A_wo, B_x, B_w_gate, B_w_up, B_w_down):
    def _A_ref(x, wqkv, w_phi, wo):
        B, S, D = x.shape
        H = 32; Dh = D // H
        qkv = (lambda x, *d: x.permute(*d))((x @ wqkv).reshape(B, S, 3, H, Dh), 2, 0, 3, 1, 4)
        q, k, v = qkv[0], qkv[1], qkv[2]
        pq = torch.einsum("bhsd,hdf->bhsf", q, w_phi)
        pk = torch.einsum("bhsd,hdf->bhsf", k, w_phi)
        phi_q = torch.concatenate([_softmax(pq, axis=-1), _softmax(-pq, axis=-1)], axis=-1)
        phi_k = torch.concatenate([_softmax(pk, axis=-1), _softmax(-pk, axis=-1)], axis=-1)
        kv = torch.einsum("bhsf,bhsd->bhfd", phi_k, v)
        z  = torch.einsum("bhsf->bhf", phi_k)
        num = torch.einsum("bhqf,bhfd->bhqd", phi_q, kv)
        den = torch.einsum("bhqf,bhf->bhq", phi_q, z)[..., None] + 1e-6
        o = num / den
        return (lambda x, *d: x.permute(*d))(o, 0, 2, 1, 3).reshape(B, S, D) @ wo

    def _B_ref(x, w_gate, w_up, w_down):
        g = torch.einsum("bsd,df->bsf", x, w_gate)
        u = torch.einsum("bsd,df->bsf", x, w_up)
        h = _gelu(g) * u
        return torch.einsum("bsf,fd->bsd", h, w_down)

    x = A_x
    xn = _layernorm(x, axis=-1)
    s = _A_ref(xn, A_wqkv, A_w_phi, A_wo)
    g = _silu(_B_ref(xn, B_w_gate, B_w_up, B_w_down))
    return x + s * g
```

```asm
; @launch grid=(256,1,1) block=(512,1,1) lds=163840
.amdgcn_target "amdgcn-amd-amdhsa--gfx950"
.text
.globl recurrent_scan__linear_kernel_hedgehog__glu_gated_geglu__prompt_kernel
.p2align 8
.type recurrent_scan__linear_kernel_hedgehog__glu_gated_geglu__prompt_kernel,@function
recurrent_scan__linear_kernel_hedgehog__glu_gated_geglu__prompt_kernel:
    s_cmp_ge_u32 s2, 256
    s_cbranch_scc1 KF_END
    s_load_dwordx16 s[52:67], s[0:1], 0
    s_load_dwordx4 s[68:71], s[0:1], 64
    s_load_dwordx2 s[72:73], s[0:1], 80
    s_getpc_b64 s[4:5]
KF_PC:
    s_lshl_b32 s3, s2, 5
    s_add_u32 s3, s3, KF_TAB-KF_PC
    s_load_dwordx8 s[24:31], s[4:5], s3
    v_and_b32 v250, 63, v0
    v_lshrrev_b32 v1, 6, v0
    s_nop 0
    v_readfirstlane_b32 s40, v1
    v_lshlrev_b32 v251, 4, v250
    v_add_u32 v252, 4096, v251
    v_mov_b32 v254, 0
    v_mov_b32 v245, 0
    v_mov_b32 v184, 0
    v_mov_b32 v231, 0
    v_mov_b32 v255, 0x40000000
    v_lshrrev_b32 v1, 3, v250
    v_and_b32 v2, 7, v250
    v_lshrrev_b32 v3, 1, v1
    v_xor_b32 v4, v2, v3
    v_lshlrev_b32 v4, 4, v4
    s_lshl_b32 s3, s40, 4
    v_add_u32 v5, s3, v1
    v_mul_u32_u24 v5, 1280, v5
    v_add_u32 v243, v5, v4
    v_xor_b32 v4, 64, v4
    v_add_u32 v244, v5, v4
    v_add_u32 v244, 10240, v244
    s_lshr_b32 s45, s40, 2
    s_and_b32 s51, s40, 3
    s_mul_i32 s48, s45, 12288
    s_lshl_b32 s3, s51, 10
    s_add_u32 s48, s48, s3
    s_lshl_b32 s49, s40, 11
    s_add_u32 s49, s49, 98304
    v_and_b32 v3, 1, v3
    s_lshl_b32 s3, s51, 3
    v_add_u32 v6, s3, v1
    v_lshlrev_b32 v177, 2, v250
    v_and_b32 v7, 15, v250
    v_lshlrev_b32 v8, 2, v7
    v_add_u32 v8, 163584, v8
    ds_write_b32 v8, v254
    s_mov_b32 s77, 0
    s_movk_i32 s46, 3840
    s_and_b32 s3, s51, 1
    s_cmp_lt_u32 s2, 112
    s_cselect_b32 s3, s45, s3
    s_cselect_b32 s46, s46, 3456
    s_cselect_b32 s7, 2, 0
    s_cselect_b32 s74, 4, 8
    s_cmp_lt_u32 s2, 64
    s_cselect_b32 s5, 1200, 0
    s_cselect_b32 s6, -80, 0
    s_cselect_b32 s7, 1, s7
    s_lshl_b32 s3, s3, 1
    v_xor_b32 v3, s3, v3
    v_lshlrev_b32 v3, 1, v3
    v_xor_b32 v3, v2, v3
    s_mul_i32 s7, s7, s45
    s_mul_i32 s7, s7, 160
    v_mul_u32_u24 v6, s46, v6
    v_add_u32 v6, s7, v6
    v_add_u32 v4, 0, v3
    v_mul_u32_u24 v5, 52, v4
    v_lshrrev_b32 v5, 8, v5
    v_lshl_add_u32 v4, v4, 4, v6
    v_and_b32 v8, 1, v5
    v_mad_i32_i24 v4, v8, s5, v4
    v_lshrrev_b32 v5, 1, v5
    v_mad_i32_i24 v240, v5, s6, v4
    v_add_u32 v4, 8, v3
    v_mul_u32_u24 v5, 52, v4
    v_lshrrev_b32 v5, 8, v5
    v_lshl_add_u32 v4, v4, 4, v6
    v_and_b32 v8, 1, v5
    v_mad_i32_i24 v4, v8, s5, v4
    v_lshrrev_b32 v5, 1, v5
    v_mad_i32_i24 v241, v5, s6, v4
    v_add_u32 v4, 16, v3
    v_mul_u32_u24 v5, 52, v4
    v_lshrrev_b32 v5, 8, v5
    v_lshl_add_u32 v4, v4, 4, v6
    v_and_b32 v8, 1, v5
    v_mad_i32_i24 v4, v8, s5, v4
    v_lshrrev_b32 v5, 1, v5
    v_mad_i32_i24 v242, v5, s6, v4
    v_cmp_gt_u32 vcc, s74, v3
    s_nop 1
    v_cndmask_b32 v242, v255, v242, vcc
    s_mov_b32 s10, 2621440
    s_mov_b32 s11, 0x00020000
    s_mul_i32 s14, s46, 640
    s_mov_b32 s15, 0x00020000
    s_lshl_b32 s46, s46, 5
    s_waitcnt lgkmcnt(0)
    s_mov_b32 s8, s52
    s_mov_b32 s9, s53
    s_cmp_eq_u32 s24, 3
    s_cbranch_scc1 KF_SPARE
    s_mul_i32 s3, s25, 163840
    v_add_u32 v243, s3, v243
    v_add_u32 v244, s3, v244
    s_and_b32 s42, s27, 2
    s_lshl_b32 s42, s42, 6
    s_mov_b32 m0, s49
    s_mov_b32 s43, s42
    buffer_load_dwordx4 v243, s[8:11], s42 offen lds
    s_add_u32 m0, s49, 1024
    s_cmp_eq_u32 s45, 0
    buffer_load_dwordx4 v244, s[8:11], s42 offen lds
    s_cselect_b32 s12, s62, s64
    s_cselect_b32 s13, s63, s65
    s_cmp_eq_u32 s24, 0
    s_cselect_b32 s12, s12, s54
    s_cselect_b32 s13, s13, s55
    s_lshr_b32 s60, s26, 8
    s_and_b32 s26, s26, 0xff
    v_add_u32 v240, s60, v240
    v_add_u32 v241, s60, v241
    v_add_u32 v242, s60, v242
    s_and_b32 s55, s27, 3
    s_mov_b32 s54, 128
    s_mul_i32 s41, s55, s46
    s_add_u32 m0, s48, 0
    s_nop 0
    buffer_load_dwordx4 v240, s[12:15], s41 offen lds
    s_add_u32 m0, s48, 4096
    s_nop 0
    buffer_load_dwordx4 v241, s[12:15], s41 offen lds
    s_add_u32 m0, s48, 8192
    s_nop 0
    buffer_load_dwordx4 v242, s[12:15], s41 offen lds
    s_xor_b32 s42, s54, s43
    s_xor_b32 s41, s55, 1
    s_mul_i32 s41, s41, s46
    s_barrier
    s_add_u32 m0, s48, 24576
    s_nop 0
    buffer_load_dwordx4 v240, s[12:15], s41 offen lds
    s_add_u32 m0, s48, 28672
    s_nop 0
    buffer_load_dwordx4 v241, s[12:15], s41 offen lds
    s_add_u32 m0, s48, 32768
    s_nop 0
    buffer_load_dwordx4 v242, s[12:15], s41 offen lds
    s_mov_b32 s47, 1
    s_cmp_lg_u32 s24, 0
    s_cbranch_scc1 KF_QKV
    s_lshl_b32 s74, s45, 6
    s_mul_i32 s46, s51, 3
    v_lshrrev_b32 v9, 4, v250
    v_bfe_u32 v10, v250, 2, 2
    v_lshl_add_u32 v11, v9, 3, v10
    v_and_b32 v12, 3, v250
    v_lshlrev_b32 v12, 3, v12
    v_lshl_add_u32 v11, v11, 7, v12
    v_lshrrev_b32 v10, 1, v10
    v_and_b32 v12, 1, v9
    v_lshl_add_u32 v10, v12, 1, v10
    s_add_u32 s3, s46, 0
    s_and_b32 s4, s3, 3
    s_lshr_b32 s3, s3, 2
    s_lshl_b32 s3, s3, 12
    v_xor_b32 v12, s4, v10
    v_lshl_add_u32 v12, v12, 5, v11
    v_add_u32 v230, s3, v12
    v_add_u32 v233, 49152, v230
    s_add_u32 s3, s46, 1
    s_and_b32 s4, s3, 3
    s_lshr_b32 s3, s3, 2
    s_lshl_b32 s3, s3, 12
    v_xor_b32 v12, s4, v10
    v_lshl_add_u32 v12, v12, 5, v11
    v_add_u32 v231, s3, v12
    v_add_u32 v234, 49152, v231
    s_add_u32 s3, s46, 2
    s_and_b32 s4, s3, 3
    s_lshr_b32 s3, s3, 2
    s_lshl_b32 s3, s3, 12
    v_xor_b32 v12, s4, v10
    v_lshl_add_u32 v12, v12, 5, v11
    v_add_u32 v232, s3, v12
    v_add_u32 v235, 49152, v232
    v_lshrrev_b32 v10, 1, v7
    v_xor_b32 v10, v9, v10
    v_lshlrev_b32 v10, 4, v10
    v_add_u32 v11, s74, v7
    v_lshl_add_u32 v10, v11, 7, v10
    v_add_u32 v236, 98304, v10
    s_and_b32 s3, s27, 1
    s_lshl_b32 s3, s3, 6
    v_xor_b32 v236, s3, v236
    v_xor_b32 v237, 64, v236
    s_add_u32 s47, s47, 1
    s_xor_b32 s41, s47, s55
    s_mul_i32 s41, s41, 110592
    s_mov_b32 s16, s72
    s_mov_b32 s17, s73
    s_mov_b32 s18, 20971520
    s_mov_b32 s19, 0x00020000
    s_mov_b32 s20, s70
    s_mov_b32 s21, s71
    s_mov_b32 s22, 256
    s_mov_b32 s23, 0x00020000
    s_mov_b32 s32, s56
    s_mov_b32 s33, s57
    s_mov_b32 s34, 25600
    s_mov_b32 s35, 0x00020000
    s_lshr_b32 s52, s31, 8
    s_and_b32 s31, s31, 0xff
    s_lshr_b32 s0, s29, 8
    s_and_b32 s29, s29, 0xff
    s_mov_b32 s36, s66
    s_mov_b32 s37, s67
    s_mov_b32 s38, 2211840
    s_mov_b32 s39, 0x00020000
    s_mov_b32 s50, 512
    s_cmp_lt_u32 s40, 4
    s_cselect_b32 s50, 32, s50
    s_cmp_eq_u32 s40, 0
    s_cselect_b32 s3, 9216, 0
    s_or_b32 s50, s50, s3
    s_sub_u32 s3, s40, 4
    s_cselect_b32 s3, 1023, s3
    s_add_u32 s3, s3, s52
    s_cmp_lt_u32 s3, 540
    s_cselect_b32 s3, 3456, 0
    s_or_b32 s50, s50, s3
    s_add_u32 s3, s26, 1
    s_lshl_b32 s3, s3, 7
    v_and_b32 v245, 1, v250
    v_mul_u32_u24 v245, s3, v245
    s_sub_u32 s7, s40, 4
    s_add_u32 s3, s52, s7
    s_mul_i32 s6, s3, 6554
    s_lshr_b32 s6, s6, 16
    s_mul_i32 s4, s6, 10
    s_sub_u32 s4, s3, s4
    s_lshl_b32 s71, s3, 12
    s_add_u32 s71, s71, 10485760
    s_lshl_b32 s70, s4, 7
    v_lshrrev_b32 v186, 3, v250
    v_and_b32 v184, 7, v250
    v_lshlrev_b32 v184, 4, v184
    s_lshl_b32 s7, s7, 12
    s_add_u32 s7, s7, 131072
    s_mul_i32 s4, s6, 40960
    s_add_u32 s70, s70, s4
    v_mul_u32_u24 v186, 1280, v186
    v_add_u32 v184, v186, v184
    s_mov_b32 s61, s7
    v_lshrrev_b32 v185, 4, v250
    v_bfe_u32 v186, v250, 2, 2
    v_lshl_add_u32 v185, v185, 3, v186
    v_and_b32 v186, 3, v250
    v_lshlrev_b32 v186, 3, v186
    v_lshl_add_u32 v185, v185, 7, v186
    v_add_u32 v185, s7, v185
    s_bfe_u32 s53, s27, 0x80008
    s_cmp_eq_u32 s45, 0
    s_cselect_b32 s53, s53, 0
    s_bitset1_b32 s50, s53
    s_add_u32 m0, s48, 49152
    s_nop 0
    buffer_load_dwordx4 v240, s[12:15], s41 offen lds
    s_add_u32 m0, s48, 53248
    s_nop 0
    buffer_load_dwordx4 v241, s[12:15], s41 offen lds
    s_add_u32 m0, s48, 57344
    s_nop 0
    buffer_load_dwordx4 v242, s[12:15], s41 offen lds
    s_add_u32 s47, s47, 1
    s_xor_b32 s41, s47, s55
    s_mul_i32 s41, s41, 110592
    s_waitcnt vmcnt(6)
    s_barrier
    ds_read_b128 v[96:99], v236 offset:0
    ds_read_b128 v[100:103], v236 offset:2048
    ds_read_b128 v[104:107], v236 offset:4096
    ds_read_b128 v[108:111], v236 offset:6144
    ds_read_b64_tr_b16 v[128:129], v230 offset:0
    ds_read_b64_tr_b16 v[130:131], v230 offset:512
    ds_read_b64_tr_b16 v[132:133], v231 offset:0
    ds_read_b64_tr_b16 v[134:135], v231 offset:512
    ds_read_b64_tr_b16 v[136:137], v232 offset:0
    ds_read_b64_tr_b16 v[138:139], v232 offset:512
    s_bfe_u32 s3, s27, 0x80010
    s_lshl_b32 s3, s3, 3
    s_lshl_b32 s5, s25, 7
    s_add_u32 s5, s5, s3
    s_add_u32 s44, s5, s40
    s_mul_i32 s3, s44, 1280
    buffer_load_dwordx4 v[166:169], v251, s[8:11], s3 offen
    buffer_load_dword v170, v177, s[8:11], s3 offen offset:1024
    s_add_u32 m0, s49, 16384
    s_nop 0
    buffer_load_dwordx4 v243, s[8:11], s42 offen lds
    s_add_u32 m0, s49, 17408
    s_nop 0
    buffer_load_dwordx4 v244, s[8:11], s42 offen lds
    s_add_u32 s54, s54, 128
    s_xor_b32 s42, s54, s43
    v_mov_b32 v12, 0
    v_mov_b32 v13, 0
    v_mov_b32 v14, 0
    v_mov_b32 v15, 0
    v_mov_b32 v16, 0
    v_mov_b32 v17, 0
    v_mov_b32 v18, 0
    v_mov_b32 v19, 0
    v_mov_b32 v20, 0
    v_mov_b32 v21, 0
    v_mov_b32 v22, 0
    v_mov_b32 v23, 0
    v_mov_b32 v36, 0
    v_mov_b32 v37, 0
    v_mov_b32 v38, 0
    v_mov_b32 v39, 0
    v_mov_b32 v40, 0
    v_mov_b32 v41, 0
    v_mov_b32 v42, 0
    v_mov_b32 v43, 0
    v_mov_b32 v44, 0
    v_mov_b32 v45, 0
    v_mov_b32 v46, 0
    v_mov_b32 v47, 0
    v_mov_b32 v60, 0
    v_mov_b32 v61, 0
    v_mov_b32 v62, 0
    v_mov_b32 v63, 0
    v_mov_b32 v64, 0
    v_mov_b32 v65, 0
    v_mov_b32 v66, 0
    v_mov_b32 v67, 0
    v_mov_b32 v68, 0
    v_mov_b32 v69, 0
    v_mov_b32 v70, 0
    v_mov_b32 v71, 0
    v_mov_b32 v84, 0
    v_mov_b32 v85, 0
    v_mov_b32 v86, 0
    v_mov_b32 v87, 0
    v_mov_b32 v88, 0
    v_mov_b32 v89, 0
    v_mov_b32 v90, 0
    v_mov_b32 v91, 0
    v_mov_b32 v92, 0
    v_mov_b32 v93, 0
    v_mov_b32 v94, 0
    v_mov_b32 v95, 0
    s_waitcnt lgkmcnt(0)
    s_waitcnt lgkmcnt(4)
    v_mfma_f32_16x16x32_bf16 v[0:3], v[128:131], v[96:99], 0
    ds_read_b64_tr_b16 v[140:141], v230 offset:12288
    s_add_u32 m0, s48, 73728
    v_mfma_f32_16x16x32_bf16 v[24:27], v[128:131], v[100:103], 0
    buffer_load_dwordx4 v240, s[12:15], s41 offen lds
    ds_read_b64_tr_b16 v[142:143], v230 offset:12800
    v_mfma_f32_16x16x32_bf16 v[48:51], v[128:131], v[104:107], 0
    ds_read_b64_tr_b16 v[144:145], v231 offset:12288
    v_mfma_f32_16x16x32_bf16 v[72:75], v[128:131], v[108:111], 0
    ds_read_b64_tr_b16 v[146:147], v231 offset:12800
    s_waitcnt lgkmcnt(6)
    v_mfma_f32_16x16x32_bf16 v[4:7], v[132:135], v[96:99], 0
    ds_read_b64_tr_b16 v[148:149], v232 offset:12288
    s_add_u32 m0, s48, 77824
    v_mfma_f32_16x16x32_bf16 v[28:31], v[132:135], v[100:103], 0
    buffer_load_dwordx4 v241, s[12:15], s41 offen lds
    ds_read_b64_tr_b16 v[150:151], v232 offset:12800
    v_mfma_f32_16x16x32_bf16 v[52:55], v[132:135], v[104:107], 0
    v_mfma_f32_16x16x32_bf16 v[76:79], v[132:135], v[108:111], 0
    s_waitcnt lgkmcnt(6)
    v_mfma_f32_16x16x32_bf16 v[8:11], v[136:139], v[96:99], 0
    s_add_u32 m0, s48, 81920
    v_mfma_f32_16x16x32_bf16 v[32:35], v[136:139], v[100:103], 0
    buffer_load_dwordx4 v242, s[12:15], s41 offen lds
    s_add_u32 s47, s47, 1
    s_xor_b32 s41, s47, s55
    s_mul_i32 s41, s41, 110592
    v_mfma_f32_16x16x32_bf16 v[56:59], v[136:139], v[104:107], 0
    v_mfma_f32_16x16x32_bf16 v[80:83], v[136:139], v[108:111], 0
    s_branch KFC_ENTRY
KFC_LOOP:
    v_mfma_f32_16x16x32_bf16 v[56:59], v[136:139], v[120:123], v[56:59]
    v_mfma_f32_16x16x32_bf16 v[80:83], v[136:139], v[124:127], v[80:83]
    s_waitcnt vmcnt(6) lgkmcnt(0)
    s_barrier
    v_mfma_f32_16x16x32_bf16 v[12:15], v[140:143], v[112:115], v[12:15]
    s_bitcmp1_b32 s50, s47
    s_cbranch_scc1 KFC_HT0
KFC_HR0:
    ds_read_b128 v[96:99], v236 offset:0
    v_mfma_f32_16x16x32_bf16 v[36:39], v[140:143], v[116:119], v[36:39]
    ds_read_b128 v[100:103], v236 offset:2048
    v_mfma_f32_16x16x32_bf16 v[60:63], v[140:143], v[120:123], v[60:63]
    ds_read_b128 v[104:107], v236 offset:4096
    v_mfma_f32_16x16x32_bf16 v[84:87], v[140:143], v[124:127], v[84:87]
    ds_read_b128 v[108:111], v236 offset:6144
    s_add_u32 m0, s49, 16384
    v_mfma_f32_16x16x32_bf16 v[16:19], v[144:147], v[112:115], v[16:19]
    buffer_load_dwordx4 v243, s[8:11], s42 offen lds
    ds_read_b64_tr_b16 v[128:129], v230 offset:0
    v_mfma_f32_16x16x32_bf16 v[40:43], v[144:147], v[116:119], v[40:43]
    ds_read_b64_tr_b16 v[130:131], v230 offset:512
    v_mfma_f32_16x16x32_bf16 v[64:67], v[144:147], v[120:123], v[64:67]
    ds_read_b64_tr_b16 v[132:133], v231 offset:0
    v_mfma_f32_16x16x32_bf16 v[88:91], v[144:147], v[124:127], v[88:91]
    ds_read_b64_tr_b16 v[134:135], v231 offset:512
    v_mfma_f32_16x16x32_bf16 v[20:23], v[148:151], v[112:115], v[20:23]
    ds_read_b64_tr_b16 v[136:137], v232 offset:0
    s_add_u32 m0, s49, 17408
    v_mfma_f32_16x16x32_bf16 v[44:47], v[148:151], v[116:119], v[44:47]
    buffer_load_dwordx4 v244, s[8:11], s42 offen lds
    s_add_u32 s54, s54, 128
    s_xor_b32 s42, s54, s43
    ds_read_b64_tr_b16 v[138:139], v232 offset:512
    v_mfma_f32_16x16x32_bf16 v[68:71], v[148:151], v[120:123], v[68:71]
    v_mfma_f32_16x16x32_bf16 v[92:95], v[148:151], v[124:127], v[92:95]
    s_waitcnt lgkmcnt(4)
    v_mfma_f32_16x16x32_bf16 v[0:3], v[128:131], v[96:99], v[0:3]
    ds_read_b64_tr_b16 v[140:141], v230 offset:12288
    s_add_u32 m0, s48, 73728
    v_mfma_f32_16x16x32_bf16 v[24:27], v[128:131], v[100:103], v[24:27]
    buffer_load_dwordx4 v240, s[12:15], s41 offen lds
    ds_read_b64_tr_b16 v[142:143], v230 offset:12800
    v_mfma_f32_16x16x32_bf16 v[48:51], v[128:131], v[104:107], v[48:51]
    ds_read_b64_tr_b16 v[144:145], v231 offset:12288
    v_mfma_f32_16x16x32_bf16 v[72:75], v[128:131], v[108:111], v[72:75]
    ds_read_b64_tr_b16 v[146:147], v231 offset:12800
    s_waitcnt lgkmcnt(6)
    v_mfma_f32_16x16x32_bf16 v[4:7], v[132:135], v[96:99], v[4:7]
    ds_read_b64_tr_b16 v[148:149], v232 offset:12288
    s_add_u32 m0, s48, 77824
    v_mfma_f32_16x16x32_bf16 v[28:31], v[132:135], v[100:103], v[28:31]
    buffer_load_dwordx4 v241, s[12:15], s41 offen lds
    ds_read_b64_tr_b16 v[150:151], v232 offset:12800
    v_mfma_f32_16x16x32_bf16 v[52:55], v[132:135], v[104:107], v[52:55]
    v_mfma_f32_16x16x32_bf16 v[76:79], v[132:135], v[108:111], v[76:79]
    s_waitcnt lgkmcnt(6)
    v_mfma_f32_16x16x32_bf16 v[8:11], v[136:139], v[96:99], v[8:11]
    s_add_u32 m0, s48, 81920
    v_mfma_f32_16x16x32_bf16 v[32:35], v[136:139], v[100:103], v[32:35]
    buffer_load_dwordx4 v242, s[12:15], s41 offen lds
    s_add_u32 s47, s47, 1
    s_xor_b32 s41, s47, s55
    s_mul_i32 s41, s41, 110592
    v_mfma_f32_16x16x32_bf16 v[56:59], v[136:139], v[104:107], v[56:59]
    v_mfma_f32_16x16x32_bf16 v[80:83], v[136:139], v[108:111], v[80:83]
KFC_ENTRY:
    s_waitcnt vmcnt(8) lgkmcnt(0)
    s_barrier
    v_mfma_f32_16x16x32_bf16 v[12:15], v[140:143], v[96:99], v[12:15]
    s_bitcmp1_b32 s50, s47
    s_cbranch_scc1 KFC_HT1
KFC_HR1:
    ds_read_b128 v[112:115], v237 offset:0
    v_mfma_f32_16x16x32_bf16 v[36:39], v[140:143], v[100:103], v[36:39]
    ds_read_b128 v[116:119], v237 offset:2048
    v_mfma_f32_16x16x32_bf16 v[60:63], v[140:143], v[104:107], v[60:63]
    ds_read_b128 v[120:123], v237 offset:4096
    v_mfma_f32_16x16x32_bf16 v[84:87], v[140:143], v[108:111], v[84:87]
    ds_read_b128 v[124:127], v237 offset:6144
    v_mfma_f32_16x16x32_bf16 v[16:19], v[144:147], v[96:99], v[16:19]
    ds_read_b64_tr_b16 v[128:129], v230 offset:24576
    v_mfma_f32_16x16x32_bf16 v[40:43], v[144:147], v[100:103], v[40:43]
    ds_read_b64_tr_b16 v[130:131], v230 offset:25088
    s_add_u32 m0, s48, 0
    v_mfma_f32_16x16x32_bf16 v[64:67], v[144:147], v[104:107], v[64:67]
    buffer_load_dwordx4 v240, s[12:15], s41 offen lds
    ds_read_b64_tr_b16 v[132:133], v231 offset:24576
    v_mfma_f32_16x16x32_bf16 v[88:91], v[144:147], v[108:111], v[88:91]
    ds_read_b64_tr_b16 v[134:135], v231 offset:25088
    v_mfma_f32_16x16x32_bf16 v[20:23], v[148:151], v[96:99], v[20:23]
    ds_read_b64_tr_b16 v[136:137], v232 offset:24576
    v_mfma_f32_16x16x32_bf16 v[44:47], v[148:151], v[100:103], v[44:47]
    ds_read_b64_tr_b16 v[138:139], v232 offset:25088
    v_mfma_f32_16x16x32_bf16 v[68:71], v[148:151], v[104:107], v[68:71]
    v_mfma_f32_16x16x32_bf16 v[92:95], v[148:151], v[108:111], v[92:95]
    s_waitcnt lgkmcnt(4)
    v_mfma_f32_16x16x32_bf16 v[0:3], v[128:131], v[112:115], v[0:3]
    ds_read_b64_tr_b16 v[140:141], v230 offset:36864
    v_mfma_f32_16x16x32_bf16 v[24:27], v[128:131], v[116:119], v[24:27]
    ds_read_b64_tr_b16 v[142:143], v230 offset:37376
    s_add_u32 m0, s48, 4096
    v_mfma_f32_16x16x32_bf16 v[48:51], v[128:131], v[120:123], v[48:51]
    buffer_load_dwordx4 v241, s[12:15], s41 offen lds
    ds_read_b64_tr_b16 v[144:145], v231 offset:36864
    v_mfma_f32_16x16x32_bf16 v[72:75], v[128:131], v[124:127], v[72:75]
    ds_read_b64_tr_b16 v[146:147], v231 offset:37376
    s_waitcnt lgkmcnt(6)
    v_mfma_f32_16x16x32_bf16 v[4:7], v[132:135], v[112:115], v[4:7]
    ds_read_b64_tr_b16 v[148:149], v232 offset:36864
    v_mfma_f32_16x16x32_bf16 v[28:31], v[132:135], v[116:119], v[28:31]
    ds_read_b64_tr_b16 v[150:151], v232 offset:37376
    v_mfma_f32_16x16x32_bf16 v[52:55], v[132:135], v[120:123], v[52:55]
    v_mfma_f32_16x16x32_bf16 v[76:79], v[132:135], v[124:127], v[76:79]
    s_add_u32 m0, s48, 8192
    s_waitcnt lgkmcnt(6)
    v_mfma_f32_16x16x32_bf16 v[8:11], v[136:139], v[112:115], v[8:11]
    buffer_load_dwordx4 v242, s[12:15], s41 offen lds
    s_add_u32 s47, s47, 1
    s_xor_b32 s41, s47, s55
    s_mul_i32 s41, s41, 110592
    v_mfma_f32_16x16x32_bf16 v[32:35], v[136:139], v[116:119], v[32:35]
    v_mfma_f32_16x16x32_bf16 v[56:59], v[136:139], v[120:123], v[56:59]
    v_mfma_f32_16x16x32_bf16 v[80:83], v[136:139], v[124:127], v[80:83]
    s_waitcnt vmcnt(6) lgkmcnt(0)
    s_barrier
    v_mfma_f32_16x16x32_bf16 v[12:15], v[140:143], v[112:115], v[12:15]
    s_bitcmp1_b32 s50, s47
    s_cbranch_scc1 KFC_HT2
KFC_HR2:
    ds_read_b128 v[96:99], v236 offset:16384
    v_mfma_f32_16x16x32_bf16 v[36:39], v[140:143], v[116:119], v[36:39]
    ds_read_b128 v[100:103], v236 offset:18432
    v_mfma_f32_16x16x32_bf16 v[60:63], v[140:143], v[120:123], v[60:63]
    ds_read_b128 v[104:107], v236 offset:20480
    v_mfma_f32_16x16x32_bf16 v[84:87], v[140:143], v[124:127], v[84:87]
    ds_read_b128 v[108:111], v236 offset:22528
    s_add_u32 m0, s49, 0
    v_mfma_f32_16x16x32_bf16 v[16:19], v[144:147], v[112:115], v[16:19]
    buffer_load_dwordx4 v243, s[8:11], s42 offen lds
    ds_read_b64_tr_b16 v[128:129], v233 offset:0
    v_mfma_f32_16x16x32_bf16 v[40:43], v[144:147], v[116:119], v[40:43]
    ds_read_b64_tr_b16 v[130:131], v233 offset:512
    v_mfma_f32_16x16x32_bf16 v[64:67], v[144:147], v[120:123], v[64:67]
    ds_read_b64_tr_b16 v[132:133], v234 offset:0
    v_mfma_f32_16x16x32_bf16 v[88:91], v[144:147], v[124:127], v[88:91]
    ds_read_b64_tr_b16 v[134:135], v234 offset:512
    v_mfma_f32_16x16x32_bf16 v[20:23], v[148:151], v[112:115], v[20:23]
    ds_read_b64_tr_b16 v[136:137], v235 offset:0
    s_add_u32 m0, s49, 1024
    v_mfma_f32_16x16x32_bf16 v[44:47], v[148:151], v[116:119], v[44:47]
    buffer_load_dwordx4 v244, s[8:11], s42 offen lds
    s_add_u32 s54, s54, 128
    s_xor_b32 s42, s54, s43
    ds_read_b64_tr_b16 v[138:139], v235 offset:512
    v_mfma_f32_16x16x32_bf16 v[68:71], v[148:151], v[120:123], v[68:71]
    v_mfma_f32_16x16x32_bf16 v[92:95], v[148:151], v[124:127], v[92:95]
    s_waitcnt lgkmcnt(4)
    v_mfma_f32_16x16x32_bf16 v[0:3], v[128:131], v[96:99], v[0:3]
    ds_read_b64_tr_b16 v[140:141], v233 offset:12288
    s_add_u32 m0, s48, 24576
    v_mfma_f32_16x16x32_bf16 v[24:27], v[128:131], v[100:103], v[24:27]
    buffer_load_dwordx4 v240, s[12:15], s41 offen lds
    ds_read_b64_tr_b16 v[142:143], v233 offset:12800
    v_mfma_f32_16x16x32_bf16 v[48:51], v[128:131], v[104:107], v[48:51]
    ds_read_b64_tr_b16 v[144:145], v234 offset:12288
    v_mfma_f32_16x16x32_bf16 v[72:75], v[128:131], v[108:111], v[72:75]
    ds_read_b64_tr_b16 v[146:147], v234 offset:12800
    s_waitcnt lgkmcnt(6)
    v_mfma_f32_16x16x32_bf16 v[4:7], v[132:135], v[96:99], v[4:7]
    ds_read_b64_tr_b16 v[148:149], v235 offset:12288
    s_add_u32 m0, s48, 28672
    v_mfma_f32_16x16x32_bf16 v[28:31], v[132:135], v[100:103], v[28:31]
    buffer_load_dwordx4 v241, s[12:15], s41 offen lds
    ds_read_b64_tr_b16 v[150:151], v235 offset:12800
    v_mfma_f32_16x16x32_bf16 v[52:55], v[132:135], v[104:107], v[52:55]
    v_mfma_f32_16x16x32_bf16 v[76:79], v[132:135], v[108:111], v[76:79]
    s_waitcnt lgkmcnt(6)
    v_mfma_f32_16x16x32_bf16 v[8:11], v[136:139], v[96:99], v[8:11]
    s_add_u32 m0, s48, 32768
    v_mfma_f32_16x16x32_bf16 v[32:35], v[136:139], v[100:103], v[32:35]
    buffer_load_dwordx4 v242, s[12:15], s41 offen lds
    s_add_u32 s47, s47, 1
    s_xor_b32 s41, s47, s55
    s_mul_i32 s41, s41, 110592
    v_mfma_f32_16x16x32_bf16 v[56:59], v[136:139], v[104:107], v[56:59]
    v_mfma_f32_16x16x32_bf16 v[80:83], v[136:139], v[108:111], v[80:83]
    s_waitcnt vmcnt(8) lgkmcnt(0)
    s_barrier
    v_mfma_f32_16x16x32_bf16 v[12:15], v[140:143], v[96:99], v[12:15]
    s_bitcmp1_b32 s50, s47
    s_cbranch_scc1 KFC_HT3
KFC_HR3:
    ds_read_b128 v[112:115], v237 offset:16384
    v_mfma_f32_16x16x32_bf16 v[36:39], v[140:143], v[100:103], v[36:39]
    ds_read_b128 v[116:119], v237 offset:18432
    v_mfma_f32_16x16x32_bf16 v[60:63], v[140:143], v[104:107], v[60:63]
    ds_read_b128 v[120:123], v237 offset:20480
    v_mfma_f32_16x16x32_bf16 v[84:87], v[140:143], v[108:111], v[84:87]
    ds_read_b128 v[124:127], v237 offset:22528
    v_mfma_f32_16x16x32_bf16 v[16:19], v[144:147], v[96:99], v[16:19]
    ds_read_b64_tr_b16 v[128:129], v233 offset:24576
    v_mfma_f32_16x16x32_bf16 v[40:43], v[144:147], v[100:103], v[40:43]
    ds_read_b64_tr_b16 v[130:131], v233 offset:25088
    s_add_u32 m0, s48, 49152
    v_mfma_f32_16x16x32_bf16 v[64:67], v[144:147], v[104:107], v[64:67]
    buffer_load_dwordx4 v240, s[12:15], s41 offen lds
    ds_read_b64_tr_b16 v[132:133], v234 offset:24576
    v_mfma_f32_16x16x32_bf16 v[88:91], v[144:147], v[108:111], v[88:91]
    ds_read_b64_tr_b16 v[134:135], v234 offset:25088
    v_mfma_f32_16x16x32_bf16 v[20:23], v[148:151], v[96:99], v[20:23]
    ds_read_b64_tr_b16 v[136:137], v235 offset:24576
    v_mfma_f32_16x16x32_bf16 v[44:47], v[148:151], v[100:103], v[44:47]
    ds_read_b64_tr_b16 v[138:139], v235 offset:25088
    v_mfma_f32_16x16x32_bf16 v[68:71], v[148:151], v[104:107], v[68:71]
    v_mfma_f32_16x16x32_bf16 v[92:95], v[148:151], v[108:111], v[92:95]
    s_waitcnt lgkmcnt(4)
    v_mfma_f32_16x16x32_bf16 v[0:3], v[128:131], v[112:115], v[0:3]
    ds_read_b64_tr_b16 v[140:141], v233 offset:36864
    v_mfma_f32_16x16x32_bf16 v[24:27], v[128:131], v[116:119], v[24:27]
    ds_read_b64_tr_b16 v[142:143], v233 offset:37376
    s_add_u32 m0, s48, 53248
    v_mfma_f32_16x16x32_bf16 v[48:51], v[128:131], v[120:123], v[48:51]
    buffer_load_dwordx4 v241, s[12:15], s41 offen lds
    ds_read_b64_tr_b16 v[144:145], v234 offset:36864
    v_mfma_f32_16x16x32_bf16 v[72:75], v[128:131], v[124:127], v[72:75]
    ds_read_b64_tr_b16 v[146:147], v234 offset:37376
    s_waitcnt lgkmcnt(6)
    v_mfma_f32_16x16x32_bf16 v[4:7], v[132:135], v[112:115], v[4:7]
    ds_read_b64_tr_b16 v[148:149], v235 offset:36864
    v_mfma_f32_16x16x32_bf16 v[28:31], v[132:135], v[116:119], v[28:31]
    ds_read_b64_tr_b16 v[150:151], v235 offset:37376
    v_mfma_f32_16x16x32_bf16 v[52:55], v[132:135], v[120:123], v[52:55]
    v_mfma_f32_16x16x32_bf16 v[76:79], v[132:135], v[124:127], v[76:79]
    s_add_u32 m0, s48, 57344
    s_waitcnt lgkmcnt(6)
    v_mfma_f32_16x16x32_bf16 v[8:11], v[136:139], v[112:115], v[8:11]
    buffer_load_dwordx4 v242, s[12:15], s41 offen lds
    s_add_u32 s47, s47, 1
    s_xor_b32 s41, s47, s55
    s_mul_i32 s41, s41, 110592
    v_mfma_f32_16x16x32_bf16 v[32:35], v[136:139], v[116:119], v[32:35]
    s_cmp_lg_u32 s47, 19
    s_cbranch_scc1 KFC_LOOP
    v_mfma_f32_16x16x32_bf16 v[56:59], v[136:139], v[120:123], v[56:59]
    v_mfma_f32_16x16x32_bf16 v[80:83], v[136:139], v[124:127], v[80:83]
    s_waitcnt vmcnt(6) lgkmcnt(0)
    s_barrier
    v_mfma_f32_16x16x32_bf16 v[12:15], v[140:143], v[112:115], v[12:15]
    v_readfirstlane_b32 s65, v253
    s_mov_b32 s44, 20119552
    s_nop 2
    s_cmp_eq_u32 s65, 0
    s_cbranch_scc1 KFC_TK
KFC_TKR:
    v_mov_b32 v253, 0
    buffer_load_dword v253, v245, s[16:19], s44 offen sc1
    ds_read_b128 v[96:99], v236 offset:0
    s_mul_i32 s3, s40, 14
    s_cmp_eq_u32 s40, 3
    s_cselect_b32 s3, 41, s3
    s_mul_i32 s4, s40, 5
    s_add_u32 s4, s4, 34
    s_cmp_ge_u32 s40, 4
    s_cselect_b32 s76, s4, s3
    s_mul_i32 s75, s29, 5120
    s_mul_i32 s4, s76, 40960
    s_add_u32 s75, s75, s4
    s_add_u32 s75, s75, 10485760
    v_mfma_f32_16x16x32_bf16 v[36:39], v[140:143], v[116:119], v[36:39]
    ds_read_b128 v[100:103], v236 offset:2048
    v_and_b32 v238, 7, v250
    v_mfma_f32_16x16x32_bf16 v[60:63], v[140:143], v[120:123], v[60:63]
    ds_read_b128 v[104:107], v236 offset:4096
    v_lshlrev_b32 v238, 3, v238
    v_mfma_f32_16x16x32_bf16 v[84:87], v[140:143], v[124:127], v[84:87]
    ds_read_b128 v[108:111], v236 offset:6144
    v_bfe_u32 v239, v250, 3, 1
    s_add_u32 m0, s49, 16384
    v_mfma_f32_16x16x32_bf16 v[16:19], v[144:147], v[112:115], v[16:19]
    buffer_load_dwordx4 v243, s[8:11], s42 offen lds
    ds_read_b64_tr_b16 v[128:129], v230 offset:0
    v_lshl_add_u32 v255, v239, 7, v238
    v_mfma_f32_16x16x32_bf16 v[40:43], v[144:147], v[116:119], v[40:43]
    ds_read_b64_tr_b16 v[130:131], v230 offset:512
    s_lshl_b32 s70, s25, 7
    v_mfma_f32_16x16x32_bf16 v[64:67], v[144:147], v[120:123], v[64:67]
    ds_read_b64_tr_b16 v[132:133], v231 offset:0
    s_add_u32 s70, s70, s74
    v_mfma_f32_16x16x32_bf16 v[88:91], v[144:147], v[124:127], v[88:91]
    ds_read_b64_tr_b16 v[134:135], v231 offset:512
    s_lshl_b32 s70, s70, 4
    v_mfma_f32_16x16x32_bf16 v[20:23], v[148:151], v[112:115], v[20:23]
    ds_read_b64_tr_b16 v[136:137], v232 offset:0
    s_add_u32 s70, s70, 19922944
    s_add_u32 m0, s49, 17408
    v_mfma_f32_16x16x32_bf16 v[44:47], v[148:151], v[116:119], v[44:47]
    buffer_load_dwordx4 v244, s[8:11], s42 offen lds
    ds_read_b64_tr_b16 v[138:139], v232 offset:512
    s_mul_i32 s72, s26, 12
    v_mfma_f32_16x16x32_bf16 v[68:71], v[148:151], v[120:123], v[68:71]
    s_add_u32 s72, s72, s46
    v_mfma_f32_16x16x32_bf16 v[92:95], v[148:151], v[124:127], v[92:95]
    s_lshl_b32 s72, s72, 6
    s_waitcnt lgkmcnt(4)
    v_mfma_f32_16x16x32_bf16 v[0:3], v[128:131], v[96:99], v[0:3]
    ds_read_b64_tr_b16 v[140:141], v230 offset:12288
    s_add_u32 s72, s72, 19972096
    s_add_u32 m0, s48, 73728
    v_mfma_f32_16x16x32_bf16 v[24:27], v[128:131], v[100:103], v[24:27]
    buffer_load_dwordx4 v240, s[12:15], s41 offen lds
    ds_read_b64_tr_b16 v[142:143], v230 offset:12800
    s_add_u32 s73, s72, 6912
    v_mfma_f32_16x16x32_bf16 v[48:51], v[128:131], v[104:107], v[48:51]
    ds_read_b64_tr_b16 v[144:145], v231 offset:12288
    v_mfma_f32_16x16x32_bf16 v[72:75], v[128:131], v[108:111], v[72:75]
    ds_read_b64_tr_b16 v[146:147], v231 offset:12800
    s_waitcnt lgkmcnt(6)
    v_mfma_f32_16x16x32_bf16 v[4:7], v[132:135], v[96:99], v[4:7]
    ds_read_b64_tr_b16 v[148:149], v232 offset:12288
    s_add_u32 m0, s48, 77824
    v_mfma_f32_16x16x32_bf16 v[28:31], v[132:135], v[100:103], v[28:31]
    buffer_load_dwordx4 v241, s[12:15], s41 offen lds
    ds_read_b64_tr_b16 v[150:151], v232 offset:12800
    v_mfma_f32_16x16x32_bf16 v[52:55], v[132:135], v[104:107], v[52:55]
    v_mfma_f32_16x16x32_bf16 v[76:79], v[132:135], v[108:111], v[76:79]
    s_waitcnt lgkmcnt(6)
    v_mfma_f32_16x16x32_bf16 v[8:11], v[136:139], v[96:99], v[8:11]
    s_add_u32 m0, s48, 81920
    v_mfma_f32_16x16x32_bf16 v[32:35], v[136:139], v[100:103], v[32:35]
    buffer_load_dwordx4 v242, s[12:15], s41 offen lds
    v_mfma_f32_16x16x32_bf16 v[56:59], v[136:139], v[104:107], v[56:59]
    v_mfma_f32_16x16x32_bf16 v[80:83], v[136:139], v[108:111], v[80:83]
    s_waitcnt vmcnt(9) lgkmcnt(0)
    s_barrier
    v_mfma_f32_16x16x32_bf16 v[12:15], v[140:143], v[96:99], v[12:15]
    ds_read_b128 v[112:115], v237 offset:0
    v_mfma_f32_16x16x32_bf16 v[36:39], v[140:143], v[100:103], v[36:39]
    ds_read_b128 v[116:119], v237 offset:2048
    v_mfma_f32_16x16x32_bf16 v[60:63], v[140:143], v[104:107], v[60:63]
    ds_read_b128 v[120:123], v237 offset:4096
    v_mfma_f32_16x16x32_bf16 v[84:87], v[140:143], v[108:111], v[84:87]
    ds_read_b128 v[124:127], v237 offset:6144
    v_mfma_f32_16x16x32_bf16 v[16:19], v[144:147], v[96:99], v[16:19]
    ds_read_b64_tr_b16 v[128:129], v230 offset:24576
    v_mfma_f32_16x16x32_bf16 v[40:43], v[144:147], v[100:103], v[40:43]
    ds_read_b64_tr_b16 v[130:131], v230 offset:25088
    v_mfma_f32_16x16x32_bf16 v[64:67], v[144:147], v[104:107], v[64:67]
    ds_read_b64_tr_b16 v[132:133], v231 offset:24576
    v_mfma_f32_16x16x32_bf16 v[88:91], v[144:147], v[108:111], v[88:91]
    ds_read_b64_tr_b16 v[134:135], v231 offset:25088
    v_mfma_f32_16x16x32_bf16 v[20:23], v[148:151], v[96:99], v[20:23]
    ds_read_b64_tr_b16 v[136:137], v232 offset:24576
    v_mfma_f32_16x16x32_bf16 v[44:47], v[148:151], v[100:103], v[44:47]
    ds_read_b64_tr_b16 v[138:139], v232 offset:25088
    v_mfma_f32_16x16x32_bf16 v[68:71], v[148:151], v[104:107], v[68:71]
    v_mfma_f32_16x16x32_bf16 v[92:95], v[148:151], v[108:111], v[92:95]
    s_waitcnt vmcnt(5)
    v_cmp_ne_u32 vcc, s65, v253
    s_nop 4
    s_cbranch_vccnz KFC_HBT1
KFC_HBR1:
    s_waitcnt lgkmcnt(4)
    v_mfma_f32_16x16x32_bf16 v[0:3], v[128:131], v[112:115], v[0:3]
    ds_read_b64_tr_b16 v[140:141], v230 offset:36864
    v_mfma_f32_16x16x32_bf16 v[24:27], v[128:131], v[116:119], v[24:27]
    ds_read_b64_tr_b16 v[142:143], v230 offset:37376
    v_mfma_f32_16x16x32_bf16 v[48:51], v[128:131], v[120:123], v[48:51]
    ds_read_b64_tr_b16 v[144:145], v231 offset:36864
    buffer_load_dwordx4 v[166:169], v251, s[16:19], s75 offen offset:0 sc1
    v_mfma_f32_16x16x32_bf16 v[72:75], v[128:131], v[124:127], v[72:75]
    ds_read_b64_tr_b16 v[146:147], v231 offset:37376
    s_waitcnt lgkmcnt(6)
    v_mfma_f32_16x16x32_bf16 v[4:7], v[132:135], v[112:115], v[4:7]
    ds_read_b64_tr_b16 v[148:149], v232 offset:36864
    v_mfma_f32_16x16x32_bf16 v[28:31], v[132:135], v[116:119], v[28:31]
    ds_read_b64_tr_b16 v[150:151], v232 offset:37376
    buffer_load_dwordx4 v[170:173], v251, s[16:19], s75 offen offset:1024 sc1
    v_mfma_f32_16x16x32_bf16 v[52:55], v[132:135], v[120:123], v[52:55]
    v_mfma_f32_16x16x32_bf16 v[76:79], v[132:135], v[124:127], v[76:79]
    s_waitcnt lgkmcnt(6)
    v_mfma_f32_16x16x32_bf16 v[8:11], v[136:139], v[112:115], v[8:11]
    buffer_load_dwordx4 v[174:177], v251, s[16:19], s75 offen offset:2048 sc1
    v_mfma_f32_16x16x32_bf16 v[32:35], v[136:139], v[116:119], v[32:35]
    v_mfma_f32_16x16x32_bf16 v[56:59], v[136:139], v[120:123], v[56:59]
    v_mfma_f32_16x16x32_bf16 v[80:83], v[136:139], v[124:127], v[80:83]
    v_and_b32 v253, 48, v250
    buffer_load_dwordx4 v[152:155], v253, s[16:19], s72 offen offset:0 sc1
    s_waitcnt vmcnt(7) lgkmcnt(0)
    s_barrier
    v_mfma_f32_16x16x32_bf16 v[12:15], v[140:143], v[112:115], v[12:15]
    ds_read_b128 v[96:99], v236 offset:16384
    v_mfma_f32_16x16x32_bf16 v[36:39], v[140:143], v[116:119], v[36:39]
    ds_read_b128 v[100:103], v236 offset:18432
    v_mfma_f32_16x16x32_bf16 v[60:63], v[140:143], v[120:123], v[60:63]
    ds_read_b128 v[104:107], v236 offset:20480
    buffer_load_dwordx4 v[156:159], v253, s[16:19], s72 offen offset:64 sc1
    v_mfma_f32_16x16x32_bf16 v[84:87], v[140:143], v[124:127], v[84:87]
    ds_read_b128 v[108:111], v236 offset:22528
    v_mfma_f32_16x16x32_bf16 v[16:19], v[144:147], v[112:115], v[16:19]
    ds_read_b64_tr_b16 v[128:129], v233 offset:0
    v_mfma_f32_16x16x32_bf16 v[40:43], v[144:147], v[116:119], v[40:43]
    ds_read_b64_tr_b16 v[130:131], v233 offset:512
    buffer_load_dwordx4 v[160:163], v253, s[16:19], s72 offen offset:128 sc1
    v_mfma_f32_16x16x32_bf16 v[64:67], v[144:147], v[120:123], v[64:67]
    ds_read_b64_tr_b16 v[132:133], v234 offset:0
    v_mfma_f32_16x16x32_bf16 v[88:91], v[144:147], v[124:127], v[88:91]
    ds_read_b64_tr_b16 v[134:135], v234 offset:512
    v_mfma_f32_16x16x32_bf16 v[20:23], v[148:151], v[112:115], v[20:23]
    ds_read_b64_tr_b16 v[136:137], v235 offset:0
    buffer_load_dwordx4 v[226:229], v253, s[16:19], s73 offen offset:0 sc1
    v_mfma_f32_16x16x32_bf16 v[44:47], v[148:151], v[116:119], v[44:47]
    ds_read_b64_tr_b16 v[138:139], v235 offset:512
    v_mfma_f32_16x16x32_bf16 v[68:71], v[148:151], v[120:123], v[68:71]
    v_mfma_f32_16x16x32_bf16 v[92:95], v[148:151], v[124:127], v[92:95]
    buffer_load_dwordx4 v[246:249], v253, s[16:19], s73 offen offset:64 sc1
    s_waitcnt lgkmcnt(4)
    v_mfma_f32_16x16x32_bf16 v[0:3], v[128:131], v[96:99], v[0:3]
    ds_read_b64_tr_b16 v[140:141], v233 offset:12288
    v_mfma_f32_16x16x32_bf16 v[24:27], v[128:131], v[100:103], v[24:27]
    ds_read_b64_tr_b16 v[142:143], v233 offset:12800
    v_mfma_f32_16x16x32_bf16 v[48:51], v[128:131], v[104:107], v[48:51]
    ds_read_b64_tr_b16 v[144:145], v234 offset:12288
    buffer_load_dwordx4 v[240:243], v253, s[16:19], s73 offen offset:128 sc1
    v_mfma_f32_16x16x32_bf16 v[72:75], v[128:131], v[108:111], v[72:75]
    ds_read_b64_tr_b16 v[146:147], v234 offset:12800
    s_waitcnt lgkmcnt(6)
    v_mfma_f32_16x16x32_bf16 v[4:7], v[132:135], v[96:99], v[4:7]
    ds_read_b64_tr_b16 v[148:149], v235 offset:12288
    v_mfma_f32_16x16x32_bf16 v[28:31], v[132:135], v[100:103], v[28:31]
    ds_read_b64_tr_b16 v[150:151], v235 offset:12800
    buffer_load_dwordx2 v[164:165], v255, s[16:19], s70 offen offset:0 sc1
    v_mfma_f32_16x16x32_bf16 v[52:55], v[132:135], v[104:107], v[52:55]
    v_mfma_f32_16x16x32_bf16 v[76:79], v[132:135], v[108:111], v[76:79]
    s_waitcnt lgkmcnt(6)
    v_mfma_f32_16x16x32_bf16 v[8:11], v[136:139], v[96:99], v[8:11]
    buffer_load_dwordx2 v[238:239], v255, s[16:19], s70 offen offset:256 sc1
    v_mfma_f32_16x16x32_bf16 v[32:35], v[136:139], v[100:103], v[32:35]
    v_mfma_f32_16x16x32_bf16 v[56:59], v[136:139], v[104:107], v[56:59]
    v_mfma_f32_16x16x32_bf16 v[80:83], v[136:139], v[108:111], v[80:83]
    buffer_load_dwordx2 v[244:245], v255, s[16:19], s70 offen offset:512 sc1
    s_waitcnt vmcnt(12) lgkmcnt(0)
    s_barrier
    v_mfma_f32_16x16x32_bf16 v[12:15], v[140:143], v[96:99], v[12:15]
    ds_read_b128 v[112:115], v237 offset:16384
    v_mfma_f32_16x16x32_bf16 v[36:39], v[140:143], v[100:103], v[36:39]
    ds_read_b128 v[116:119], v237 offset:18432
    v_mfma_f32_16x16x32_bf16 v[60:63], v[140:143], v[104:107], v[60:63]
    ds_read_b128 v[120:123], v237 offset:20480
    buffer_load_dwordx2 v[230:231], v255, s[16:19], s70 offen offset:768 sc1
    v_mfma_f32_16x16x32_bf16 v[84:87], v[140:143], v[108:111], v[84:87]
    ds_read_b128 v[124:127], v237 offset:22528
    v_mfma_f32_16x16x32_bf16 v[16:19], v[144:147], v[96:99], v[16:19]
    ds_read_b64_tr_b16 v[128:129], v233 offset:24576
    v_mfma_f32_16x16x32_bf16 v[40:43], v[144:147], v[100:103], v[40:43]
    ds_read_b64_tr_b16 v[130:131], v233 offset:25088
    buffer_load_dwordx4 v[178:181], v251, s[16:19], s75 offen offset:3072 sc1
    v_mfma_f32_16x16x32_bf16 v[64:67], v[144:147], v[104:107], v[64:67]
    ds_read_b64_tr_b16 v[132:133], v234 offset:24576
    v_mfma_f32_16x16x32_bf16 v[88:91], v[144:147], v[108:111], v[88:91]
    ds_read_b64_tr_b16 v[134:135], v234 offset:25088
    v_mfma_f32_16x16x32_bf16 v[20:23], v[148:151], v[96:99], v[20:23]
    ds_read_b64_tr_b16 v[136:137], v235 offset:24576
    buffer_load_dwordx4 v[182:185], v252, s[16:19], s75 offen sc1
    s_add_u32 s75, s75, 40960
    v_mfma_f32_16x16x32_bf16 v[44:47], v[148:151], v[100:103], v[44:47]
    ds_read_b64_tr_b16 v[138:139], v235 offset:25088
    v_mfma_f32_16x16x32_bf16 v[68:71], v[148:151], v[104:107], v[68:71]
    v_mfma_f32_16x16x32_bf16 v[92:95], v[148:151], v[108:111], v[92:95]
    buffer_load_dwordx4 v[186:189], v251, s[16:19], s75 offen offset:0 sc1
    s_waitcnt lgkmcnt(4)
    v_mfma_f32_16x16x32_bf16 v[0:3], v[128:131], v[112:115], v[0:3]
    ds_read_b64_tr_b16 v[140:141], v233 offset:36864
    v_mfma_f32_16x16x32_bf16 v[24:27], v[128:131], v[116:119], v[24:27]
    ds_read_b64_tr_b16 v[142:143], v233 offset:37376
    v_mfma_f32_16x16x32_bf16 v[48:51], v[128:131], v[120:123], v[48:51]
    ds_read_b64_tr_b16 v[144:145], v234 offset:36864
    buffer_load_dwordx4 v[190:193], v251, s[16:19], s75 offen offset:1024 sc1
    v_mfma_f32_16x16x32_bf16 v[72:75], v[128:131], v[124:127], v[72:75]
    ds_read_b64_tr_b16 v[146:147], v234 offset:37376
    s_waitcnt lgkmcnt(6)
    v_mfma_f32_16x16x32_bf16 v[4:7], v[132:135], v[112:115], v[4:7]
    ds_read_b64_tr_b16 v[148:149], v235 offset:36864
    v_mfma_f32_16x16x32_bf16 v[28:31], v[132:135], v[116:119], v[28:31]
    ds_read_b64_tr_b16 v[150:151], v235 offset:37376
    buffer_load_dwordx4 v[194:197], v251, s[16:19], s75 offen offset:2048 sc1
    v_mfma_f32_16x16x32_bf16 v[52:55], v[132:135], v[120:123], v[52:55]
    v_mfma_f32_16x16x32_bf16 v[76:79], v[132:135], v[124:127], v[76:79]
    s_waitcnt lgkmcnt(6)
    v_mfma_f32_16x16x32_bf16 v[8:11], v[136:139], v[112:115], v[8:11]
    buffer_load_dwordx4 v[198:201], v251, s[16:19], s75 offen offset:3072 sc1
    v_mfma_f32_16x16x32_bf16 v[32:35], v[136:139], v[116:119], v[32:35]
    v_mfma_f32_16x16x32_bf16 v[56:59], v[136:139], v[120:123], v[56:59]
    v_mfma_f32_16x16x32_bf16 v[80:83], v[136:139], v[124:127], v[80:83]
    buffer_load_dwordx4 v[202:205], v252, s[16:19], s75 offen sc1
    s_add_u32 s75, s75, 40960
    s_waitcnt lgkmcnt(0)
    s_barrier
    v_mfma_f32_16x16x32_bf16 v[12:15], v[140:143], v[112:115], v[12:15]
    v_mfma_f32_16x16x32_bf16 v[36:39], v[140:143], v[116:119], v[36:39]
    v_mfma_f32_16x16x32_bf16 v[60:63], v[140:143], v[120:123], v[60:63]
    buffer_load_dwordx4 v[206:209], v251, s[16:19], s75 offen offset:0 sc1
    v_mfma_f32_16x16x32_bf16 v[84:87], v[140:143], v[124:127], v[84:87]
    v_mfma_f32_16x16x32_bf16 v[16:19], v[144:147], v[112:115], v[16:19]
    v_mfma_f32_16x16x32_bf16 v[40:43], v[144:147], v[116:119], v[40:43]
    buffer_load_dwordx4 v[210:213], v251, s[16:19], s75 offen offset:1024 sc1
    v_mfma_f32_16x16x32_bf16 v[64:67], v[144:147], v[120:123], v[64:67]
    v_mfma_f32_16x16x32_bf16 v[88:91], v[144:147], v[124:127], v[88:91]
    v_mfma_f32_16x16x32_bf16 v[20:23], v[148:151], v[112:115], v[20:23]
    buffer_load_dwordx4 v[214:217], v251, s[16:19], s75 offen offset:2048 sc1
    v_mfma_f32_16x16x32_bf16 v[44:47], v[148:151], v[116:119], v[44:47]
    v_mfma_f32_16x16x32_bf16 v[68:71], v[148:151], v[120:123], v[68:71]
    v_mfma_f32_16x16x32_bf16 v[92:95], v[148:151], v[124:127], v[92:95]
    buffer_load_dwordx4 v[218:221], v251, s[16:19], s75 offen offset:3072 sc1
    buffer_load_dwordx4 v[222:225], v252, s[16:19], s75 offen sc1
    s_add_u32 s75, s75, 40960
    s_waitcnt vmcnt(12)
    s_branch KFC_DONE
KFC_HT0:
    s_cmp_eq_u32 s47, 7
    s_cbranch_scc1 KFC_HT0B
    buffer_store_dwordx4 v[196:199], v251, s[16:19], s71 offen offset:2048 sc1
    buffer_store_dwordx4 v[200:203], v251, s[16:19], s71 offen offset:3072 sc1
    s_branch KFC_HR0
KFC_HT0B:
    s_add_u32 m0, s61, 0
    s_nop 0
    buffer_load_dwordx4 v184, s[36:39], s70 offen lds
    s_add_u32 s70, s70, 10240
    s_add_u32 m0, s61, 1024
    s_nop 0
    buffer_load_dwordx4 v184, s[36:39], s70 offen lds
    s_add_u32 s70, s70, 10240
    s_branch KFC_HR0
KFC_HT1:
    s_cmp_eq_u32 s47, s53
    s_cbranch_scc1 KFC_HD
    s_add_u32 m0, s61, 2048
    s_nop 0
    buffer_load_dwordx4 v184, s[36:39], s70 offen lds
    s_add_u32 s70, s70, 10240
    s_add_u32 m0, s61, 3072
    s_nop 0
    buffer_load_dwordx4 v184, s[36:39], s70 offen lds
    s_branch KFC_HR1
KFC_HT2:
    s_cmp_eq_u32 s47, 13
    s_cbranch_scc1 KFC_HA
    v_lshlrev_b32 v174, 16, v166
    v_and_b32 v175, 0xffff0000, v166
    v_add_f32 v172, v174, v175
    v_mul_f32 v173, v174, v174
    v_fmac_f32 v173, v175, v175
    v_lshlrev_b32 v174, 16, v167
    v_and_b32 v175, 0xffff0000, v167
    v_add_f32 v172, v172, v174
    v_fmac_f32 v173, v174, v174
    v_add_f32 v172, v172, v175
    v_fmac_f32 v173, v175, v175
    v_lshlrev_b32 v174, 16, v168
    v_and_b32 v175, 0xffff0000, v168
    v_add_f32 v172, v172, v174
    v_fmac_f32 v173, v174, v174
    v_add_f32 v172, v172, v175
    v_fmac_f32 v173, v175, v175
    v_lshlrev_b32 v174, 16, v169
    v_and_b32 v175, 0xffff0000, v169
    v_add_f32 v172, v172, v174
    v_fmac_f32 v173, v174, v174
    v_add_f32 v172, v172, v175
    v_fmac_f32 v173, v175, v175
    v_lshlrev_b32 v174, 16, v170
    v_and_b32 v175, 0xffff0000, v170
    v_add_f32 v172, v172, v174
    v_fmac_f32 v173, v174, v174
    v_add_f32 v172, v172, v175
    v_fmac_f32 v173, v175, v175
    s_lshl_b32 s3, s40, 5
    v_add_f32_dpp v172, v172, v172 quad_perm:[1,0,3,2] row_mask:0xf bank_mask:0xf
    v_add_f32_dpp v173, v173, v173 quad_perm:[1,0,3,2] row_mask:0xf bank_mask:0xf
    s_add_u32 s3, s3, 163328
    v_add_f32_dpp v172, v172, v172 quad_perm:[2,3,0,1] row_mask:0xf bank_mask:0xf
    v_add_f32_dpp v173, v173, v173 quad_perm:[2,3,0,1] row_mask:0xf bank_mask:0xf
    v_lshrrev_b32 v174, 4, v250
    v_add_f32_dpp v172, v172, v172 row_half_mirror row_mask:0xf bank_mask:0xf
    v_add_f32_dpp v173, v173, v173 row_half_mirror row_mask:0xf bank_mask:0xf
    v_lshl_add_u32 v174, v174, 3, s3
    v_add_f32_dpp v172, v172, v172 row_mirror row_mask:0xf bank_mask:0xf
    v_add_f32_dpp v173, v173, v173 row_mirror row_mask:0xf bank_mask:0xf
    ds_write_b64 v174, v[172:173]
    buffer_load_dword v253, v254, s[20:23], 0 offen sc1
    s_branch KFC_HR2
KFC_HA:
KFC_HG2T:
    v_readfirstlane_b32 s65, v253
    s_nop 3
    s_cmp_lg_u32 s65, 0
    s_cbranch_scc1 KFC_HG2T_X
    s_add_u32 s77, s77, 1
    s_cmp_gt_u32 s77, 100000
    s_cbranch_scc1 KFC_HG2T_X
    s_sleep 8
    buffer_load_dword v253, v254, s[20:23], 0 offen sc1
    s_waitcnt vmcnt(0)
    s_branch KFC_HG2T
KFC_HG2T_X:
    s_cmp_lg_u32 s40, 0
    s_cbranch_scc1 KFC_HG2
    s_bfe_u32 s4, s27, 0x80010
    s_lshl_b32 s4, s4, 4
    s_add_u32 s4, s4, s25
    s_lshl_b32 s4, s4, 7
    s_add_u32 s4, s4, 20086784
    v_lshlrev_b32 v166, 2, v250
    v_mov_b32 v167, s65
    s_mov_b32 exec_hi, 0
    buffer_store_dword v167, v166, s[16:19], s4 offen sc1
    s_mov_b32 exec_hi, -1
KFC_HG2:
    s_branch KFC_HR2
KFC_HT3:
    s_cmp_eq_u32 s40, 0
    s_cbranch_scc1 KFC_HT3B
    ds_read_b64_tr_b16 v[188:189], v185 offset:0
    ds_read_b64_tr_b16 v[190:191], v185 offset:512
    ds_read_b64_tr_b16 v[192:193], v185 offset:32
    ds_read_b64_tr_b16 v[194:195], v185 offset:544
    ds_read_b64_tr_b16 v[196:197], v185 offset:64
    ds_read_b64_tr_b16 v[198:199], v185 offset:576
    ds_read_b64_tr_b16 v[200:201], v185 offset:96
    ds_read_b64_tr_b16 v[202:203], v185 offset:608
    s_waitcnt lgkmcnt(6)
    buffer_store_dwordx4 v[188:191], v251, s[16:19], s71 offen offset:0 sc1
    s_waitcnt lgkmcnt(4)
    buffer_store_dwordx4 v[192:195], v251, s[16:19], s71 offen offset:1024 sc1
    s_branch KFC_HR3
KFC_HT3B:
    v_and_b32 v174, 7, v250
    v_lshlrev_b32 v174, 5, v174
    v_add_u32 v174, 163328, v174
    ds_read_b128 v[166:169], v174
    ds_read_b128 v[170:173], v174 offset:16
    v_lshlrev_b32 v175, 3, v250
    v_lshlrev_b32 v174, 26, v250
    v_and_b32 v174, 0xc0000000, v174
    v_lshrrev_b32 v174, 1, v174
    v_or_b32 v175, v174, v175
    s_lshl_b32 s3, s44, 4
    s_add_u32 s3, s3, 19922944
    s_waitcnt lgkmcnt(0)
    v_add_f32 v166, v166, v168
    v_add_f32 v167, v167, v169
    v_add_f32 v170, v170, v172
    v_add_f32 v171, v171, v173
    v_add_f32 v166, v166, v170
    v_add_f32 v167, v167, v171
    v_mul_f32 v166, 0xbacccccd, v166
    v_mul_f32 v174, v166, v166
    v_cvt_pk_bf16_f32 v168, v166, v166
    v_mul_f32 v167, 0x3acccccd, v167
    v_sub_f32 v167, v167, v174
    v_max_f32 v167, 0, v167
    v_cvt_pk_bf16_f32 v174, v167, v167
    v_and_b32 v174, 0xffff0000, v174
    v_add_f32 v174, 0x3727c5ac, v174
    v_cvt_pk_bf16_f32 v174, v174, v174
    v_and_b32 v174, 0xffff0000, v174
    v_sqrt_f32 v174, v174
    s_nop 0
    v_cvt_pk_bf16_f32 v174, v174, v174
    v_and_b32 v169, 0xffff0000, v174
    buffer_store_dwordx2 v[168:169], v175, s[16:19], s3 offen sc1
    s_branch KFC_HR3
KFC_TK:
KFC_TK1:
    v_readfirstlane_b32 s65, v253
    s_nop 3
    s_cmp_lg_u32 s65, 0
    s_cbranch_scc1 KFC_TK1_X
    s_add_u32 s77, s77, 1
    s_cmp_gt_u32 s77, 100000
    s_cbranch_scc1 KFC_TK1_X
    s_sleep 8
    buffer_load_dword v253, v254, s[20:23], 0 offen sc1
    s_waitcnt vmcnt(0)
    s_branch KFC_TK1
KFC_TK1_X:
    s_branch KFC_TKR
KFC_HBT1:
    s_waitcnt lgkmcnt(0)
    s_call_b64 s[6:7], KFC_HB
    s_branch KFC_HBR1
KFC_HB:
    s_add_u32 s77, s77, 1
    s_cmp_gt_u32 s77, 100000
    s_cbranch_scc1 KFC_HBX
    s_sleep 2
    buffer_load_dword v253, v245, s[16:19], s44 offen sc1
    s_waitcnt vmcnt(0)
    v_cmp_ne_u32 vcc, s65, v253
    s_nop 4
    s_cbranch_vccnz KFC_HB
KFC_HBX:
    s_setpc_b64 s[6:7]
KFC_HD:
    s_lshl_b32 s3, s26, 2
    s_add_u32 s3, s3, s51
    s_lshl_b32 s3, s3, 3
    s_lshr_b32 s4, s27, 24
    s_add_u32 s3, s3, s4
    s_lshl_b32 s3, s3, 9
    s_add_u32 s3, s3, 20152320
    v_mov_b32 v180, 0x3f803f80
    v_mov_b32 v181, 0x3f803f80
    v_mov_b32 v182, 0x3f803f80
    v_mov_b32 v183, 0x3f803f80
    s_nop 1
    v_mfma_f32_16x16x32_bf16 v[184:187], v[128:131], v[180:183], 0
    v_mfma_f32_16x16x32_bf16 v[188:191], v[132:135], v[180:183], 0
    v_mfma_f32_16x16x32_bf16 v[192:195], v[136:139], v[180:183], 0
    v_mfma_f32_16x16x32_bf16 v[196:199], v[140:143], v[180:183], 0
    v_mfma_f32_16x16x32_bf16 v[200:203], v[144:147], v[180:183], 0
    v_mfma_f32_16x16x32_bf16 v[204:207], v[148:151], v[180:183], 0
    v_and_b32 v178, 15, v250
    v_and_b32 v179, 48, v250
    v_lshl_add_u32 v179, v178, 6, v179
    v_lshlrev_b32 v208, 27, v178
    v_and_b32 v208, 0x40000000, v208
    v_or_b32 v179, v208, v179
    v_cmp_eq_u32 vcc, 1, v178
    s_nop 1
    v_cndmask_b32 v184, v184, v188, vcc
    v_cndmask_b32 v185, v185, v189, vcc
    v_cndmask_b32 v186, v186, v190, vcc
    v_cndmask_b32 v187, v187, v191, vcc
    v_cmp_eq_u32 vcc, 2, v178
    s_nop 1
    v_cndmask_b32 v184, v184, v192, vcc
    v_cndmask_b32 v185, v185, v193, vcc
    v_cndmask_b32 v186, v186, v194, vcc
    v_cndmask_b32 v187, v187, v195, vcc
    v_cmp_eq_u32 vcc, 3, v178
    s_nop 1
    v_cndmask_b32 v184, v184, v196, vcc
    v_cndmask_b32 v185, v185, v197, vcc
    v_cndmask_b32 v186, v186, v198, vcc
    v_cndmask_b32 v187, v187, v199, vcc
    v_cmp_eq_u32 vcc, 4, v178
    s_nop 1
    v_cndmask_b32 v184, v184, v200, vcc
    v_cndmask_b32 v185, v185, v201, vcc
    v_cndmask_b32 v186, v186, v202, vcc
    v_cndmask_b32 v187, v187, v203, vcc
    v_cmp_eq_u32 vcc, 5, v178
    s_nop 1
    v_cndmask_b32 v184, v184, v204, vcc
    v_cndmask_b32 v185, v185, v205, vcc
    v_cndmask_b32 v186, v186, v206, vcc
    v_cndmask_b32 v187, v187, v207, vcc
    buffer_store_dwordx4 v[184:187], v179, s[16:19], s3 offen sc1
    s_branch KFC_HR1
KFC_DONE:
    v_rcp_f32 v97, v165
    v_mul_f32 v100, v165, v165
    v_and_b32 v102, 0xffff0000, v164
    v_mul_f32 v98, 0xc0135761, v97
    v_mul_f32 v97, v97, v97
    v_mul_f32 v97, 0x3d372713, v97
    v_mul_f32 v96, v97, v98
    v_rcp_f32 v105, v239
    v_mul_f32 v108, v239, v239
    v_and_b32 v110, 0xffff0000, v238
    v_mul_f32 v106, 0xc0135761, v105
    v_mul_f32 v105, v105, v105
    v_mul_f32 v105, 0x3d372713, v105
    v_mul_f32 v104, v105, v106
    v_rcp_f32 v113, v245
    v_mul_f32 v116, v245, v245
    v_and_b32 v118, 0xffff0000, v244
    v_mul_f32 v114, 0xc0135761, v113
    v_mul_f32 v113, v113, v113
    v_mul_f32 v113, 0x3d372713, v113
    v_mul_f32 v112, v113, v114
    v_rcp_f32 v121, v231
    v_mul_f32 v124, v231, v231
    v_and_b32 v126, 0xffff0000, v230
    v_mul_f32 v122, 0xc0135761, v121
    v_mul_f32 v121, v121, v121
    v_mul_f32 v121, 0x3d372713, v121
    v_mul_f32 v120, v121, v122
    v_and_b32 v232, 15, v250
    v_lshlrev_b32 v232, 4, v232
    v_lshrrev_b32 v233, 5, v250
    v_lshl_add_u32 v232, v233, 8, v232
    v_bfe_u32 v233, v250, 4, 1
    v_lshl_add_u32 v232, v233, 10, v232
    v_mov_b32 v255, 0x40000000
    s_lshl_b32 s3, s25, 1
    s_add_u32 s3, s3, s45
    s_mul_i32 s5, s3, 303104
    s_mul_i32 s6, s26, 12
    s_add_u32 s6, s6, s46
    s_add_u32 s3, s6, 0
    s_lshr_b32 s4, s3, 1
    s_lshl_b32 s4, s4, 12
    s_and_b32 s3, s3, 1
    s_lshl_b32 s3, s3, 9
    s_add_u32 s4, s4, s3
    s_add_u32 s41, s4, s5
    s_add_u32 s3, s6, 1
    s_lshr_b32 s4, s3, 1
    s_lshl_b32 s4, s4, 12
    s_and_b32 s3, s3, 1
    s_lshl_b32 s3, s3, 9
    s_add_u32 s4, s4, s3
    s_add_u32 s42, s4, s5
    s_add_u32 s3, s6, 2
    s_lshr_b32 s4, s3, 1
    s_lshl_b32 s4, s4, 12
    s_and_b32 s3, s3, 1
    s_lshl_b32 s3, s3, 9
    s_add_u32 s4, s4, s3
    s_add_u32 s43, s4, s5
    s_cmp_lt_u32 s40, 4
    s_cbranch_scc1 KF_CE1
    s_mul_i32 s48, s40, 20480
    s_sub_u32 s3, s40, 4
    s_mul_i32 s4, s3, 14
    s_cmp_eq_u32 s3, 3
    s_cselect_b32 s4, 41, s4
    s_add_u32 s4, s4, 8
    s_mul_i32 s4, s4, 40960
    s_mul_i32 s3, s29, 5120
    s_add_u32 s4, s4, s3
    s_add_u32 s49, s4, 10485760
    s_add_u32 m0, s48, 0
    s_nop 0
    buffer_load_dwordx4 v251, s[16:19], s49 offen offset:0 sc1 lds
    s_add_u32 m0, s48, 0
    s_nop 0
    buffer_load_dwordx4 v251, s[16:19], s49 offen offset:1024 sc1 lds
    s_add_u32 m0, s48, 0
    s_nop 0
    buffer_load_dwordx4 v251, s[16:19], s49 offen offset:2048 sc1 lds
    s_add_u32 m0, s48, 0
    s_nop 0
    buffer_load_dwordx4 v251, s[16:19], s49 offen offset:3072 sc1 lds
    s_add_u32 m0, s48, 4096
    s_nop 0
    buffer_load_dwordx4 v252, s[16:19], s49 offen sc1 lds
    s_add_u32 s49, s49, 40960
    s_add_u32 m0, s48, 5120
    s_nop 0
    buffer_load_dwordx4 v251, s[16:19], s49 offen offset:0 sc1 lds
    s_add_u32 m0, s48, 5120
    s_nop 0
    buffer_load_dwordx4 v251, s[16:19], s49 offen offset:1024 sc1 lds
    s_add_u32 m0, s48, 5120
    s_nop 0
    buffer_load_dwordx4 v251, s[16:19], s49 offen offset:2048 sc1 lds
    s_add_u32 m0, s48, 5120
    s_nop 0
    buffer_load_dwordx4 v251, s[16:19], s49 offen offset:3072 sc1 lds
    s_add_u32 m0, s48, 9216
    s_nop 0
    buffer_load_dwordx4 v252, s[16:19], s49 offen sc1 lds
    s_add_u32 s49, s49, 40960
KF_CE1:
    v_pk_fma_f32 v[0:1], v[152:153], v[102:103], v[0:1] op_sel_hi:[1,0,1]
    v_pk_fma_f32 v[2:3], v[154:155], v[102:103], v[2:3] op_sel_hi:[1,0,1]
    v_pk_fma_f32 v[24:25], v[152:153], v[110:111], v[24:25] op_sel_hi:[1,0,1]
    v_pk_fma_f32 v[26:27], v[154:155], v[110:111], v[26:27] op_sel_hi:[1,0,1]
    v_pk_fma_f32 v[48:49], v[152:153], v[118:119], v[48:49] op_sel_hi:[1,0,1]
    v_pk_fma_f32 v[50:51], v[154:155], v[118:119], v[50:51] op_sel_hi:[1,0,1]
    v_pk_fma_f32 v[72:73], v[152:153], v[126:127], v[72:73] op_sel_hi:[1,0,1]
    v_pk_fma_f32 v[74:75], v[154:155], v[126:127], v[74:75] op_sel_hi:[1,0,1]
    v_pk_fma_f32 v[4:5], v[156:157], v[102:103], v[4:5] op_sel_hi:[1,0,1]
    v_pk_fma_f32 v[6:7], v[158:159], v[102:103], v[6:7] op_sel_hi:[1,0,1]
    v_pk_fma_f32 v[28:29], v[156:157], v[110:111], v[28:29] op_sel_hi:[1,0,1]
    v_pk_fma_f32 v[30:31], v[158:159], v[110:111], v[30:31] op_sel_hi:[1,0,1]
    v_pk_fma_f32 v[52:53], v[156:157], v[118:119], v[52:53] op_sel_hi:[1,0,1]
    v_pk_fma_f32 v[54:55], v[158:159], v[118:119], v[54:55] op_sel_hi:[1,0,1]
    v_pk_fma_f32 v[76:77], v[156:157], v[126:127], v[76:77] op_sel_hi:[1,0,1]
    v_pk_fma_f32 v[78:79], v[158:159], v[126:127], v[78:79] op_sel_hi:[1,0,1]
    v_pk_fma_f32 v[8:9], v[160:161], v[102:103], v[8:9] op_sel_hi:[1,0,1]
    v_pk_fma_f32 v[10:11], v[162:163], v[102:103], v[10:11] op_sel_hi:[1,0,1]
    v_pk_fma_f32 v[32:33], v[160:161], v[110:111], v[32:33] op_sel_hi:[1,0,1]
    v_pk_fma_f32 v[34:35], v[162:163], v[110:111], v[34:35] op_sel_hi:[1,0,1]
    v_pk_fma_f32 v[56:57], v[160:161], v[118:119], v[56:57] op_sel_hi:[1,0,1]
    v_pk_fma_f32 v[58:59], v[162:163], v[118:119], v[58:59] op_sel_hi:[1,0,1]
    v_pk_fma_f32 v[80:81], v[160:161], v[126:127], v[80:81] op_sel_hi:[1,0,1]
    v_pk_fma_f32 v[82:83], v[162:163], v[126:127], v[82:83] op_sel_hi:[1,0,1]
    v_pk_mul_f32 v[128:129], v[0:1], v[0:1]
    v_pk_mul_f32 v[130:131], v[2:3], v[2:3]
    v_pk_mul_f32 v[132:133], v[24:25], v[24:25]
    v_pk_mul_f32 v[134:135], v[26:27], v[26:27]
    v_pk_fma_f32 v[128:129], v[128:129], v[96:97], v[98:99] op_sel_hi:[1,0,0]
    v_pk_fma_f32 v[130:131], v[130:131], v[96:97], v[98:99] op_sel_hi:[1,0,0]
    v_pk_fma_f32 v[132:133], v[132:133], v[104:105], v[106:107] op_sel_hi:[1,0,0]
    v_pk_fma_f32 v[134:135], v[134:135], v[104:105], v[106:107] op_sel_hi:[1,0,0]
    v_pk_mul_f32 v[128:129], v[128:129], v[0:1]
    v_pk_mul_f32 v[130:131], v[130:131], v[2:3]
    v_pk_mul_f32 v[132:133], v[132:133], v[24:25]
    v_pk_mul_f32 v[134:135], v[134:135], v[26:27]
    buffer_load_dwordx4 v[146:149], v251, s[16:19], s75 offen offset:0 sc1
    v_exp_f32 v128, v128
    v_exp_f32 v129, v129
    v_exp_f32 v130, v130
    v_exp_f32 v131, v131
    v_exp_f32 v132, v132
    v_exp_f32 v133, v133
    v_exp_f32 v134, v134
    v_exp_f32 v135, v135
    v_pk_fma_f32 v[12:13], v[226:227], v[102:103], v[12:13] op_sel_hi:[1,0,1]
    v_pk_fma_f32 v[14:15], v[228:229], v[102:103], v[14:15] op_sel_hi:[1,0,1]
    v_pk_fma_f32 v[36:37], v[226:227], v[110:111], v[36:37] op_sel_hi:[1,0,1]
    v_pk_fma_f32 v[38:39], v[228:229], v[110:111], v[38:39] op_sel_hi:[1,0,1]
    buffer_load_dwordx4 v[150:153], v251, s[16:19], s75 offen offset:1024 sc1
    v_pk_fma_f32 v[128:129], v[128:129], v[100:101], v[100:101] op_sel_hi:[1,0,0]
    v_pk_fma_f32 v[130:131], v[130:131], v[100:101], v[100:101] op_sel_hi:[1,0,0]
    v_pk_fma_f32 v[132:133], v[132:133], v[108:109], v[108:109] op_sel_hi:[1,0,0]
    v_pk_fma_f32 v[134:135], v[134:135], v[108:109], v[108:109] op_sel_hi:[1,0,0]
    v_pk_mul_f32 v[0:1], v[0:1], v[12:13]
    v_pk_mul_f32 v[2:3], v[2:3], v[14:15]
    v_pk_mul_f32 v[24:25], v[24:25], v[36:37]
    v_pk_mul_f32 v[26:27], v[26:27], v[38:39]
    v_rcp_f32 v128, v128
    v_rcp_f32 v129, v129
    v_rcp_f32 v130, v130
    v_rcp_f32 v131, v131
    buffer_load_dwordx4 v[154:157], v251, s[16:19], s75 offen offset:2048 sc1
    v_rcp_f32 v132, v132
    v_rcp_f32 v133, v133
    v_rcp_f32 v134, v134
    v_rcp_f32 v135, v135
    v_pk_mul_f32 v[0:1], v[0:1], v[128:129]
    v_pk_mul_f32 v[2:3], v[2:3], v[130:131]
    v_pk_mul_f32 v[24:25], v[24:25], v[132:133]
    v_pk_mul_f32 v[26:27], v[26:27], v[134:135]
    v_cvt_pk_bf16_f32 v136, v0, v1
    v_cvt_pk_bf16_f32 v137, v2, v3
    v_cvt_pk_bf16_f32 v138, v24, v25
    v_cvt_pk_bf16_f32 v139, v26, v27
    buffer_load_dwordx4 v[158:161], v251, s[16:19], s75 offen offset:3072 sc1
    v_permlane16_swap_b32 v136, v138
    v_permlane16_swap_b32 v137, v139
    buffer_store_dwordx4 v[136:139], v232, s[16:19], s41 offen offset:0 sc1
    v_pk_mul_f32 v[128:129], v[48:49], v[48:49]
    v_pk_mul_f32 v[130:131], v[50:51], v[50:51]
    v_pk_mul_f32 v[132:133], v[72:73], v[72:73]
    v_pk_mul_f32 v[134:135], v[74:75], v[74:75]
    v_pk_fma_f32 v[128:129], v[128:129], v[112:113], v[114:115] op_sel_hi:[1,0,0]
    v_pk_fma_f32 v[130:131], v[130:131], v[112:113], v[114:115] op_sel_hi:[1,0,0]
    v_pk_fma_f32 v[132:133], v[132:133], v[120:121], v[122:123] op_sel_hi:[1,0,0]
    v_pk_fma_f32 v[134:135], v[134:135], v[120:121], v[122:123] op_sel_hi:[1,0,0]
    v_pk_mul_f32 v[128:129], v[128:129], v[48:49]
    v_pk_mul_f32 v[130:131], v[130:131], v[50:51]
    v_pk_mul_f32 v[132:133], v[132:133], v[72:73]
    v_pk_mul_f32 v[134:135], v[134:135], v[74:75]
    buffer_load_dwordx4 v[162:165], v252, s[16:19], s75 offen sc1
    s_add_u32 s75, s75, 40960
    v_exp_f32 v128, v128
    v_exp_f32 v129, v129
    v_exp_f32 v130, v130
    v_exp_f32 v131, v131
    v_exp_f32 v132, v132
    v_exp_f32 v133, v133
    v_exp_f32 v134, v134
    v_exp_f32 v135, v135
    v_pk_fma_f32 v[60:61], v[226:227], v[118:119], v[60:61] op_sel_hi:[1,0,1]
    v_pk_fma_f32 v[62:63], v[228:229], v[118:119], v[62:63] op_sel_hi:[1,0,1]
    v_pk_fma_f32 v[84:85], v[226:227], v[126:127], v[84:85] op_sel_hi:[1,0,1]
    v_pk_fma_f32 v[86:87], v[228:229], v[126:127], v[86:87] op_sel_hi:[1,0,1]
    v_pk_fma_f32 v[128:129], v[128:129], v[116:117], v[116:117] op_sel_hi:[1,0,0]
    v_pk_fma_f32 v[130:131], v[130:131], v[116:117], v[116:117] op_sel_hi:[1,0,0]
    v_pk_fma_f32 v[132:133], v[132:133], v[124:125], v[124:125] op_sel_hi:[1,0,0]
    v_pk_fma_f32 v[134:135], v[134:135], v[124:125], v[124:125] op_sel_hi:[1,0,0]
    v_pk_mul_f32 v[48:49], v[48:49], v[60:61]
    v_pk_mul_f32 v[50:51], v[50:51], v[62:63]
    v_pk_mul_f32 v[72:73], v[72:73], v[84:85]
    v_pk_mul_f32 v[74:75], v[74:75], v[86:87]
    v_rcp_f32 v128, v128
    v_rcp_f32 v129, v129
    v_rcp_f32 v130, v130
    v_rcp_f32 v131, v131
    v_rcp_f32 v132, v132
    v_rcp_f32 v133, v133
    v_rcp_f32 v134, v134
    v_rcp_f32 v135, v135
    v_pk_mul_f32 v[48:49], v[48:49], v[128:129]
    v_pk_mul_f32 v[50:51], v[50:51], v[130:131]
    v_pk_mul_f32 v[72:73], v[72:73], v[132:133]
    v_pk_mul_f32 v[74:75], v[74:75], v[134:135]
    v_cvt_pk_bf16_f32 v140, v48, v49
    v_cvt_pk_bf16_f32 v141, v50, v51
    v_cvt_pk_bf16_f32 v142, v72, v73
    v_cvt_pk_bf16_f32 v143, v74, v75
    s_nop 0
    v_permlane16_swap_b32 v140, v142
    v_permlane16_swap_b32 v141, v143
    buffer_store_dwordx4 v[140:143], v232, s[16:19], s41 offen offset:2048 sc1
    v_pk_mul_f32 v[128:129], v[4:5], v[4:5]
    v_pk_mul_f32 v[130:131], v[6:7], v[6:7]
    v_pk_mul_f32 v[132:133], v[28:29], v[28:29]
    v_pk_mul_f32 v[134:135], v[30:31], v[30:31]
    v_pk_fma_f32 v[128:129], v[128:129], v[96:97], v[98:99] op_sel_hi:[1,0,0]
    v_pk_fma_f32 v[130:131], v[130:131], v[96:97], v[98:99] op_sel_hi:[1,0,0]
    v_pk_fma_f32 v[132:133], v[132:133], v[104:105], v[106:107] op_sel_hi:[1,0,0]
    v_pk_fma_f32 v[134:135], v[134:135], v[104:105], v[106:107] op_sel_hi:[1,0,0]
    v_pk_mul_f32 v[128:129], v[128:129], v[4:5]
    v_pk_mul_f32 v[130:131], v[130:131], v[6:7]
    v_pk_mul_f32 v[132:133], v[132:133], v[28:29]
    v_pk_mul_f32 v[134:135], v[134:135], v[30:31]
    v_exp_f32 v128, v128
    v_exp_f32 v129, v129
    v_exp_f32 v130, v130
    v_exp_f32 v131, v131
    v_exp_f32 v132, v132
    v_exp_f32 v133, v133
    v_exp_f32 v134, v134
    v_exp_f32 v135, v135
    v_pk_fma_f32 v[16:17], v[246:247], v[102:103], v[16:17] op_sel_hi:[1,0,1]
    v_pk_fma_f32 v[18:19], v[248:249], v[102:103], v[18:19] op_sel_hi:[1,0,1]
    v_pk_fma_f32 v[40:41], v[246:247], v[110:111], v[40:41] op_sel_hi:[1,0,1]
    v_pk_fma_f32 v[42:43], v[248:249], v[110:111], v[42:43] op_sel_hi:[1,0,1]
    v_pk_fma_f32 v[128:129], v[128:129], v[100:101], v[100:101] op_sel_hi:[1,0,0]
    v_pk_fma_f32 v[130:131], v[130:131], v[100:101], v[100:101] op_sel_hi:[1,0,0]
    v_pk_fma_f32 v[132:133], v[132:133], v[108:109], v[108:109] op_sel_hi:[1,0,0]
    v_pk_fma_f32 v[134:135], v[134:135], v[108:109], v[108:109] op_sel_hi:[1,0,0]
    v_pk_mul_f32 v[4:5], v[4:5], v[16:17]
    v_pk_mul_f32 v[6:7], v[6:7], v[18:19]
    v_pk_mul_f32 v[28:29], v[28:29], v[40:41]
    v_pk_mul_f32 v[30:31], v[30:31], v[42:43]
    v_rcp_f32 v128, v128
    v_rcp_f32 v129, v129
    v_rcp_f32 v130, v130
    v_rcp_f32 v131, v131
    v_rcp_f32 v132, v132
    v_rcp_f32 v133, v133
    v_rcp_f32 v134, v134
    v_rcp_f32 v135, v135
    v_pk_mul_f32 v[4:5], v[4:5], v[128:129]
    v_pk_mul_f32 v[6:7], v[6:7], v[130:131]
    v_pk_mul_f32 v[28:29], v[28:29], v[132:133]
    v_pk_mul_f32 v[30:31], v[30:31], v[134:135]
    v_cvt_pk_bf16_f32 v136, v4, v5
    v_cvt_pk_bf16_f32 v137, v6, v7
    v_cvt_pk_bf16_f32 v138, v28, v29
    v_cvt_pk_bf16_f32 v139, v30, v31
    s_nop 0
    v_permlane16_swap_b32 v136, v138
    v_permlane16_swap_b32 v137, v139
    buffer_store_dwordx4 v[136:139], v232, s[16:19], s42 offen offset:0 sc1
    v_pk_mul_f32 v[128:129], v[52:53], v[52:53]
    v_pk_mul_f32 v[130:131], v[54:55], v[54:55]
    v_pk_mul_f32 v[132:133], v[76:77], v[76:77]
    v_pk_mul_f32 v[134:135], v[78:79], v[78:79]
    v_pk_fma_f32 v[128:129], v[128:129], v[112:113], v[114:115] op_sel_hi:[1,0,0]
    v_pk_fma_f32 v[130:131], v[130:131], v[112:113], v[114:115] op_sel_hi:[1,0,0]
    v_pk_fma_f32 v[132:133], v[132:133], v[120:121], v[122:123] op_sel_hi:[1,0,0]
    v_pk_fma_f32 v[134:135], v[134:135], v[120:121], v[122:123] op_sel_hi:[1,0,0]
    v_pk_mul_f32 v[128:129], v[128:129], v[52:53]
    v_pk_mul_f32 v[130:131], v[130:131], v[54:55]
    v_pk_mul_f32 v[132:133], v[132:133], v[76:77]
    v_pk_mul_f32 v[134:135], v[134:135], v[78:79]
    v_exp_f32 v128, v128
    v_exp_f32 v129, v129
    v_exp_f32 v130, v130
    v_exp_f32 v131, v131
    v_exp_f32 v132, v132
    v_exp_f32 v133, v133
    v_exp_f32 v134, v134
    v_exp_f32 v135, v135
    v_pk_fma_f32 v[64:65], v[246:247], v[118:119], v[64:65] op_sel_hi:[1,0,1]
    v_pk_fma_f32 v[66:67], v[248:249], v[118:119], v[66:67] op_sel_hi:[1,0,1]
    v_pk_fma_f32 v[88:89], v[246:247], v[126:127], v[88:89] op_sel_hi:[1,0,1]
    v_pk_fma_f32 v[90:91], v[248:249], v[126:127], v[90:91] op_sel_hi:[1,0,1]
    v_pk_fma_f32 v[128:129], v[128:129], v[116:117], v[116:117] op_sel_hi:[1,0,0]
    v_pk_fma_f32 v[130:131], v[130:131], v[116:117], v[116:117] op_sel_hi:[1,0,0]
    v_pk_fma_f32 v[132:133], v[132:133], v[124:125], v[124:125] op_sel_hi:[1,0,0]
    v_pk_fma_f32 v[134:135], v[134:135], v[124:125], v[124:125] op_sel_hi:[1,0,0]
    v_pk_mul_f32 v[52:53], v[52:53], v[64:65]
    v_pk_mul_f32 v[54:55], v[54:55], v[66:67]
    v_pk_mul_f32 v[76:77], v[76:77], v[88:89]
    v_pk_mul_f32 v[78:79], v[78:79], v[90:91]
    v_rcp_f32 v128, v128
    v_rcp_f32 v129, v129
    v_rcp_f32 v130, v130
    v_rcp_f32 v131, v131
    v_rcp_f32 v132, v132
    v_rcp_f32 v133, v133
    v_rcp_f32 v134, v134
    v_rcp_f32 v135, v135
    v_pk_mul_f32 v[52:53], v[52:53], v[128:129]
    v_pk_mul_f32 v[54:55], v[54:55], v[130:131]
    v_pk_mul_f32 v[76:77], v[76:77], v[132:133]
    v_pk_mul_f32 v[78:79], v[78:79], v[134:135]
    v_cvt_pk_bf16_f32 v140, v52, v53
    v_cvt_pk_bf16_f32 v141, v54, v55
    v_cvt_pk_bf16_f32 v142, v76, v77
    v_cvt_pk_bf16_f32 v143, v78, v79
    s_nop 0
    v_permlane16_swap_b32 v140, v142
    v_permlane16_swap_b32 v141, v143
    buffer_store_dwordx4 v[140:143], v232, s[16:19], s42 offen offset:2048 sc1
    v_pk_mul_f32 v[128:129], v[8:9], v[8:9]
    v_pk_mul_f32 v[130:131], v[10:11], v[10:11]
    v_pk_mul_f32 v[132:133], v[32:33], v[32:33]
    v_pk_mul_f32 v[134:135], v[34:35], v[34:35]
    v_pk_fma_f32 v[128:129], v[128:129], v[96:97], v[98:99] op_sel_hi:[1,0,0]
    v_pk_fma_f32 v[130:131], v[130:131], v[96:97], v[98:99] op_sel_hi:[1,0,0]
    v_pk_fma_f32 v[132:133], v[132:133], v[104:105], v[106:107] op_sel_hi:[1,0,0]
    v_pk_fma_f32 v[134:135], v[134:135], v[104:105], v[106:107] op_sel_hi:[1,0,0]
    v_pk_mul_f32 v[128:129], v[128:129], v[8:9]
    v_pk_mul_f32 v[130:131], v[130:131], v[10:11]
    v_pk_mul_f32 v[132:133], v[132:133], v[32:33]
    v_pk_mul_f32 v[134:135], v[134:135], v[34:35]
    v_exp_f32 v128, v128
    v_exp_f32 v129, v129
    v_exp_f32 v130, v130
    v_exp_f32 v131, v131
    v_exp_f32 v132, v132
    v_exp_f32 v133, v133
    v_exp_f32 v134, v134
    v_exp_f32 v135, v135
    v_pk_fma_f32 v[20:21], v[240:241], v[102:103], v[20:21] op_sel_hi:[1,0,1]
    v_pk_fma_f32 v[22:23], v[242:243], v[102:103], v[22:23] op_sel_hi:[1,0,1]
    v_pk_fma_f32 v[44:45], v[240:241], v[110:111], v[44:45] op_sel_hi:[1,0,1]
    v_pk_fma_f32 v[46:47], v[242:243], v[110:111], v[46:47] op_sel_hi:[1,0,1]
    v_pk_fma_f32 v[128:129], v[128:129], v[100:101], v[100:101] op_sel_hi:[1,0,0]
    v_pk_fma_f32 v[130:131], v[130:131], v[100:101], v[100:101] op_sel_hi:[1,0,0]
    v_pk_fma_f32 v[132:133], v[132:133], v[108:109], v[108:109] op_sel_hi:[1,0,0]
    v_pk_fma_f32 v[134:135], v[134:135], v[108:109], v[108:109] op_sel_hi:[1,0,0]
    v_pk_mul_f32 v[8:9], v[8:9], v[20:21]
    v_pk_mul_f32 v[10:11], v[10:11], v[22:23]
    v_pk_mul_f32 v[32:33], v[32:33], v[44:45]
    v_pk_mul_f32 v[34:35], v[34:35], v[46:47]
    v_rcp_f32 v128, v128
    v_rcp_f32 v129, v129
    v_rcp_f32 v130, v130
    v_rcp_f32 v131, v131
    v_rcp_f32 v132, v132
    v_rcp_f32 v133, v133
    v_rcp_f32 v134, v134
    v_rcp_f32 v135, v135
    v_pk_mul_f32 v[8:9], v[8:9], v[128:129]
    v_pk_mul_f32 v[10:11], v[10:11], v[130:131]
    v_pk_mul_f32 v[32:33], v[32:33], v[132:133]
    v_pk_mul_f32 v[34:35], v[34:35], v[134:135]
    v_cvt_pk_bf16_f32 v136, v8, v9
    v_cvt_pk_bf16_f32 v137, v10, v11
    v_cvt_pk_bf16_f32 v138, v32, v33
    v_cvt_pk_bf16_f32 v139, v34, v35
    s_nop 0
    v_permlane16_swap_b32 v136, v138
    v_permlane16_swap_b32 v137, v139
    buffer_store_dwordx4 v[136:139], v232, s[16:19], s43 offen offset:0 sc1
    v_pk_mul_f32 v[128:129], v[56:57], v[56:57]
    v_pk_mul_f32 v[130:131], v[58:59], v[58:59]
    v_pk_mul_f32 v[132:133], v[80:81], v[80:81]
    v_pk_mul_f32 v[134:135], v[82:83], v[82:83]
    v_pk_fma_f32 v[128:129], v[128:129], v[112:113], v[114:115] op_sel_hi:[1,0,0]
    v_pk_fma_f32 v[130:131], v[130:131], v[112:113], v[114:115] op_sel_hi:[1,0,0]
    v_pk_fma_f32 v[132:133], v[132:133], v[120:121], v[122:123] op_sel_hi:[1,0,0]
    v_pk_fma_f32 v[134:135], v[134:135], v[120:121], v[122:123] op_sel_hi:[1,0,0]
    v_pk_mul_f32 v[128:129], v[128:129], v[56:57]
    v_pk_mul_f32 v[130:131], v[130:131], v[58:59]
    v_pk_mul_f32 v[132:133], v[132:133], v[80:81]
    v_pk_mul_f32 v[134:135], v[134:135], v[82:83]
    v_exp_f32 v128, v128
    v_exp_f32 v129, v129
    v_exp_f32 v130, v130
    v_exp_f32 v131, v131
    v_exp_f32 v132, v132
    v_exp_f32 v133, v133
    v_exp_f32 v134, v134
    v_exp_f32 v135, v135
    v_pk_fma_f32 v[68:69], v[240:241], v[118:119], v[68:69] op_sel_hi:[1,0,1]
    v_pk_fma_f32 v[70:71], v[242:243], v[118:119], v[70:71] op_sel_hi:[1,0,1]
    v_pk_fma_f32 v[92:93], v[240:241], v[126:127], v[92:93] op_sel_hi:[1,0,1]
    v_pk_fma_f32 v[94:95], v[242:243], v[126:127], v[94:95] op_sel_hi:[1,0,1]
    v_pk_fma_f32 v[128:129], v[128:129], v[116:117], v[116:117] op_sel_hi:[1,0,0]
    v_pk_fma_f32 v[130:131], v[130:131], v[116:117], v[116:117] op_sel_hi:[1,0,0]
    v_pk_fma_f32 v[132:133], v[132:133], v[124:125], v[124:125] op_sel_hi:[1,0,0]
    v_pk_fma_f32 v[134:135], v[134:135], v[124:125], v[124:125] op_sel_hi:[1,0,0]
    v_pk_mul_f32 v[56:57], v[56:57], v[68:69]
    v_pk_mul_f32 v[58:59], v[58:59], v[70:71]
    v_pk_mul_f32 v[80:81], v[80:81], v[92:93]
    v_pk_mul_f32 v[82:83], v[82:83], v[94:95]
    v_rcp_f32 v128, v128
    v_rcp_f32 v129, v129
    v_rcp_f32 v130, v130
    v_rcp_f32 v131, v131
    v_rcp_f32 v132, v132
    v_rcp_f32 v133, v133
    v_rcp_f32 v134, v134
    v_rcp_f32 v135, v135
    v_pk_mul_f32 v[56:57], v[56:57], v[128:129]
    v_pk_mul_f32 v[58:59], v[58:59], v[130:131]
    v_pk_mul_f32 v[80:81], v[80:81], v[132:133]
    v_pk_mul_f32 v[82:83], v[82:83], v[134:135]
    v_cvt_pk_bf16_f32 v140, v56, v57
    v_cvt_pk_bf16_f32 v141, v58, v59
    v_cvt_pk_bf16_f32 v142, v80, v81
    v_cvt_pk_bf16_f32 v143, v82, v83
    s_nop 0
    v_permlane16_swap_b32 v140, v142
    v_permlane16_swap_b32 v141, v143
    buffer_store_dwordx4 v[140:143], v232, s[16:19], s43 offen offset:2048 sc1
    s_branch KF_PUB
KF_QKV:
    s_mov_b32 s3, s45
    s_mov_b32 s45, s51
    s_mov_b32 s51, s3
    s_lshl_b32 s74, s45, 5
    s_mul_i32 s46, s51, 5
    v_and_b32 v10, 1, v250
    v_bfe_u32 v11, v250, 1, 1
    v_bfe_u32 v12, v250, 4, 1
    v_lshl_add_u32 v11, v12, 1, v11
    v_lshlrev_b32 v11, 3, v11
    v_bfe_u32 v1, v250, 2, 2
    v_lshrrev_b32 v9, 5, v250
    v_lshl_add_u32 v2, v9, 3, v1
    v_lshl_add_u32 v11, v2, 7, v11
    v_mul_u32_u24 v2, 12288, v10
    v_add_u32 v11, v2, v11
    v_lshrrev_b32 v1, 1, v1
    v_lshlrev_b32 v2, 1, v10
    v_xor_b32 v1, v1, v2
    s_add_u32 s3, s46, 0
    s_and_b32 s4, s3, 3
    s_lshr_b32 s3, s3, 2
    s_lshl_b32 s3, s3, 12
    v_xor_b32 v2, s4, v1
    v_lshl_add_u32 v2, v2, 5, v11
    v_add_u32 v226, s3, v2
    v_add_u32 v231, 49152, v226
    s_add_u32 s3, s46, 1
    s_and_b32 s4, s3, 3
    s_lshr_b32 s3, s3, 2
    s_lshl_b32 s3, s3, 12
    v_xor_b32 v2, s4, v1
    v_lshl_add_u32 v2, v2, 5, v11
    v_add_u32 v227, s3, v2
    v_add_u32 v232, 49152, v227
    s_add_u32 s3, s46, 2
    s_and_b32 s4, s3, 3
    s_lshr_b32 s3, s3, 2
    s_lshl_b32 s3, s3, 12
    v_xor_b32 v2, s4, v1
    v_lshl_add_u32 v2, v2, 5, v11
    v_add_u32 v228, s3, v2
    v_add_u32 v233, 49152, v228
    s_add_u32 s3, s46, 3
    s_and_b32 s4, s3, 3
    s_lshr_b32 s3, s3, 2
    s_lshl_b32 s3, s3, 12
    v_xor_b32 v2, s4, v1
    v_lshl_add_u32 v2, v2, 5, v11
    v_add_u32 v229, s3, v2
    v_add_u32 v234, 49152, v229
    s_add_u32 s3, s46, 4
    s_and_b32 s4, s3, 3
    s_lshr_b32 s3, s3, 2
    s_lshl_b32 s3, s3, 12
    v_xor_b32 v2, s4, v1
    v_lshl_add_u32 v2, v2, 5, v11
    v_add_u32 v230, s3, v2
    v_add_u32 v235, 49152, v230
    v_and_b32 v1, 31, v250
    v_bfe_u32 v3, v250, 1, 3
    v_xor_b32 v3, v9, v3
    v_lshlrev_b32 v3, 4, v3
    v_add_u32 v1, s74, v1
    v_lshl_add_u32 v3, v1, 7, v3
    v_add_u32 v236, 98304, v3
    s_and_b32 s3, s27, 1
    s_lshl_b32 s3, s3, 6
    v_xor_b32 v236, s3, v236
    v_xor_b32 v237, 32, v236
    v_xor_b32 v238, 64, v236
    v_xor_b32 v239, 96, v236
    s_add_u32 s47, s47, 1
    s_xor_b32 s41, s47, s55
    s_mul_i32 s41, s41, 122880
    s_mov_b32 s16, s72
    s_mov_b32 s17, s73
    s_mov_b32 s18, 20971520
    s_mov_b32 s19, 0x00020000
    s_mov_b32 s20, s70
    s_mov_b32 s21, s71
    s_mov_b32 s22, 256
    s_mov_b32 s23, 0x00020000
    s_mov_b32 s32, s56
    s_mov_b32 s33, s57
    s_mov_b32 s34, 25600
    s_mov_b32 s35, 0x00020000
    s_lshr_b32 s52, s31, 8
    s_and_b32 s31, s31, 0xff
    s_lshr_b32 s0, s29, 8
    s_and_b32 s29, s29, 0xff
    s_mov_b32 s36, s58
    s_mov_b32 s37, s59
    s_mov_b32 s38, 819200
    s_mov_b32 s39, 0x00020000
    s_mov_b32 s50, 512
    s_cmp_lt_u32 s40, 4
    s_cselect_b32 s50, 32, s50
    s_cmp_eq_u32 s40, 0
    s_cselect_b32 s3, 9216, 0
    s_or_b32 s50, s50, s3
    s_sub_u32 s3, s40, 1
    s_cselect_b32 s3, 1023, s3
    s_add_u32 s3, s3, s52
    s_cmp_lt_u32 s3, 200
    s_cselect_b32 s3, 3456, 0
    s_or_b32 s50, s50, s3
    v_and_b32 v86, 7, v250
    v_add_u32 v245, 9, v86
    v_cmp_ne_u32 vcc, 0, v86
    s_nop 1
    v_cndmask_b32 v245, 0, v245, vcc
    v_lshlrev_b32 v245, 7, v245
    s_add_u32 m0, s48, 49152
    s_nop 0
    buffer_load_dwordx4 v240, s[12:15], s41 offen lds
    s_add_u32 m0, s48, 53248
    s_nop 0
    buffer_load_dwordx4 v241, s[12:15], s41 offen lds
    s_add_u32 m0, s48, 57344
    s_nop 0
    buffer_load_dwordx4 v242, s[12:15], s41 offen lds
    s_add_u32 s47, s47, 1
    s_xor_b32 s41, s47, s55
    s_mul_i32 s41, s41, 122880
    s_waitcnt vmcnt(6)
    s_barrier
    ds_read_b128 v[98:101], v236 offset:0
    ds_read_b64_tr_b16 v[102:103], v226 offset:0
    ds_read_b64_tr_b16 v[104:105], v226 offset:512
    ds_read_b64_tr_b16 v[106:107], v227 offset:0
    ds_read_b64_tr_b16 v[108:109], v227 offset:512
    ds_read_b64_tr_b16 v[110:111], v228 offset:0
    ds_read_b64_tr_b16 v[112:113], v228 offset:512
    ds_read_b64_tr_b16 v[114:115], v229 offset:0
    ds_read_b64_tr_b16 v[116:117], v229 offset:512
    ds_read_b64_tr_b16 v[118:119], v230 offset:0
    ds_read_b64_tr_b16 v[120:121], v230 offset:512
    s_bfe_u32 s3, s27, 0x80010
    s_lshl_b32 s3, s3, 3
    s_lshl_b32 s5, s25, 7
    s_add_u32 s5, s5, s3
    s_add_u32 s44, s5, s40
    s_mul_i32 s3, s44, 1280
    buffer_load_dwordx4 v[166:169], v251, s[8:11], s3 offen
    buffer_load_dword v170, v177, s[8:11], s3 offen offset:1024
    s_add_u32 m0, s49, 16384
    s_nop 0
    buffer_load_dwordx4 v243, s[8:11], s42 offen lds
    s_add_u32 m0, s49, 17408
    s_nop 0
    buffer_load_dwordx4 v244, s[8:11], s42 offen lds
    s_add_u32 s54, s54, 128
    s_xor_b32 s42, s54, s43
    s_waitcnt lgkmcnt(0)
    s_add_u32 m0, s48, 73728
    v_mfma_f32_32x32x16_bf16 v[0:15], v[102:105], v[98:101], 0
    buffer_load_dwordx4 v240, s[12:15], s41 offen lds
    ds_read_b128 v[122:125], v237 offset:0
    ds_read_b64_tr_b16 v[126:127], v226 offset:2048
    ds_read_b64_tr_b16 v[128:129], v226 offset:2560
    v_mfma_f32_32x32x16_bf16 v[16:31], v[106:109], v[98:101], 0
    ds_read_b64_tr_b16 v[130:131], v227 offset:2048
    ds_read_b64_tr_b16 v[132:133], v227 offset:2560
    ds_read_b64_tr_b16 v[134:135], v228 offset:2048
    s_add_u32 m0, s48, 77824
    v_mfma_f32_32x32x16_bf16 v[32:47], v[110:113], v[98:101], 0
    buffer_load_dwordx4 v241, s[12:15], s41 offen lds
    ds_read_b64_tr_b16 v[136:137], v228 offset:2560
    ds_read_b64_tr_b16 v[138:139], v229 offset:2048
    ds_read_b64_tr_b16 v[140:141], v229 offset:2560
    s_add_u32 m0, s48, 81920
    v_mfma_f32_32x32x16_bf16 v[48:63], v[114:117], v[98:101], 0
    buffer_load_dwordx4 v242, s[12:15], s41 offen lds
    s_add_u32 s47, s47, 1
    s_xor_b32 s41, s47, s55
    s_mul_i32 s41, s41, 122880
    ds_read_b64_tr_b16 v[142:143], v230 offset:2048
    ds_read_b64_tr_b16 v[144:145], v230 offset:2560
    v_mfma_f32_32x32x16_bf16 v[64:79], v[118:121], v[98:101], 0
    s_branch KFQ_ENTRY
KFQ_LOOP:
    v_mfma_f32_32x32x16_bf16 v[64:79], v[118:121], v[98:101], v[64:79]
    s_waitcnt vmcnt(6) lgkmcnt(0)
    s_barrier
    v_mfma_f32_32x32x16_bf16 v[0:15], v[126:129], v[122:125], v[0:15]
    s_bitcmp1_b32 s50, s47
    s_cbranch_scc1 KFQ_HT0
KFQ_HR0:
    ds_read_b128 v[98:101], v236 offset:0
    ds_read_b64_tr_b16 v[102:103], v226 offset:0
    ds_read_b64_tr_b16 v[104:105], v226 offset:512
    s_add_u32 m0, s49, 16384
    v_mfma_f32_32x32x16_bf16 v[16:31], v[130:133], v[122:125], v[16:31]
    buffer_load_dwordx4 v243, s[8:11], s42 offen lds
    ds_read_b64_tr_b16 v[106:107], v227 offset:0
    ds_read_b64_tr_b16 v[108:109], v227 offset:512
    ds_read_b64_tr_b16 v[110:111], v228 offset:0
    v_mfma_f32_32x32x16_bf16 v[32:47], v[134:137], v[122:125], v[32:47]
    ds_read_b64_tr_b16 v[112:113], v228 offset:512
    ds_read_b64_tr_b16 v[114:115], v229 offset:0
    ds_read_b64_tr_b16 v[116:117], v229 offset:512
    s_add_u32 m0, s49, 17408
    v_mfma_f32_32x32x16_bf16 v[48:63], v[138:141], v[122:125], v[48:63]
    buffer_load_dwordx4 v244, s[8:11], s42 offen lds
    s_add_u32 s54, s54, 128
    s_xor_b32 s42, s54, s43
    ds_read_b64_tr_b16 v[118:119], v230 offset:0
    ds_read_b64_tr_b16 v[120:121], v230 offset:512
    v_mfma_f32_32x32x16_bf16 v[64:79], v[142:145], v[122:125], v[64:79]
    s_waitcnt lgkmcnt(0)
    s_add_u32 m0, s48, 73728
    v_mfma_f32_32x32x16_bf16 v[0:15], v[102:105], v[98:101], v[0:15]
    buffer_load_dwordx4 v240, s[12:15], s41 offen lds
    ds_read_b128 v[122:125], v237 offset:0
    ds_read_b64_tr_b16 v[126:127], v226 offset:2048
    ds_read_b64_tr_b16 v[128:129], v226 offset:2560
    v_mfma_f32_32x32x16_bf16 v[16:31], v[106:109], v[98:101], v[16:31]
    ds_read_b64_tr_b16 v[130:131], v227 offset:2048
    ds_read_b64_tr_b16 v[132:133], v227 offset:2560
    ds_read_b64_tr_b16 v[134:135], v228 offset:2048
    s_add_u32 m0, s48, 77824
    v_mfma_f32_32x32x16_bf16 v[32:47], v[110:113], v[98:101], v[32:47]
    buffer_load_dwordx4 v241, s[12:15], s41 offen lds
    ds_read_b64_tr_b16 v[136:137], v228 offset:2560
    ds_read_b64_tr_b16 v[138:139], v229 offset:2048
    ds_read_b64_tr_b16 v[140:141], v229 offset:2560
    s_add_u32 m0, s48, 81920
    v_mfma_f32_32x32x16_bf16 v[48:63], v[114:117], v[98:101], v[48:63]
    buffer_load_dwordx4 v242, s[12:15], s41 offen lds
    s_add_u32 s47, s47, 1
    s_xor_b32 s41, s47, s55
    s_mul_i32 s41, s41, 122880
    ds_read_b64_tr_b16 v[142:143], v230 offset:2048
    ds_read_b64_tr_b16 v[144:145], v230 offset:2560
    v_mfma_f32_32x32x16_bf16 v[64:79], v[118:121], v[98:101], v[64:79]
KFQ_ENTRY:
    s_waitcnt vmcnt(8) lgkmcnt(0)
    s_barrier
    v_mfma_f32_32x32x16_bf16 v[0:15], v[126:129], v[122:125], v[0:15]
    s_bitcmp1_b32 s50, s47
    s_cbranch_scc1 KFQ_HT1
KFQ_HR1:
    ds_read_b128 v[98:101], v238 offset:0
    ds_read_b64_tr_b16 v[102:103], v226 offset:24576
    ds_read_b64_tr_b16 v[104:105], v226 offset:25088
    v_mfma_f32_32x32x16_bf16 v[16:31], v[130:133], v[122:125], v[16:31]
    ds_read_b64_tr_b16 v[106:107], v227 offset:24576
    ds_read_b64_tr_b16 v[108:109], v227 offset:25088
    ds_read_b64_tr_b16 v[110:111], v228 offset:24576
    v_mfma_f32_32x32x16_bf16 v[32:47], v[134:137], v[122:125], v[32:47]
    ds_read_b64_tr_b16 v[112:113], v228 offset:25088
    ds_read_b64_tr_b16 v[114:115], v229 offset:24576
    ds_read_b64_tr_b16 v[116:117], v229 offset:25088
    s_add_u32 m0, s48, 0
    v_mfma_f32_32x32x16_bf16 v[48:63], v[138:141], v[122:125], v[48:63]
    buffer_load_dwordx4 v240, s[12:15], s41 offen lds
    ds_read_b64_tr_b16 v[118:119], v230 offset:24576
    ds_read_b64_tr_b16 v[120:121], v230 offset:25088
    v_mfma_f32_32x32x16_bf16 v[64:79], v[142:145], v[122:125], v[64:79]
    s_waitcnt lgkmcnt(0)
    v_mfma_f32_32x32x16_bf16 v[0:15], v[102:105], v[98:101], v[0:15]
    ds_read_b128 v[122:125], v239 offset:0
    ds_read_b64_tr_b16 v[126:127], v226 offset:26624
    ds_read_b64_tr_b16 v[128:129], v226 offset:27136
    s_add_u32 m0, s48, 4096
    v_mfma_f32_32x32x16_bf16 v[16:31], v[106:109], v[98:101], v[16:31]
    buffer_load_dwordx4 v241, s[12:15], s41 offen lds
    ds_read_b64_tr_b16 v[130:131], v227 offset:26624
    ds_read_b64_tr_b16 v[132:133], v227 offset:27136
    ds_read_b64_tr_b16 v[134:135], v228 offset:26624
    v_mfma_f32_32x32x16_bf16 v[32:47], v[110:113], v[98:101], v[32:47]
    ds_read_b64_tr_b16 v[136:137], v228 offset:27136
    ds_read_b64_tr_b16 v[138:139], v229 offset:26624
    ds_read_b64_tr_b16 v[140:141], v229 offset:27136
    s_add_u32 m0, s48, 8192
    v_mfma_f32_32x32x16_bf16 v[48:63], v[114:117], v[98:101], v[48:63]
    buffer_load_dwordx4 v242, s[12:15], s41 offen lds
    s_add_u32 s47, s47, 1
    s_xor_b32 s41, s47, s55
    s_mul_i32 s41, s41, 122880
    ds_read_b64_tr_b16 v[142:143], v230 offset:26624
    ds_read_b64_tr_b16 v[144:145], v230 offset:27136
    v_mfma_f32_32x32x16_bf16 v[64:79], v[118:121], v[98:101], v[64:79]
    s_waitcnt vmcnt(6) lgkmcnt(0)
    s_barrier
    v_mfma_f32_32x32x16_bf16 v[0:15], v[126:129], v[122:125], v[0:15]
    s_bitcmp1_b32 s50, s47
    s_cbranch_scc1 KFQ_HT2
KFQ_HR2:
    ds_read_b128 v[98:101], v236 offset:16384
    ds_read_b64_tr_b16 v[102:103], v231 offset:0
    ds_read_b64_tr_b16 v[104:105], v231 offset:512
    s_add_u32 m0, s49, 0
    v_mfma_f32_32x32x16_bf16 v[16:31], v[130:133], v[122:125], v[16:31]
    buffer_load_dwordx4 v243, s[8:11], s42 offen lds
    ds_read_b64_tr_b16 v[106:107], v232 offset:0
    ds_read_b64_tr_b16 v[108:109], v232 offset:512
    ds_read_b64_tr_b16 v[110:111], v233 offset:0
    v_mfma_f32_32x32x16_bf16 v[32:47], v[134:137], v[122:125], v[32:47]
    ds_read_b64_tr_b16 v[112:113], v233 offset:512
    ds_read_b64_tr_b16 v[114:115], v234 offset:0
    ds_read_b64_tr_b16 v[116:117], v234 offset:512
    s_add_u32 m0, s49, 1024
    v_mfma_f32_32x32x16_bf16 v[48:63], v[138:141], v[122:125], v[48:63]
    buffer_load_dwordx4 v244, s[8:11], s42 offen lds
    s_add_u32 s54, s54, 128
    s_xor_b32 s42, s54, s43
    ds_read_b64_tr_b16 v[118:119], v235 offset:0
    ds_read_b64_tr_b16 v[120:121], v235 offset:512
    v_mfma_f32_32x32x16_bf16 v[64:79], v[142:145], v[122:125], v[64:79]
    s_waitcnt lgkmcnt(0)
    s_add_u32 m0, s48, 24576
    v_mfma_f32_32x32x16_bf16 v[0:15], v[102:105], v[98:101], v[0:15]
    buffer_load_dwordx4 v240, s[12:15], s41 offen lds
    ds_read_b128 v[122:125], v237 offset:16384
    ds_read_b64_tr_b16 v[126:127], v231 offset:2048
    ds_read_b64_tr_b16 v[128:129], v231 offset:2560
    v_mfma_f32_32x32x16_bf16 v[16:31], v[106:109], v[98:101], v[16:31]
    ds_read_b64_tr_b16 v[130:131], v232 offset:2048
    ds_read_b64_tr_b16 v[132:133], v232 offset:2560
    ds_read_b64_tr_b16 v[134:135], v233 offset:2048
    s_add_u32 m0, s48, 28672
    v_mfma_f32_32x32x16_bf16 v[32:47], v[110:113], v[98:101], v[32:47]
    buffer_load_dwordx4 v241, s[12:15], s41 offen lds
    ds_read_b64_tr_b16 v[136:137], v233 offset:2560
    ds_read_b64_tr_b16 v[138:139], v234 offset:2048
    ds_read_b64_tr_b16 v[140:141], v234 offset:2560
    s_add_u32 m0, s48, 32768
    v_mfma_f32_32x32x16_bf16 v[48:63], v[114:117], v[98:101], v[48:63]
    buffer_load_dwordx4 v242, s[12:15], s41 offen lds
    s_add_u32 s47, s47, 1
    s_xor_b32 s41, s47, s55
    s_mul_i32 s41, s41, 122880
    ds_read_b64_tr_b16 v[142:143], v235 offset:2048
    ds_read_b64_tr_b16 v[144:145], v235 offset:2560
    v_mfma_f32_32x32x16_bf16 v[64:79], v[118:121], v[98:101], v[64:79]
    s_waitcnt vmcnt(8) lgkmcnt(0)
    s_barrier
    v_mfma_f32_32x32x16_bf16 v[0:15], v[126:129], v[122:125], v[0:15]
    s_bitcmp1_b32 s50, s47
    s_cbranch_scc1 KFQ_HT3
KFQ_HR3:
    ds_read_b128 v[98:101], v238 offset:16384
    ds_read_b64_tr_b16 v[102:103], v231 offset:24576
    ds_read_b64_tr_b16 v[104:105], v231 offset:25088
    v_mfma_f32_32x32x16_bf16 v[16:31], v[130:133], v[122:125], v[16:31]
    ds_read_b64_tr_b16 v[106:107], v232 offset:24576
    ds_read_b64_tr_b16 v[108:109], v232 offset:25088
    ds_read_b64_tr_b16 v[110:111], v233 offset:24576
    v_mfma_f32_32x32x16_bf16 v[32:47], v[134:137], v[122:125], v[32:47]
    ds_read_b64_tr_b16 v[112:113], v233 offset:25088
    ds_read_b64_tr_b16 v[114:115], v234 offset:24576
    ds_read_b64_tr_b16 v[116:117], v234 offset:25088
    s_add_u32 m0, s48, 49152
    v_mfma_f32_32x32x16_bf16 v[48:63], v[138:141], v[122:125], v[48:63]
    buffer_load_dwordx4 v240, s[12:15], s41 offen lds
    ds_read_b64_tr_b16 v[118:119], v235 offset:24576
    ds_read_b64_tr_b16 v[120:121], v235 offset:25088
    v_mfma_f32_32x32x16_bf16 v[64:79], v[142:145], v[122:125], v[64:79]
    s_waitcnt lgkmcnt(0)
    v_mfma_f32_32x32x16_bf16 v[0:15], v[102:105], v[98:101], v[0:15]
    ds_read_b128 v[122:125], v239 offset:16384
    ds_read_b64_tr_b16 v[126:127], v231 offset:26624
    ds_read_b64_tr_b16 v[128:129], v231 offset:27136
    s_add_u32 m0, s48, 53248
    v_mfma_f32_32x32x16_bf16 v[16:31], v[106:109], v[98:101], v[16:31]
    buffer_load_dwordx4 v241, s[12:15], s41 offen lds
    ds_read_b64_tr_b16 v[130:131], v232 offset:26624
    ds_read_b64_tr_b16 v[132:133], v232 offset:27136
    ds_read_b64_tr_b16 v[134:135], v233 offset:26624
    v_mfma_f32_32x32x16_bf16 v[32:47], v[110:113], v[98:101], v[32:47]
    ds_read_b64_tr_b16 v[136:137], v233 offset:27136
    ds_read_b64_tr_b16 v[138:139], v234 offset:26624
    ds_read_b64_tr_b16 v[140:141], v234 offset:27136
    s_add_u32 m0, s48, 57344
    v_mfma_f32_32x32x16_bf16 v[48:63], v[114:117], v[98:101], v[48:63]
    buffer_load_dwordx4 v242, s[12:15], s41 offen lds
    s_add_u32 s47, s47, 1
    s_xor_b32 s41, s47, s55
    s_mul_i32 s41, s41, 122880
    ds_read_b64_tr_b16 v[142:143], v235 offset:26624
    ds_read_b64_tr_b16 v[144:145], v235 offset:27136
    s_cmp_lg_u32 s47, 19
    s_cbranch_scc1 KFQ_LOOP
    v_mfma_f32_32x32x16_bf16 v[64:79], v[118:121], v[98:101], v[64:79]
    s_waitcnt vmcnt(6) lgkmcnt(0)
    s_barrier
    v_mfma_f32_32x32x16_bf16 v[0:15], v[126:129], v[122:125], v[0:15]
    v_readfirstlane_b32 s65, v253
    s_mov_b32 s44, 20119552
    s_nop 2
    s_cmp_eq_u32 s65, 0
    s_cbranch_scc1 KFQ_TK
KFQ_TKR:
    v_mov_b32 v253, 0
    buffer_load_dword v253, v254, s[16:19], s44 offen sc1
    ds_read_b128 v[98:101], v236 offset:0
    ds_read_b64_tr_b16 v[102:103], v226 offset:0
    ds_read_b64_tr_b16 v[104:105], v226 offset:512
    s_mul_i32 s3, s40, 14
    s_cmp_eq_u32 s40, 3
    s_cselect_b32 s3, 41, s3
    s_mul_i32 s4, s40, 5
    s_add_u32 s4, s4, 34
    s_cmp_ge_u32 s40, 4
    s_cselect_b32 s76, s4, s3
    s_mul_i32 s75, s29, 5120
    s_mul_i32 s4, s76, 40960
    s_add_u32 s75, s75, s4
    s_add_u32 s75, s75, 10485760
    s_lshl_b32 s5, s40, 10
    v_add_u32 v96, s5, v251
    s_add_u32 m0, s49, 16384
    v_mfma_f32_32x32x16_bf16 v[16:31], v[130:133], v[122:125], v[16:31]
    buffer_load_dwordx4 v243, s[8:11], s42 offen lds
    ds_read_b64_tr_b16 v[106:107], v227 offset:0
    ds_read_b64_tr_b16 v[108:109], v227 offset:512
    ds_read_b64_tr_b16 v[110:111], v228 offset:0
    v_cmp_gt_u32 vcc, 6400, v96
    s_nop 1
    v_cndmask_b32 v96, v255, v96, vcc
    v_and_b32 v80, 7, v250
    v_mfma_f32_32x32x16_bf16 v[32:47], v[134:137], v[122:125], v[32:47]
    ds_read_b64_tr_b16 v[112:113], v228 offset:512
    ds_read_b64_tr_b16 v[114:115], v229 offset:0
    ds_read_b64_tr_b16 v[116:117], v229 offset:512
    v_lshlrev_b32 v80, 3, v80
    v_bfe_u32 v84, v250, 3, 2
    s_add_u32 m0, s49, 17408
    v_mfma_f32_32x32x16_bf16 v[48:63], v[138:141], v[122:125], v[48:63]
    buffer_load_dwordx4 v244, s[8:11], s42 offen lds
    ds_read_b64_tr_b16 v[118:119], v230 offset:0
    ds_read_b64_tr_b16 v[120:121], v230 offset:512
    v_lshl_add_u32 v80, v84, 7, v80
    s_lshl_b32 s70, s25, 7
    v_mfma_f32_32x32x16_bf16 v[64:79], v[142:145], v[122:125], v[64:79]
    s_add_u32 s70, s70, s74
    s_lshl_b32 s70, s70, 4
    s_waitcnt lgkmcnt(0)
    s_add_u32 m0, s48, 73728
    v_mfma_f32_32x32x16_bf16 v[0:15], v[102:105], v[98:101], v[0:15]
    buffer_load_dwordx4 v240, s[12:15], s41 offen lds
    ds_read_b128 v[122:125], v237 offset:0
    ds_read_b64_tr_b16 v[126:127], v226 offset:2048
    ds_read_b64_tr_b16 v[128:129], v226 offset:2560
    s_add_u32 s70, s70, 19922944
    v_and_b32 v81, 3, v250
    v_mfma_f32_32x32x16_bf16 v[16:31], v[106:109], v[98:101], v[16:31]
    ds_read_b64_tr_b16 v[130:131], v227 offset:2048
    ds_read_b64_tr_b16 v[132:133], v227 offset:2560
    ds_read_b64_tr_b16 v[134:135], v228 offset:2048
    v_lshl_add_u32 v81, v84, 2, v81
    v_bfe_u32 v85, v250, 2, 1
    s_add_u32 m0, s48, 77824
    v_mfma_f32_32x32x16_bf16 v[32:47], v[110:113], v[98:101], v[32:47]
    buffer_load_dwordx4 v241, s[12:15], s41 offen lds
    ds_read_b64_tr_b16 v[136:137], v228 offset:2560
    ds_read_b64_tr_b16 v[138:139], v229 offset:2048
    ds_read_b64_tr_b16 v[140:141], v229 offset:2560
    s_mul_i32 s72, s24, 80
    v_mad_u32_u24 v81, v85, s72, v81
    s_add_u32 m0, s48, 81920
    v_mfma_f32_32x32x16_bf16 v[48:63], v[114:117], v[98:101], v[48:63]
    buffer_load_dwordx4 v242, s[12:15], s41 offen lds
    ds_read_b64_tr_b16 v[142:143], v230 offset:2048
    ds_read_b64_tr_b16 v[144:145], v230 offset:2560
    v_lshlrev_b32 v81, 3, v81
    s_mul_i32 s72, s72, s51
    v_mfma_f32_32x32x16_bf16 v[64:79], v[118:121], v[98:101], v[64:79]
    s_add_u32 s72, s72, s60
    s_lshl_b32 s72, s72, 2
    s_waitcnt vmcnt(9) lgkmcnt(0)
    s_barrier
    v_mfma_f32_32x32x16_bf16 v[0:15], v[126:129], v[122:125], v[0:15]
    s_lshl_b32 s5, s40, 10
    s_add_u32 m0, s5, 147456
    s_mul_i32 s4, s26, 6400
    buffer_load_dwordx4 v96, s[32:35], s4 offen lds
    ds_read_b128 v[98:101], v238 offset:0
    ds_read_b64_tr_b16 v[102:103], v226 offset:24576
    ds_read_b64_tr_b16 v[104:105], v226 offset:25088
    s_add_u32 s72, s72, 19955712
    s_sub_u32 s73, 2, s24
    v_mfma_f32_32x32x16_bf16 v[16:31], v[130:133], v[122:125], v[16:31]
    ds_read_b64_tr_b16 v[106:107], v227 offset:24576
    ds_read_b64_tr_b16 v[108:109], v227 offset:25088
    ds_read_b64_tr_b16 v[110:111], v228 offset:24576
    s_mul_i32 s73, s73, 4800
    v_add_u32 v82, s73, v81
    v_mfma_f32_32x32x16_bf16 v[32:47], v[134:137], v[122:125], v[32:47]
    ds_read_b64_tr_b16 v[112:113], v228 offset:25088
    ds_read_b64_tr_b16 v[114:115], v229 offset:24576
    ds_read_b64_tr_b16 v[116:117], v229 offset:25088
    v_lshrrev_b32 v84, 1, v84
    v_mad_u32_u24 v83, v84, s73, v81
    v_mfma_f32_32x32x16_bf16 v[48:63], v[138:141], v[122:125], v[48:63]
    ds_read_b64_tr_b16 v[118:119], v230 offset:24576
    ds_read_b64_tr_b16 v[120:121], v230 offset:25088
    v_bfe_u32 v84, v250, 2, 2
    v_mul_u32_u24 v84, 40, v84
    v_mfma_f32_32x32x16_bf16 v[64:79], v[142:145], v[122:125], v[64:79]
    v_bfe_u32 v85, v250, 1, 1
    v_bfe_u32 v246, v250, 4, 1
    s_waitcnt vmcnt(6)
    v_cmp_ne_u32 vcc, s65, v253
    s_nop 4
    s_cbranch_vccnz KFQ_HBT1
KFQ_HBR1:
    v_mov_b32 v253, 0
    buffer_load_dword v253, v245, s[16:19], s44 offen sc1
    s_waitcnt lgkmcnt(0)
    v_mfma_f32_32x32x16_bf16 v[0:15], v[102:105], v[98:101], v[0:15]
    ds_read_b128 v[122:125], v239 offset:0
    ds_read_b64_tr_b16 v[126:127], v226 offset:26624
    ds_read_b64_tr_b16 v[128:129], v226 offset:27136
    v_lshl_add_u32 v85, v246, 1, v85
    v_and_b32 v246, 1, v250
    v_mfma_f32_32x32x16_bf16 v[16:31], v[106:109], v[98:101], v[16:31]
    ds_read_b64_tr_b16 v[130:131], v227 offset:26624
    ds_read_b64_tr_b16 v[132:133], v227 offset:27136
    ds_read_b64_tr_b16 v[134:135], v228 offset:26624
    buffer_load_dwordx4 v[166:169], v251, s[16:19], s75 offen offset:0 sc1
    v_mul_u32_u24 v247, 3200, v246
    v_add_u32 v84, v247, v84
    v_mfma_f32_32x32x16_bf16 v[32:47], v[110:113], v[98:101], v[32:47]
    ds_read_b64_tr_b16 v[136:137], v228 offset:27136
    ds_read_b64_tr_b16 v[138:139], v229 offset:26624
    ds_read_b64_tr_b16 v[140:141], v229 offset:27136
    s_mul_i32 s71, s51, 1600
    s_add_u32 s71, s71, 147456
    v_mfma_f32_32x32x16_bf16 v[48:63], v[114:117], v[98:101], v[48:63]
    ds_read_b64_tr_b16 v[142:143], v230 offset:26624
    ds_read_b64_tr_b16 v[144:145], v230 offset:27136
    buffer_load_dwordx4 v[170:173], v251, s[16:19], s75 offen offset:1024 sc1
    v_add_u32 v84, s71, v84
    v_lshrrev_b32 v247, 5, v250
    v_mfma_f32_32x32x16_bf16 v[64:79], v[118:121], v[98:101], v[64:79]
    v_lshl_add_u32 v248, v85, 3, v84
    v_add_u32 v249, 32, v84
    s_waitcnt vmcnt(7) lgkmcnt(0)
    s_barrier
    v_mfma_f32_32x32x16_bf16 v[0:15], v[126:129], v[122:125], v[0:15]
    ds_read_b128 v[98:101], v236 offset:16384
    ds_read_b64_tr_b16 v[102:103], v231 offset:0
    ds_read_b64_tr_b16 v[104:105], v231 offset:512
    v_mov_b32 v84, 153856
    v_cmp_eq_u32 vcc, v246, v247
    s_nop 1
    v_cndmask_b32 v248, v84, v248, vcc
    v_cndmask_b32 v249, v84, v249, vcc
    v_mfma_f32_32x32x16_bf16 v[16:31], v[130:133], v[122:125], v[16:31]
    ds_read_b64_tr_b16 v[106:107], v232 offset:0
    ds_read_b64_tr_b16 v[108:109], v232 offset:512
    ds_read_b64_tr_b16 v[110:111], v233 offset:0
    buffer_load_dwordx4 v[174:177], v251, s[16:19], s75 offen offset:2048 sc1
    v_cmp_eq_u32 vcc, 0, v85
    s_nop 1
    v_cndmask_b32 v249, v84, v249, vcc
    v_mfma_f32_32x32x16_bf16 v[32:47], v[134:137], v[122:125], v[32:47]
    ds_read_b64_tr_b16 v[112:113], v233 offset:512
    ds_read_b64_tr_b16 v[114:115], v234 offset:0
    ds_read_b64_tr_b16 v[116:117], v234 offset:512
    v_mfma_f32_32x32x16_bf16 v[48:63], v[138:141], v[122:125], v[48:63]
    ds_read_b64_tr_b16 v[118:119], v235 offset:0
    ds_read_b64_tr_b16 v[120:121], v235 offset:512
    buffer_load_dwordx4 v[178:181], v251, s[16:19], s75 offen offset:3072 sc1
    v_mfma_f32_32x32x16_bf16 v[64:79], v[142:145], v[122:125], v[64:79]
    s_waitcnt vmcnt(4)
    v_cmp_ne_u32 vcc, s65, v253
    s_nop 4
    s_cbranch_vccnz KFQ_HBT2
KFQ_HBR2:
    s_waitcnt lgkmcnt(0)
    v_mfma_f32_32x32x16_bf16 v[0:15], v[102:105], v[98:101], v[0:15]
    ds_read_b128 v[122:125], v237 offset:16384
    ds_read_b64_tr_b16 v[126:127], v231 offset:2048
    ds_read_b64_tr_b16 v[128:129], v231 offset:2560
    buffer_load_dwordx2 v[86:87], v80, s[16:19], s70 offen sc1
    v_mfma_f32_32x32x16_bf16 v[16:31], v[106:109], v[98:101], v[16:31]
    ds_read_b64_tr_b16 v[130:131], v232 offset:2048
    ds_read_b64_tr_b16 v[132:133], v232 offset:2560
    ds_read_b64_tr_b16 v[134:135], v233 offset:2048
    buffer_load_dwordx2 v[88:89], v81, s[16:19], s72 offen offset:0 sc1
    v_mfma_f32_32x32x16_bf16 v[32:47], v[110:113], v[98:101], v[32:47]
    ds_read_b64_tr_b16 v[136:137], v233 offset:2560
    ds_read_b64_tr_b16 v[138:139], v234 offset:2048
    ds_read_b64_tr_b16 v[140:141], v234 offset:2560
    buffer_load_dwordx2 v[90:91], v81, s[16:19], s72 offen offset:128 sc1
    v_mfma_f32_32x32x16_bf16 v[48:63], v[114:117], v[98:101], v[48:63]
    ds_read_b64_tr_b16 v[142:143], v235 offset:2048
    ds_read_b64_tr_b16 v[144:145], v235 offset:2560
    buffer_load_dwordx2 v[92:93], v83, s[16:19], s72 offen offset:256 sc1
    v_mfma_f32_32x32x16_bf16 v[64:79], v[118:121], v[98:101], v[64:79]
    buffer_load_dwordx2 v[94:95], v82, s[16:19], s72 offen offset:384 sc1
    s_waitcnt vmcnt(10) lgkmcnt(0)
    s_barrier
    v_mfma_f32_32x32x16_bf16 v[0:15], v[126:129], v[122:125], v[0:15]
    ds_read_b128 v[98:101], v238 offset:16384
    ds_read_b64_tr_b16 v[102:103], v231 offset:24576
    ds_read_b64_tr_b16 v[104:105], v231 offset:25088
    v_mfma_f32_32x32x16_bf16 v[16:31], v[130:133], v[122:125], v[16:31]
    ds_read_b64_tr_b16 v[106:107], v232 offset:24576
    ds_read_b64_tr_b16 v[108:109], v232 offset:25088
    ds_read_b64_tr_b16 v[110:111], v233 offset:24576
    buffer_load_dwordx2 v[96:97], v82, s[16:19], s72 offen offset:512 sc1
    v_mfma_f32_32x32x16_bf16 v[32:47], v[134:137], v[122:125], v[32:47]
    ds_read_b64_tr_b16 v[112:113], v233 offset:25088
    ds_read_b64_tr_b16 v[114:115], v234 offset:24576
    ds_read_b64_tr_b16 v[116:117], v234 offset:25088
    v_mfma_f32_32x32x16_bf16 v[48:63], v[138:141], v[122:125], v[48:63]
    ds_read_b64_tr_b16 v[118:119], v235 offset:24576
    ds_read_b64_tr_b16 v[120:121], v235 offset:25088
    buffer_load_dwordx4 v[182:185], v252, s[16:19], s75 offen sc1
    s_add_u32 s75, s75, 40960
    v_mfma_f32_32x32x16_bf16 v[64:79], v[142:145], v[122:125], v[64:79]
    s_waitcnt lgkmcnt(0)
    v_mfma_f32_32x32x16_bf16 v[0:15], v[102:105], v[98:101], v[0:15]
    ds_read_b128 v[122:125], v239 offset:16384
    ds_read_b64_tr_b16 v[126:127], v231 offset:26624
    ds_read_b64_tr_b16 v[128:129], v231 offset:27136
    v_mfma_f32_32x32x16_bf16 v[16:31], v[106:109], v[98:101], v[16:31]
    ds_read_b64_tr_b16 v[130:131], v232 offset:26624
    ds_read_b64_tr_b16 v[132:133], v232 offset:27136
    ds_read_b64_tr_b16 v[134:135], v233 offset:26624
    buffer_load_dwordx4 v[186:189], v251, s[16:19], s75 offen offset:0 sc1
    v_mfma_f32_32x32x16_bf16 v[32:47], v[110:113], v[98:101], v[32:47]
    ds_read_b64_tr_b16 v[136:137], v233 offset:27136
    ds_read_b64_tr_b16 v[138:139], v234 offset:26624
    ds_read_b64_tr_b16 v[140:141], v234 offset:27136
    v_mfma_f32_32x32x16_bf16 v[48:63], v[114:117], v[98:101], v[48:63]
    ds_read_b64_tr_b16 v[142:143], v235 offset:26624
    ds_read_b64_tr_b16 v[144:145], v235 offset:27136
    buffer_load_dwordx4 v[190:193], v251, s[16:19], s75 offen offset:1024 sc1
    v_mfma_f32_32x32x16_bf16 v[64:79], v[118:121], v[98:101], v[64:79]
    s_waitcnt lgkmcnt(0)
    s_barrier
    v_mfma_f32_32x32x16_bf16 v[0:15], v[126:129], v[122:125], v[0:15]
    v_mfma_f32_32x32x16_bf16 v[16:31], v[130:133], v[122:125], v[16:31]
    buffer_load_dwordx4 v[194:197], v251, s[16:19], s75 offen offset:2048 sc1
    v_mfma_f32_32x32x16_bf16 v[32:47], v[134:137], v[122:125], v[32:47]
    v_mfma_f32_32x32x16_bf16 v[48:63], v[138:141], v[122:125], v[48:63]
    buffer_load_dwordx4 v[198:201], v251, s[16:19], s75 offen offset:3072 sc1
    v_mfma_f32_32x32x16_bf16 v[64:79], v[142:145], v[122:125], v[64:79]
    buffer_load_dwordx4 v[202:205], v252, s[16:19], s75 offen sc1
    s_add_u32 s75, s75, 40960
    s_waitcnt vmcnt(6)
    s_branch KFQ_DONE
KFQ_HT0:
    s_cmp_eq_u32 s47, 7
    s_cbranch_scc1 KFQ_HT0B
    buffer_store_dwordx4 v[196:199], v251, s[16:19], s71 offen offset:2048 sc1
    buffer_store_dwordx4 v[200:203], v251, s[16:19], s71 offen offset:3072 sc1
    s_branch KFQ_HR0
KFQ_HT0B:
    s_sub_u32 s7, s40, 1
    s_add_u32 s3, s52, s7
    s_mul_i32 s6, s3, 6554
    s_lshr_b32 s6, s6, 16
    s_mul_i32 s4, s6, 10
    s_sub_u32 s4, s3, s4
    s_lshl_b32 s71, s3, 12
    s_add_u32 s71, s71, 12697600
    s_lshl_b32 s70, s4, 7
    v_lshrrev_b32 v186, 3, v250
    v_and_b32 v184, 7, v250
    v_lshlrev_b32 v184, 4, v184
    s_lshl_b32 s7, s7, 12
    s_add_u32 s7, s7, 131072
    s_mul_i32 s4, s6, 52
    s_lshr_b32 s4, s4, 8
    s_mul_i32 s5, s4, 5
    s_sub_u32 s5, s6, s5
    s_mul_i32 s4, s4, 160
    s_mul_i32 s3, s5, 40
    s_cmp_eq_u32 s5, 4
    s_cselect_b32 s3, 16, s3
    s_cselect_b32 s72, 40, 8
    s_cselect_b32 s73, 40, 12
    s_cselect_b32 s5, 16, 0
    s_add_u32 s4, s4, s3
    s_mul_i32 s4, s4, 1280
    s_add_u32 s70, s70, s4
    s_mul_i32 s72, s72, 1280
    s_mul_i32 s73, s73, 1280
    v_lshrrev_b32 v185, 2, v186
    v_mad_u32_u24 v186, v185, s5, v186
    v_mul_u32_u24 v186, 1280, v186
    v_add_u32 v184, v186, v184
    s_mov_b32 s61, s7
    v_lshrrev_b32 v185, 4, v250
    v_bfe_u32 v186, v250, 2, 2
    v_lshl_add_u32 v185, v185, 3, v186
    v_and_b32 v186, 3, v250
    v_lshlrev_b32 v186, 3, v186
    v_lshl_add_u32 v185, v185, 7, v186
    v_add_u32 v185, s7, v185
    s_add_u32 m0, s61, 0
    s_nop 0
    buffer_load_dwordx4 v184, s[36:39], s70 offen lds
    s_add_u32 s70, s70, s72
    s_add_u32 m0, s61, 1024
    s_nop 0
    buffer_load_dwordx4 v184, s[36:39], s70 offen lds
    s_add_u32 s70, s70, s73
    s_branch KFQ_HR0
KFQ_HT1:
    s_add_u32 m0, s61, 2048
    s_nop 0
    buffer_load_dwordx4 v184, s[36:39], s70 offen lds
    s_add_u32 s70, s70, s72
    s_add_u32 m0, s61, 3072
    s_nop 0
    buffer_load_dwordx4 v184, s[36:39], s70 offen lds
    s_branch KFQ_HR1
KFQ_HT2:
    s_cmp_eq_u32 s47, 13
    s_cbranch_scc1 KFQ_HA
    v_lshlrev_b32 v174, 16, v166
    v_and_b32 v175, 0xffff0000, v166
    v_add_f32 v172, v174, v175
    v_mul_f32 v173, v174, v174
    v_fmac_f32 v173, v175, v175
    v_lshlrev_b32 v174, 16, v167
    v_and_b32 v175, 0xffff0000, v167
    v_add_f32 v172, v172, v174
    v_fmac_f32 v173, v174, v174
    v_add_f32 v172, v172, v175
    v_fmac_f32 v173, v175, v175
    v_lshlrev_b32 v174, 16, v168
    v_and_b32 v175, 0xffff0000, v168
    v_add_f32 v172, v172, v174
    v_fmac_f32 v173, v174, v174
    v_add_f32 v172, v172, v175
    v_fmac_f32 v173, v175, v175
    v_lshlrev_b32 v174, 16, v169
    v_and_b32 v175, 0xffff0000, v169
    v_add_f32 v172, v172, v174
    v_fmac_f32 v173, v174, v174
    v_add_f32 v172, v172, v175
    v_fmac_f32 v173, v175, v175
    v_lshlrev_b32 v174, 16, v170
    v_and_b32 v175, 0xffff0000, v170
    v_add_f32 v172, v172, v174
    v_fmac_f32 v173, v174, v174
    v_add_f32 v172, v172, v175
    v_fmac_f32 v173, v175, v175
    s_lshl_b32 s3, s40, 5
    v_add_f32_dpp v172, v172, v172 quad_perm:[1,0,3,2] row_mask:0xf bank_mask:0xf
    v_add_f32_dpp v173, v173, v173 quad_perm:[1,0,3,2] row_mask:0xf bank_mask:0xf
    s_add_u32 s3, s3, 163328
    v_add_f32_dpp v172, v172, v172 quad_perm:[2,3,0,1] row_mask:0xf bank_mask:0xf
    v_add_f32_dpp v173, v173, v173 quad_perm:[2,3,0,1] row_mask:0xf bank_mask:0xf
    v_lshrrev_b32 v174, 4, v250
    v_add_f32_dpp v172, v172, v172 row_half_mirror row_mask:0xf bank_mask:0xf
    v_add_f32_dpp v173, v173, v173 row_half_mirror row_mask:0xf bank_mask:0xf
    v_lshl_add_u32 v174, v174, 3, s3
    v_add_f32_dpp v172, v172, v172 row_mirror row_mask:0xf bank_mask:0xf
    v_add_f32_dpp v173, v173, v173 row_mirror row_mask:0xf bank_mask:0xf
    ds_write_b64 v174, v[172:173]
    buffer_load_dword v253, v254, s[20:23], 0 offen sc1
    s_branch KFQ_HR2
KFQ_HA:
KFQ_HG2T:
    v_readfirstlane_b32 s65, v253
    s_nop 3
    s_cmp_lg_u32 s65, 0
    s_cbranch_scc1 KFQ_HG2T_X
    s_add_u32 s77, s77, 1
    s_cmp_gt_u32 s77, 100000
    s_cbranch_scc1 KFQ_HG2T_X
    s_sleep 8
    buffer_load_dword v253, v254, s[20:23], 0 offen sc1
    s_waitcnt vmcnt(0)
    s_branch KFQ_HG2T
KFQ_HG2T_X:
    s_cmp_lg_u32 s40, 0
    s_cbranch_scc1 KFQ_HG2
    s_bfe_u32 s4, s27, 0x80010
    s_lshl_b32 s4, s4, 4
    s_add_u32 s4, s4, s25
    s_lshl_b32 s4, s4, 7
    s_add_u32 s4, s4, 20086784
    v_lshlrev_b32 v166, 2, v250
    v_mov_b32 v167, s65
    s_mov_b32 exec_hi, 0
    buffer_store_dword v167, v166, s[16:19], s4 offen sc1
    s_mov_b32 exec_hi, -1
KFQ_HG2:
    s_branch KFQ_HR2
KFQ_HT3:
    s_cmp_eq_u32 s40, 0
    s_cbranch_scc1 KFQ_HT3B
    ds_read_b64_tr_b16 v[188:189], v185 offset:0
    ds_read_b64_tr_b16 v[190:191], v185 offset:512
    ds_read_b64_tr_b16 v[192:193], v185 offset:32
    ds_read_b64_tr_b16 v[194:195], v185 offset:544
    ds_read_b64_tr_b16 v[196:197], v185 offset:64
    ds_read_b64_tr_b16 v[198:199], v185 offset:576
    ds_read_b64_tr_b16 v[200:201], v185 offset:96
    ds_read_b64_tr_b16 v[202:203], v185 offset:608
    s_waitcnt lgkmcnt(6)
    buffer_store_dwordx4 v[188:191], v251, s[16:19], s71 offen offset:0 sc1
    s_waitcnt lgkmcnt(4)
    buffer_store_dwordx4 v[192:195], v251, s[16:19], s71 offen offset:1024 sc1
    s_branch KFQ_HR3
KFQ_HT3B:
    v_and_b32 v174, 7, v250
    v_lshlrev_b32 v174, 5, v174
    v_add_u32 v174, 163328, v174
    ds_read_b128 v[166:169], v174
    ds_read_b128 v[170:173], v174 offset:16
    v_lshlrev_b32 v175, 3, v250
    v_lshlrev_b32 v174, 26, v250
    v_and_b32 v174, 0xc0000000, v174
    v_lshrrev_b32 v174, 1, v174
    v_or_b32 v175, v174, v175
    s_lshl_b32 s3, s44, 4
    s_add_u32 s3, s3, 19922944
    s_waitcnt lgkmcnt(0)
    v_add_f32 v166, v166, v168
    v_add_f32 v167, v167, v169
    v_add_f32 v170, v170, v172
    v_add_f32 v171, v171, v173
    v_add_f32 v166, v166, v170
    v_add_f32 v167, v167, v171
    v_mul_f32 v166, 0xbacccccd, v166
    v_mul_f32 v174, v166, v166
    v_cvt_pk_bf16_f32 v168, v166, v166
    v_mul_f32 v167, 0x3acccccd, v167
    v_sub_f32 v167, v167, v174
    v_max_f32 v167, 0, v167
    v_cvt_pk_bf16_f32 v174, v167, v167
    v_and_b32 v174, 0xffff0000, v174
    v_add_f32 v174, 0x3727c5ac, v174
    v_cvt_pk_bf16_f32 v174, v174, v174
    v_and_b32 v174, 0xffff0000, v174
    v_sqrt_f32 v174, v174
    s_nop 0
    v_cvt_pk_bf16_f32 v174, v174, v174
    v_and_b32 v169, 0xffff0000, v174
    buffer_store_dwordx2 v[168:169], v175, s[16:19], s3 offen sc1
    s_branch KFQ_HR3
KFQ_TK:
KFQ_TK1:
    v_readfirstlane_b32 s65, v253
    s_nop 3
    s_cmp_lg_u32 s65, 0
    s_cbranch_scc1 KFQ_TK1_X
    s_add_u32 s77, s77, 1
    s_cmp_gt_u32 s77, 100000
    s_cbranch_scc1 KFQ_TK1_X
    s_sleep 8
    buffer_load_dword v253, v254, s[20:23], 0 offen sc1
    s_waitcnt vmcnt(0)
    s_branch KFQ_TK1
KFQ_TK1_X:
    s_branch KFQ_TKR
KFQ_HBT1:
    s_waitcnt lgkmcnt(0)
    s_call_b64 s[6:7], KFQ_HB
    s_branch KFQ_HBR1
KFQ_HBT2:
    s_waitcnt lgkmcnt(0)
    s_call_b64 s[6:7], KFQ_HB
    s_branch KFQ_HBR2
KFQ_HB:
    s_add_u32 s77, s77, 1
    s_cmp_gt_u32 s77, 100000
    s_cbranch_scc1 KFQ_HBX
    s_sleep 2
    buffer_load_dword v253, v245, s[16:19], s44 offen sc1
    s_waitcnt vmcnt(0)
    v_cmp_ne_u32 vcc, s65, v253
    s_nop 4
    s_cbranch_vccnz KFQ_HB
KFQ_HBX:
    s_setpc_b64 s[6:7]
KFQ_DONE:
    v_cmp_gt_u32 vcc, 32, v250
    s_nop 1
    v_cndmask_b32 v98, 0, v86, vcc
    v_and_b32 v99, 0xffff, v98
    s_nop 1
    v_mfma_f32_32x32x8_bf16 v[0:15], v[88:89], v[98:99], v[0:15]
    v_mfma_f32_32x32x8_bf16 v[16:31], v[90:91], v[98:99], v[16:31]
    v_mfma_f32_32x32x8_bf16 v[32:47], v[92:93], v[98:99], v[32:47]
    v_mfma_f32_32x32x8_bf16 v[48:63], v[94:95], v[98:99], v[48:63]
    v_mfma_f32_32x32x8_bf16 v[64:79], v[96:97], v[98:99], v[64:79]
    v_rcp_f32 v246, v87
    s_cmp_eq_u32 s24, 2
    s_cbranch_scc1 KF_QEPI
    ds_read_b64_tr_b16 v[124:125], v248 offset:0
    ds_read_b64_tr_b16 v[126:127], v248 offset:160
    ds_read_b64_tr_b16 v[128:129], v248 offset:320
    ds_read_b64_tr_b16 v[130:131], v248 offset:480
    ds_read_b64_tr_b16 v[132:133], v248 offset:640
    ds_read_b64_tr_b16 v[134:135], v249 offset:0
    ds_read_b64_tr_b16 v[136:137], v249 offset:160
    ds_read_b64_tr_b16 v[138:139], v249 offset:320
    ds_read_b64_tr_b16 v[140:141], v249 offset:480
    ds_read_b64_tr_b16 v[142:143], v249 offset:640
    ds_read_b64_tr_b16 v[226:227], v248 offset:800
    ds_read_b64_tr_b16 v[228:229], v248 offset:960
    ds_read_b64_tr_b16 v[230:231], v248 offset:1120
    ds_read_b64_tr_b16 v[232:233], v248 offset:1280
    ds_read_b64_tr_b16 v[234:235], v248 offset:1440
    ds_read_b64_tr_b16 v[236:237], v249 offset:800
    ds_read_b64_tr_b16 v[238:239], v249 offset:960
    ds_read_b64_tr_b16 v[240:241], v249 offset:1120
    ds_read_b64_tr_b16 v[242:243], v249 offset:1280
    ds_read_b64_tr_b16 v[244:245], v249 offset:1440
    v_cvt_pk_bf16_f32 v80, v0, v1
    v_cvt_pk_bf16_f32 v81, v2, v3
    v_cvt_pk_bf16_f32 v82, v4, v5
    v_cvt_pk_bf16_f32 v83, v6, v7
    v_cvt_pk_bf16_f32 v84, v8, v9
    v_cvt_pk_bf16_f32 v85, v10, v11
    v_cvt_pk_bf16_f32 v86, v12, v13
    v_cvt_pk_bf16_f32 v87, v14, v15
    v_cvt_pk_bf16_f32 v88, v16, v17
    v_cvt_pk_bf16_f32 v89, v18, v19
    v_cvt_pk_bf16_f32 v90, v20, v21
    v_cvt_pk_bf16_f32 v91, v22, v23
    v_cvt_pk_bf16_f32 v92, v24, v25
    v_cvt_pk_bf16_f32 v93, v26, v27
    v_cvt_pk_bf16_f32 v94, v28, v29
    v_cvt_pk_bf16_f32 v95, v30, v31
    v_cvt_pk_bf16_f32 v96, v32, v33
    v_cvt_pk_bf16_f32 v97, v34, v35
    v_cvt_pk_bf16_f32 v98, v36, v37
    v_cvt_pk_bf16_f32 v99, v38, v39
    s_waitcnt lgkmcnt(0)
    v_mfma_f32_32x32x16_bf16 v[0:15], v[124:127], v[80:83], 0
    v_mfma_f32_32x32x16_bf16 v[0:15], v[128:131], v[84:87], v[0:15]
    v_mfma_f32_32x32x8_bf16 v[0:15], v[132:133], v[88:89], v[0:15]
    v_mfma_f32_32x32x16_bf16 v[16:31], v[134:137], v[80:83], 0
    v_mfma_f32_32x32x16_bf16 v[16:31], v[138:141], v[84:87], v[16:31]
    v_mfma_f32_32x32x8_bf16 v[16:31], v[142:143], v[88:89], v[16:31]
    v_mul_f32 v40, v246, v40
    v_mul_f32 v41, v246, v41
    v_mul_f32 v42, v246, v42
    v_mul_f32 v43, v246, v43
    v_mul_f32 v44, v246, v44
    v_mul_f32 v45, v246, v45
    v_mul_f32 v46, v246, v46
    v_mul_f32 v47, v246, v47
    v_mul_f32 v48, v246, v48
    v_mul_f32 v49, v246, v49
    v_mul_f32 v50, v246, v50
    v_mul_f32 v51, v246, v51
    v_mul_f32 v52, v246, v52
    v_mul_f32 v53, v246, v53
    v_mul_f32 v54, v246, v54
    v_mul_f32 v55, v246, v55
    v_mul_f32 v56, v246, v56
    v_mul_f32 v57, v246, v57
    v_mul_f32 v58, v246, v58
    v_mul_f32 v59, v246, v59
    v_cvt_pk_bf16_f32 v100, v40, v41
    v_cvt_pk_bf16_f32 v101, v42, v43
    v_cvt_pk_bf16_f32 v102, v44, v45
    v_cvt_pk_bf16_f32 v103, v46, v47
    v_cvt_pk_bf16_f32 v104, v48, v49
    v_cvt_pk_bf16_f32 v105, v50, v51
    v_cvt_pk_bf16_f32 v106, v52, v53
    v_cvt_pk_bf16_f32 v107, v54, v55
    v_cvt_pk_bf16_f32 v108, v56, v57
    v_cvt_pk_bf16_f32 v109, v58, v59
    v_mov_b32 v110, 0x3f80
    v_mov_b32 v111, 0
    v_mul_f32 v60, v246, v60
    v_mul_f32 v61, v246, v61
    v_mul_f32 v62, v246, v62
    v_mul_f32 v63, v246, v63
    v_mul_f32 v64, v246, v64
    v_mul_f32 v65, v246, v65
    v_mul_f32 v66, v246, v66
    v_mul_f32 v67, v246, v67
    v_mul_f32 v68, v246, v68
    v_mul_f32 v69, v246, v69
    v_mul_f32 v70, v246, v70
    v_mul_f32 v71, v246, v71
    v_mul_f32 v72, v246, v72
    v_mul_f32 v73, v246, v73
    v_mul_f32 v74, v246, v74
    v_mul_f32 v75, v246, v75
    v_mul_f32 v76, v246, v76
    v_mul_f32 v77, v246, v77
    v_mul_f32 v78, v246, v78
    v_mul_f32 v79, v246, v79
    v_cvt_pk_bf16_f32 v112, v60, v61
    v_cvt_pk_bf16_f32 v113, v62, v63
    v_cvt_pk_bf16_f32 v114, v64, v65
    v_cvt_pk_bf16_f32 v115, v66, v67
    v_cvt_pk_bf16_f32 v116, v68, v69
    v_cvt_pk_bf16_f32 v117, v70, v71
    v_cvt_pk_bf16_f32 v118, v72, v73
    v_cvt_pk_bf16_f32 v119, v74, v75
    v_cvt_pk_bf16_f32 v120, v76, v77
    v_cvt_pk_bf16_f32 v121, v78, v79
    v_mov_b32 v122, 0x3f80
    v_mov_b32 v123, 0
    v_mfma_f32_32x32x16_bf16 v[32:47], v[226:229], v[90:93], 0
    v_mfma_f32_32x32x16_bf16 v[32:47], v[230:233], v[94:97], v[32:47]
    v_mfma_f32_32x32x8_bf16 v[32:47], v[234:235], v[98:99], v[32:47]
    v_mfma_f32_32x32x16_bf16 v[48:63], v[236:239], v[90:93], 0
    v_mfma_f32_32x32x16_bf16 v[48:63], v[240:243], v[94:97], v[48:63]
    v_mfma_f32_32x32x8_bf16 v[48:63], v[244:245], v[98:99], v[48:63]
    v_mul_f32 v144, 0x3fb8aa3b, v246
    v_sub_f32 v145, 0, v144
    v_lshrrev_b32 v64, 5, v250
    v_mul_u32_u24 v64, 73728, v64
    v_and_b32 v65, 31, v250
    v_add_u32 v65, s74, v65
    v_mul_u32_u24 v65, 144, v65
    v_add_u32 v64, v64, v65
    s_mul_i32 s3, s51, 36864
    v_add_u32 v247, s3, v64
    ds_write_b128 v247, v[100:103] offset:80
    ds_write_b128 v247, v[104:107] offset:96
    ds_write_b128 v247, v[108:111] offset:112
    ds_write_b128 v247, v[112:115] offset:18512
    ds_write_b128 v247, v[116:119] offset:18528
    ds_write_b128 v247, v[120:123] offset:18544
    v_max3_f32 v64, v0, v1, v2
    v_min3_f32 v65, v0, v1, v2
    v_max3_f32 v64, v64, v3, v4
    v_min3_f32 v65, v65, v3, v4
    v_max3_f32 v64, v64, v5, v6
    v_min3_f32 v65, v65, v5, v6
    v_max3_f32 v64, v64, v7, v8
    v_min3_f32 v65, v65, v7, v8
    v_max3_f32 v64, v64, v9, v10
    v_min3_f32 v65, v65, v9, v10
    v_max3_f32 v64, v64, v11, v12
    v_min3_f32 v65, v65, v11, v12
    v_max3_f32 v64, v64, v13, v14
    v_min3_f32 v65, v65, v13, v14
    buffer_load_dwordx4 v[206:209], v251, s[16:19], s75 offen offset:0 sc1
    v_max3_f32 v64, v64, v15, v16
    v_min3_f32 v65, v65, v15, v16
    v_max3_f32 v64, v64, v17, v18
    v_min3_f32 v65, v65, v17, v18
    v_max_f32 v64, v64, v19
    v_min_f32 v65, v65, v19
    v_mul_f32 v64, v145, v64
    v_mul_f32 v70, v144, v65
    v_pk_fma_f32 v[124:125], v[0:1], v[144:145], v[70:71] op_sel_hi:[1,0,0] neg_lo:[1,0,0] neg_hi:[1,0,0]
    v_pk_fma_f32 v[0:1], v[0:1], v[144:145], v[64:65] op_sel_hi:[1,0,0]
    v_pk_fma_f32 v[126:127], v[2:3], v[144:145], v[70:71] op_sel_hi:[1,0,0] neg_lo:[1,0,0] neg_hi:[1,0,0]
    v_pk_fma_f32 v[2:3], v[2:3], v[144:145], v[64:65] op_sel_hi:[1,0,0]
    v_pk_fma_f32 v[128:129], v[4:5], v[144:145], v[70:71] op_sel_hi:[1,0,0] neg_lo:[1,0,0] neg_hi:[1,0,0]
    v_pk_fma_f32 v[4:5], v[4:5], v[144:145], v[64:65] op_sel_hi:[1,0,0]
    buffer_load_dwordx4 v[210:213], v251, s[16:19], s75 offen offset:1024 sc1
    v_pk_fma_f32 v[130:131], v[6:7], v[144:145], v[70:71] op_sel_hi:[1,0,0] neg_lo:[1,0,0] neg_hi:[1,0,0]
    v_pk_fma_f32 v[6:7], v[6:7], v[144:145], v[64:65] op_sel_hi:[1,0,0]
    v_pk_fma_f32 v[132:133], v[8:9], v[144:145], v[70:71] op_sel_hi:[1,0,0] neg_lo:[1,0,0] neg_hi:[1,0,0]
    v_pk_fma_f32 v[8:9], v[8:9], v[144:145], v[64:65] op_sel_hi:[1,0,0]
    v_pk_fma_f32 v[134:135], v[10:11], v[144:145], v[70:71] op_sel_hi:[1,0,0] neg_lo:[1,0,0] neg_hi:[1,0,0]
    v_pk_fma_f32 v[10:11], v[10:11], v[144:145], v[64:65] op_sel_hi:[1,0,0]
    v_pk_fma_f32 v[136:137], v[12:13], v[144:145], v[70:71] op_sel_hi:[1,0,0] neg_lo:[1,0,0] neg_hi:[1,0,0]
    v_pk_fma_f32 v[12:13], v[12:13], v[144:145], v[64:65] op_sel_hi:[1,0,0]
    v_pk_fma_f32 v[138:139], v[14:15], v[144:145], v[70:71] op_sel_hi:[1,0,0] neg_lo:[1,0,0] neg_hi:[1,0,0]
    v_pk_fma_f32 v[14:15], v[14:15], v[144:145], v[64:65] op_sel_hi:[1,0,0]
    v_pk_fma_f32 v[140:141], v[16:17], v[144:145], v[70:71] op_sel_hi:[1,0,0] neg_lo:[1,0,0] neg_hi:[1,0,0]
    v_pk_fma_f32 v[16:17], v[16:17], v[144:145], v[64:65] op_sel_hi:[1,0,0]
    v_pk_fma_f32 v[142:143], v[18:19], v[144:145], v[70:71] op_sel_hi:[1,0,0] neg_lo:[1,0,0] neg_hi:[1,0,0]
    v_pk_fma_f32 v[18:19], v[18:19], v[144:145], v[64:65] op_sel_hi:[1,0,0]
    buffer_load_dwordx4 v[214:217], v251, s[16:19], s75 offen offset:2048 sc1
    v_exp_f32 v124, v124
    v_exp_f32 v0, v0
    v_exp_f32 v125, v125
    v_exp_f32 v1, v1
    v_exp_f32 v126, v126
    v_exp_f32 v2, v2
    v_exp_f32 v127, v127
    v_exp_f32 v3, v3
    v_exp_f32 v128, v128
    v_exp_f32 v4, v4
    v_exp_f32 v129, v129
    v_exp_f32 v5, v5
    v_exp_f32 v130, v130
    v_exp_f32 v6, v6
    buffer_load_dwordx4 v[218:221], v251, s[16:19], s75 offen offset:3072 sc1
    v_exp_f32 v131, v131
    v_exp_f32 v7, v7
    v_exp_f32 v132, v132
    v_exp_f32 v8, v8
    v_exp_f32 v133, v133
    v_exp_f32 v9, v9
    v_exp_f32 v134, v134
    v_exp_f32 v10, v10
    v_exp_f32 v135, v135
    v_exp_f32 v11, v11
    v_exp_f32 v136, v136
    v_exp_f32 v12, v12
    v_exp_f32 v137, v137
    v_exp_f32 v13, v13
    buffer_load_dwordx4 v[222:225], v252, s[16:19], s75 offen sc1
    s_add_u32 s75, s75, 40960
    v_exp_f32 v138, v138
    v_exp_f32 v14, v14
    v_exp_f32 v139, v139
    v_exp_f32 v15, v15
    v_exp_f32 v140, v140
    v_exp_f32 v16, v16
    v_exp_f32 v141, v141
    v_exp_f32 v17, v17
    v_exp_f32 v142, v142
    v_exp_f32 v18, v18
    v_exp_f32 v143, v143
    v_exp_f32 v19, v19
    v_pk_add_f32 v[66:67], v[0:1], v[2:3]
    v_pk_add_f32 v[68:69], v[124:125], v[126:127]
    buffer_load_dwordx4 v[146:149], v251, s[16:19], s75 offen offset:0 sc1
    v_pk_add_f32 v[66:67], v[66:67], v[4:5]
    v_pk_add_f32 v[68:69], v[68:69], v[128:129]
    v_pk_add_f32 v[66:67], v[66:67], v[6:7]
    v_pk_add_f32 v[68:69], v[68:69], v[130:131]
    v_pk_add_f32 v[66:67], v[66:67], v[8:9]
    v_pk_add_f32 v[68:69], v[68:69], v[132:133]
    v_pk_add_f32 v[66:67], v[66:67], v[10:11]
    v_pk_add_f32 v[68:69], v[68:69], v[134:135]
    v_pk_add_f32 v[66:67], v[66:67], v[12:13]
    v_pk_add_f32 v[68:69], v[68:69], v[136:137]
    v_pk_add_f32 v[66:67], v[66:67], v[14:15]
    v_pk_add_f32 v[68:69], v[68:69], v[138:139]
    v_pk_add_f32 v[66:67], v[66:67], v[16:17]
    v_pk_add_f32 v[68:69], v[68:69], v[140:141]
    buffer_load_dwordx4 v[150:153], v251, s[16:19], s75 offen offset:1024 sc1
    v_pk_add_f32 v[66:67], v[66:67], v[18:19]
    v_pk_add_f32 v[68:69], v[68:69], v[142:143]
    v_add_f32 v66, v66, v67
    v_add_f32 v68, v68, v69
    v_rcp_f32 v66, v66
    v_rcp_f32 v68, v68
    v_pk_mul_f32 v[0:1], v[0:1], v[66:67] op_sel_hi:[1,0]
    v_pk_mul_f32 v[124:125], v[124:125], v[68:69] op_sel_hi:[1,0]
    v_pk_mul_f32 v[2:3], v[2:3], v[66:67] op_sel_hi:[1,0]
    v_pk_mul_f32 v[126:127], v[126:127], v[68:69] op_sel_hi:[1,0]
    v_pk_mul_f32 v[4:5], v[4:5], v[66:67] op_sel_hi:[1,0]
    v_pk_mul_f32 v[128:129], v[128:129], v[68:69] op_sel_hi:[1,0]
    v_pk_mul_f32 v[6:7], v[6:7], v[66:67] op_sel_hi:[1,0]
    v_pk_mul_f32 v[130:131], v[130:131], v[68:69] op_sel_hi:[1,0]
    buffer_load_dwordx4 v[154:157], v251, s[16:19], s75 offen offset:2048 sc1
    v_pk_mul_f32 v[8:9], v[8:9], v[66:67] op_sel_hi:[1,0]
    v_pk_mul_f32 v[132:133], v[132:133], v[68:69] op_sel_hi:[1,0]
    v_pk_mul_f32 v[10:11], v[10:11], v[66:67] op_sel_hi:[1,0]
    v_pk_mul_f32 v[134:135], v[134:135], v[68:69] op_sel_hi:[1,0]
    v_pk_mul_f32 v[12:13], v[12:13], v[66:67] op_sel_hi:[1,0]
    v_pk_mul_f32 v[136:137], v[136:137], v[68:69] op_sel_hi:[1,0]
    v_pk_mul_f32 v[14:15], v[14:15], v[66:67] op_sel_hi:[1,0]
    v_pk_mul_f32 v[138:139], v[138:139], v[68:69] op_sel_hi:[1,0]
    v_pk_mul_f32 v[16:17], v[16:17], v[66:67] op_sel_hi:[1,0]
    v_pk_mul_f32 v[140:141], v[140:141], v[68:69] op_sel_hi:[1,0]
    v_pk_mul_f32 v[18:19], v[18:19], v[66:67] op_sel_hi:[1,0]
    v_pk_mul_f32 v[142:143], v[142:143], v[68:69] op_sel_hi:[1,0]
    v_cvt_pk_bf16_f32 v80, v0, v1
    v_cvt_pk_bf16_f32 v81, v2, v3
    buffer_load_dwordx4 v[158:161], v251, s[16:19], s75 offen offset:3072 sc1
    v_cvt_pk_bf16_f32 v82, v4, v5
    v_cvt_pk_bf16_f32 v83, v6, v7
    ds_write_b128 v247, v[80:83] offset:0
    v_cvt_pk_bf16_f32 v84, v16, v17
    v_cvt_pk_bf16_f32 v85, v124, v125
    v_cvt_pk_bf16_f32 v86, v126, v127
    v_cvt_pk_bf16_f32 v87, v128, v129
    ds_write_b128 v247, v[84:87] offset:16
    v_cvt_pk_bf16_f32 v88, v130, v131
    v_cvt_pk_bf16_f32 v89, v140, v141
    v_cvt_pk_bf16_f32 v90, v8, v9
    v_cvt_pk_bf16_f32 v91, v10, v11
    ds_write_b128 v247, v[88:91] offset:32
    v_cvt_pk_bf16_f32 v92, v12, v13
    v_cvt_pk_bf16_f32 v93, v14, v15
    v_cvt_pk_bf16_f32 v94, v18, v19
    v_cvt_pk_bf16_f32 v95, v132, v133
    buffer_load_dwordx4 v[162:165], v252, s[16:19], s75 offen sc1
    s_add_u32 s75, s75, 40960
    ds_write_b128 v247, v[92:95] offset:48
    v_cvt_pk_bf16_f32 v96, v134, v135
    v_cvt_pk_bf16_f32 v97, v136, v137
    v_cvt_pk_bf16_f32 v98, v138, v139
    v_cvt_pk_bf16_f32 v99, v142, v143
    ds_write_b128 v247, v[96:99] offset:64
    v_max3_f32 v64, v32, v33, v34
    v_min3_f32 v65, v32, v33, v34
    v_max3_f32 v64, v64, v35, v36
    v_min3_f32 v65, v65, v35, v36
    v_max3_f32 v64, v64, v37, v38
    v_min3_f32 v65, v65, v37, v38
    v_max3_f32 v64, v64, v39, v40
    v_min3_f32 v65, v65, v39, v40
    v_max3_f32 v64, v64, v41, v42
    v_min3_f32 v65, v65, v41, v42
    v_max3_f32 v64, v64, v43, v44
    v_min3_f32 v65, v65, v43, v44
    v_max3_f32 v64, v64, v45, v46
    v_min3_f32 v65, v65, v45, v46
    v_max3_f32 v64, v64, v47, v48
    v_min3_f32 v65, v65, v47, v48
    v_max3_f32 v64, v64, v49, v50
    v_min3_f32 v65, v65, v49, v50
    v_max_f32 v64, v64, v51
    v_min_f32 v65, v65, v51
    v_mul_f32 v64, v145, v64
    v_mul_f32 v70, v144, v65
    v_pk_fma_f32 v[124:125], v[32:33], v[144:145], v[70:71] op_sel_hi:[1,0,0] neg_lo:[1,0,0] neg_hi:[1,0,0]
    v_pk_fma_f32 v[32:33], v[32:33], v[144:145], v[64:65] op_sel_hi:[1,0,0]
    v_pk_fma_f32 v[126:127], v[34:35], v[144:145], v[70:71] op_sel_hi:[1,0,0] neg_lo:[1,0,0] neg_hi:[1,0,0]
    v_pk_fma_f32 v[34:35], v[34:35], v[144:145], v[64:65] op_sel_hi:[1,0,0]
    v_pk_fma_f32 v[128:129], v[36:37], v[144:145], v[70:71] op_sel_hi:[1,0,0] neg_lo:[1,0,0] neg_hi:[1,0,0]
    v_pk_fma_f32 v[36:37], v[36:37], v[144:145], v[64:65] op_sel_hi:[1,0,0]
    v_pk_fma_f32 v[130:131], v[38:39], v[144:145], v[70:71] op_sel_hi:[1,0,0] neg_lo:[1,0,0] neg_hi:[1,0,0]
    v_pk_fma_f32 v[38:39], v[38:39], v[144:145], v[64:65] op_sel_hi:[1,0,0]
    v_pk_fma_f32 v[132:133], v[40:41], v[144:145], v[70:71] op_sel_hi:[1,0,0] neg_lo:[1,0,0] neg_hi:[1,0,0]
    v_pk_fma_f32 v[40:41], v[40:41], v[144:145], v[64:65] op_sel_hi:[1,0,0]
    v_pk_fma_f32 v[134:135], v[42:43], v[144:145], v[70:71] op_sel_hi:[1,0,0] neg_lo:[1,0,0] neg_hi:[1,0,0]
    v_pk_fma_f32 v[42:43], v[42:43], v[144:145], v[64:65] op_sel_hi:[1,0,0]
    v_pk_fma_f32 v[136:137], v[44:45], v[144:145], v[70:71] op_sel_hi:[1,0,0] neg_lo:[1,0,0] neg_hi:[1,0,0]
    v_pk_fma_f32 v[44:45], v[44:45], v[144:145], v[64:65] op_sel_hi:[1,0,0]
    v_pk_fma_f32 v[138:139], v[46:47], v[144:145], v[70:71] op_sel_hi:[1,0,0] neg_lo:[1,0,0] neg_hi:[1,0,0]
    v_pk_fma_f32 v[46:47], v[46:47], v[144:145], v[64:65] op_sel_hi:[1,0,0]
    v_pk_fma_f32 v[140:141], v[48:49], v[144:145], v[70:71] op_sel_hi:[1,0,0] neg_lo:[1,0,0] neg_hi:[1,0,0]
    v_pk_fma_f32 v[48:49], v[48:49], v[144:145], v[64:65] op_sel_hi:[1,0,0]
    v_pk_fma_f32 v[142:143], v[50:51], v[144:145], v[70:71] op_sel_hi:[1,0,0] neg_lo:[1,0,0] neg_hi:[1,0,0]
    v_pk_fma_f32 v[50:51], v[50:51], v[144:145], v[64:65] op_sel_hi:[1,0,0]
    v_exp_f32 v124, v124
    v_exp_f32 v32, v32
    v_exp_f32 v125, v125
    v_exp_f32 v33, v33
    v_exp_f32 v126, v126
    v_exp_f32 v34, v34
    v_exp_f32 v127, v127
    v_exp_f32 v35, v35
    v_exp_f32 v128, v128
    v_exp_f32 v36, v36
    v_exp_f32 v129, v129
    v_exp_f32 v37, v37
    v_exp_f32 v130, v130
    v_exp_f32 v38, v38
    v_exp_f32 v131, v131
    v_exp_f32 v39, v39
    v_exp_f32 v132, v132
    v_exp_f32 v40, v40
    v_exp_f32 v133, v133
    v_exp_f32 v41, v41
    v_exp_f32 v134, v134
    v_exp_f32 v42, v42
    v_exp_f32 v135, v135
    v_exp_f32 v43, v43
    v_exp_f32 v136, v136
    v_exp_f32 v44, v44
    v_exp_f32 v137, v137
    v_exp_f32 v45, v45
    v_exp_f32 v138, v138
    v_exp_f32 v46, v46
    v_exp_f32 v139, v139
    v_exp_f32 v47, v47
    v_exp_f32 v140, v140
    v_exp_f32 v48, v48
    v_exp_f32 v141, v141
    v_exp_f32 v49, v49
    v_exp_f32 v142, v142
    v_exp_f32 v50, v50
    v_exp_f32 v143, v143
    v_exp_f32 v51, v51
    v_pk_add_f32 v[66:67], v[32:33], v[34:35]
    v_pk_add_f32 v[68:69], v[124:125], v[126:127]
    v_pk_add_f32 v[66:67], v[66:67], v[36:37]
    v_pk_add_f32 v[68:69], v[68:69], v[128:129]
    v_pk_add_f32 v[66:67], v[66:67], v[38:39]
    v_pk_add_f32 v[68:69], v[68:69], v[130:131]
    v_pk_add_f32 v[66:67], v[66:67], v[40:41]
    v_pk_add_f32 v[68:69], v[68:69], v[132:133]
    v_pk_add_f32 v[66:67], v[66:67], v[42:43]
    v_pk_add_f32 v[68:69], v[68:69], v[134:135]
    v_pk_add_f32 v[66:67], v[66:67], v[44:45]
    v_pk_add_f32 v[68:69], v[68:69], v[136:137]
    v_pk_add_f32 v[66:67], v[66:67], v[46:47]
    v_pk_add_f32 v[68:69], v[68:69], v[138:139]
    v_pk_add_f32 v[66:67], v[66:67], v[48:49]
    v_pk_add_f32 v[68:69], v[68:69], v[140:141]
    v_pk_add_f32 v[66:67], v[66:67], v[50:51]
    v_pk_add_f32 v[68:69], v[68:69], v[142:143]
    v_add_f32 v66, v66, v67
    v_add_f32 v68, v68, v69
    v_rcp_f32 v66, v66
    v_rcp_f32 v68, v68
    v_pk_mul_f32 v[32:33], v[32:33], v[66:67] op_sel_hi:[1,0]
    v_pk_mul_f32 v[124:125], v[124:125], v[68:69] op_sel_hi:[1,0]
    v_pk_mul_f32 v[34:35], v[34:35], v[66:67] op_sel_hi:[1,0]
    v_pk_mul_f32 v[126:127], v[126:127], v[68:69] op_sel_hi:[1,0]
    v_pk_mul_f32 v[36:37], v[36:37], v[66:67] op_sel_hi:[1,0]
    v_pk_mul_f32 v[128:129], v[128:129], v[68:69] op_sel_hi:[1,0]
    v_pk_mul_f32 v[38:39], v[38:39], v[66:67] op_sel_hi:[1,0]
    v_pk_mul_f32 v[130:131], v[130:131], v[68:69] op_sel_hi:[1,0]
    v_pk_mul_f32 v[40:41], v[40:41], v[66:67] op_sel_hi:[1,0]
    v_pk_mul_f32 v[132:133], v[132:133], v[68:69] op_sel_hi:[1,0]
    v_pk_mul_f32 v[42:43], v[42:43], v[66:67] op_sel_hi:[1,0]
    v_pk_mul_f32 v[134:135], v[134:135], v[68:69] op_sel_hi:[1,0]
    v_pk_mul_f32 v[44:45], v[44:45], v[66:67] op_sel_hi:[1,0]
    v_pk_mul_f32 v[136:137], v[136:137], v[68:69] op_sel_hi:[1,0]
    v_pk_mul_f32 v[46:47], v[46:47], v[66:67] op_sel_hi:[1,0]
    v_pk_mul_f32 v[138:139], v[138:139], v[68:69] op_sel_hi:[1,0]
    v_pk_mul_f32 v[48:49], v[48:49], v[66:67] op_sel_hi:[1,0]
    v_pk_mul_f32 v[140:141], v[140:141], v[68:69] op_sel_hi:[1,0]
    v_pk_mul_f32 v[50:51], v[50:51], v[66:67] op_sel_hi:[1,0]
    v_pk_mul_f32 v[142:143], v[142:143], v[68:69] op_sel_hi:[1,0]
    v_cvt_pk_bf16_f32 v80, v32, v33
    v_cvt_pk_bf16_f32 v81, v34, v35
    v_cvt_pk_bf16_f32 v82, v36, v37
    v_cvt_pk_bf16_f32 v83, v38, v39
    ds_write_b128 v247, v[80:83] offset:18432
    v_cvt_pk_bf16_f32 v84, v48, v49
    v_cvt_pk_bf16_f32 v85, v124, v125
    v_cvt_pk_bf16_f32 v86, v126, v127
    v_cvt_pk_bf16_f32 v87, v128, v129
    ds_write_b128 v247, v[84:87] offset:18448
    v_cvt_pk_bf16_f32 v88, v130, v131
    v_cvt_pk_bf16_f32 v89, v140, v141
    v_cvt_pk_bf16_f32 v90, v40, v41
    v_cvt_pk_bf16_f32 v91, v42, v43
    ds_write_b128 v247, v[88:91] offset:18464
    v_cvt_pk_bf16_f32 v92, v44, v45
    v_cvt_pk_bf16_f32 v93, v46, v47
    v_cvt_pk_bf16_f32 v94, v50, v51
    v_cvt_pk_bf16_f32 v95, v132, v133
    ds_write_b128 v247, v[92:95] offset:18480
    v_cvt_pk_bf16_f32 v96, v134, v135
    v_cvt_pk_bf16_f32 v97, v136, v137
    v_cvt_pk_bf16_f32 v98, v138, v139
    v_cvt_pk_bf16_f32 v99, v142, v143
    ds_write_b128 v247, v[96:99] offset:18496
    v_bfe_u32 v64, v250, 2, 2
    v_lshrrev_b32 v65, 5, v250
    v_lshl_add_u32 v64, v65, 3, v64
    v_mul_u32_u24 v64, 144, v64
    v_and_b32 v66, 3, v250
    v_bfe_u32 v67, v250, 4, 1
    v_lshl_add_u32 v66, v67, 2, v66
    v_lshl_add_u32 v64, v66, 3, v64
    s_mul_i32 s3, s40, 18432
    v_add_u32 v246, s3, v64
    v_and_b32 v66, 31, v250
    v_mul_u32_u24 v65, 24, v65
    v_add_u32 v65, v65, v66
    v_lshlrev_b32 v67, 3, v65
    v_lshlrev_b32 v65, 4, v65
    v_cmp_gt_u32 vcc, 24, v66
    s_nop 1
    v_cndmask_b32 v247, v255, v65, vcc
    v_cndmask_b32 v145, v255, v67, vcc
    s_lshl_b32 s3, s26, 3
    s_add_u32 s3, s3, s40
    s_lshl_b32 s3, s3, 4
    s_add_u32 s3, s3, s25
    s_mul_i32 s3, s3, 1920
    s_add_u32 s3, s3, 17825792
    s_waitcnt lgkmcnt(0)
    s_barrier
    ds_read_b64_tr_b16 v[32:33], v246 offset:0
    ds_read_b64_tr_b16 v[34:35], v246 offset:576
    ds_read_b64_tr_b16 v[36:37], v246 offset:64
    ds_read_b64_tr_b16 v[38:39], v246 offset:640
    ds_read_b64_tr_b16 v[40:41], v246 offset:80
    ds_read_b64_tr_b16 v[42:43], v246 offset:656
    ds_read_b64_tr_b16 v[44:45], v246 offset:2304
    ds_read_b64_tr_b16 v[46:47], v246 offset:2880
    ds_read_b64_tr_b16 v[48:49], v246 offset:2368
    ds_read_b64_tr_b16 v[50:51], v246 offset:2944
    ds_read_b64_tr_b16 v[52:53], v246 offset:2384
    ds_read_b64_tr_b16 v[54:55], v246 offset:2960
    s_waitcnt lgkmcnt(6)
    v_mfma_f32_32x32x16_bf16 v[0:15], v[32:35], v[40:43], 0
    v_mfma_f32_32x32x16_bf16 v[16:31], v[36:39], v[40:43], 0
    ds_read_b64_tr_b16 v[56:57], v246 offset:4608
    ds_read_b64_tr_b16 v[58:59], v246 offset:5184
    ds_read_b64_tr_b16 v[60:61], v246 offset:4672
    ds_read_b64_tr_b16 v[62:63], v246 offset:5248
    ds_read_b64_tr_b16 v[64:65], v246 offset:4688
    ds_read_b64_tr_b16 v[66:67], v246 offset:5264
    s_waitcnt lgkmcnt(6)
    v_mfma_f32_32x32x16_bf16 v[0:15], v[44:47], v[52:55], v[0:15]
    v_mfma_f32_32x32x16_bf16 v[16:31], v[48:51], v[52:55], v[16:31]
    ds_read_b64_tr_b16 v[68:69], v246 offset:6912
    ds_read_b64_tr_b16 v[70:71], v246 offset:7488
    ds_read_b64_tr_b16 v[72:73], v246 offset:6976
    ds_read_b64_tr_b16 v[74:75], v246 offset:7552
    ds_read_b64_tr_b16 v[76:77], v246 offset:6992
    ds_read_b64_tr_b16 v[78:79], v246 offset:7568
    s_waitcnt lgkmcnt(6)
    v_mfma_f32_32x32x16_bf16 v[0:15], v[56:59], v[64:67], v[0:15]
    v_mfma_f32_32x32x16_bf16 v[16:31], v[60:63], v[64:67], v[16:31]
    ds_read_b64_tr_b16 v[80:81], v246 offset:9216
    ds_read_b64_tr_b16 v[82:83], v246 offset:9792
    ds_read_b64_tr_b16 v[84:85], v246 offset:9280
    ds_read_b64_tr_b16 v[86:87], v246 offset:9856
    ds_read_b64_tr_b16 v[88:89], v246 offset:9296
    ds_read_b64_tr_b16 v[90:91], v246 offset:9872
    s_waitcnt lgkmcnt(6)
    v_mfma_f32_32x32x16_bf16 v[0:15], v[68:71], v[76:79], v[0:15]
    v_mfma_f32_32x32x16_bf16 v[16:31], v[72:75], v[76:79], v[16:31]
    ds_read_b64_tr_b16 v[92:93], v246 offset:11520
    ds_read_b64_tr_b16 v[94:95], v246 offset:12096
    ds_read_b64_tr_b16 v[96:97], v246 offset:11584
    ds_read_b64_tr_b16 v[98:99], v246 offset:12160
    ds_read_b64_tr_b16 v[100:101], v246 offset:11600
    ds_read_b64_tr_b16 v[102:103], v246 offset:12176
    s_waitcnt lgkmcnt(6)
    v_mfma_f32_32x32x16_bf16 v[0:15], v[80:83], v[88:91], v[0:15]
    v_mfma_f32_32x32x16_bf16 v[16:31], v[84:87], v[88:91], v[16:31]
    ds_read_b64_tr_b16 v[104:105], v246 offset:13824
    ds_read_b64_tr_b16 v[106:107], v246 offset:14400
    ds_read_b64_tr_b16 v[108:109], v246 offset:13888
    ds_read_b64_tr_b16 v[110:111], v246 offset:14464
    ds_read_b64_tr_b16 v[112:113], v246 offset:13904
    ds_read_b64_tr_b16 v[114:115], v246 offset:14480
    s_waitcnt lgkmcnt(6)
    v_mfma_f32_32x32x16_bf16 v[0:15], v[92:95], v[100:103], v[0:15]
    v_mfma_f32_32x32x16_bf16 v[16:31], v[96:99], v[100:103], v[16:31]
    ds_read_b64_tr_b16 v[116:117], v246 offset:16128
    ds_read_b64_tr_b16 v[118:119], v246 offset:16704
    ds_read_b64_tr_b16 v[120:121], v246 offset:16192
    ds_read_b64_tr_b16 v[122:123], v246 offset:16768
    ds_read_b64_tr_b16 v[124:125], v246 offset:16208
    ds_read_b64_tr_b16 v[126:127], v246 offset:16784
    s_waitcnt lgkmcnt(6)
    v_mfma_f32_32x32x16_bf16 v[0:15], v[104:107], v[112:115], v[0:15]
    v_mfma_f32_32x32x16_bf16 v[16:31], v[108:111], v[112:115], v[16:31]
    s_waitcnt lgkmcnt(0)
    v_mfma_f32_32x32x16_bf16 v[0:15], v[116:119], v[124:127], v[0:15]
    v_mfma_f32_32x32x16_bf16 v[16:31], v[120:123], v[124:127], v[16:31]
    s_nop 10
    v_cvt_pk_bf16_f32 v32, v0, v1
    v_cvt_pk_bf16_f32 v33, v2, v3
    v_cvt_pk_bf16_f32 v34, v4, v5
    v_cvt_pk_bf16_f32 v35, v6, v7
    buffer_store_dwordx4 v[32:35], v247, s[16:19], s3 offen offset:0 sc1
    v_cvt_pk_bf16_f32 v36, v8, v9
    v_cvt_pk_bf16_f32 v37, v10, v11
    v_cvt_pk_bf16_f32 v38, v12, v13
    v_cvt_pk_bf16_f32 v39, v14, v15
    buffer_store_dwordx4 v[36:39], v247, s[16:19], s3 offen offset:768 sc1
    v_cvt_pk_bf16_f32 v40, v16, v17
    v_cvt_pk_bf16_f32 v41, v18, v19
    buffer_store_dwordx2 v[40:41], v145, s[16:19], s3 offen offset:1536 sc1
    s_branch KF_PUB
KF_QEPI:
    v_lshrrev_b32 v80, 5, v250
    v_and_b32 v81, 31, v250
    v_lshlrev_b32 v82, 19, v80
    v_lshl_add_u32 v144, v81, 4, v82
    v_lshlrev_b32 v82, 17, v80
    v_lshl_add_u32 v145, v81, 3, v82
    s_lshl_b32 s3, s26, 2
    s_add_u32 s3, s3, s51
    s_lshl_b32 s3, s3, 8
    s_lshl_b32 s4, s25, 2
    s_add_u32 s4, s4, s45
    s_add_u32 s3, s3, s4
    s_lshl_b32 s5, s3, 10
    s_add_u32 s5, s5, 14680064
    s_lshl_b32 s6, s3, 8
    s_add_u32 s6, s6, 16777216
    v_mul_f32 v0, v246, v0
    v_mul_f32 v1, v246, v1
    v_mul_f32 v2, v246, v2
    v_mul_f32 v3, v246, v3
    v_mul_f32 v4, v246, v4
    v_mul_f32 v5, v246, v5
    v_mul_f32 v6, v246, v6
    v_mul_f32 v7, v246, v7
    v_mul_f32 v8, v246, v8
    v_mul_f32 v9, v246, v9
    v_mul_f32 v10, v246, v10
    v_mul_f32 v11, v246, v11
    v_mul_f32 v12, v246, v12
    v_mul_f32 v13, v246, v13
    v_mul_f32 v14, v246, v14
    v_mul_f32 v15, v246, v15
    v_mul_f32 v16, v246, v16
    v_mul_f32 v17, v246, v17
    v_mul_f32 v18, v246, v18
    v_mul_f32 v19, v246, v19
    v_cvt_pk_bf16_f32 v100, v0, v1
    v_cvt_pk_bf16_f32 v101, v2, v3
    v_cvt_pk_bf16_f32 v102, v4, v5
    v_cvt_pk_bf16_f32 v103, v6, v7
    v_cvt_pk_bf16_f32 v104, v8, v9
    v_cvt_pk_bf16_f32 v105, v10, v11
    v_cvt_pk_bf16_f32 v106, v12, v13
    v_cvt_pk_bf16_f32 v107, v14, v15
    v_cvt_pk_bf16_f32 v108, v16, v17
    v_cvt_pk_bf16_f32 v109, v18, v19
    buffer_store_dwordx4 v[100:103], v144, s[16:19], s5 offen sc1
    buffer_store_dwordx4 v[104:107], v144, s[16:19], s5 offen offset:512 sc1
    buffer_store_dwordx2 v[108:109], v145, s[16:19], s6 offen sc1
    s_add_u32 s5, s5, 65536
    s_add_u32 s6, s6, 16384
    v_mul_f32 v20, v246, v20
    v_mul_f32 v21, v246, v21
    v_mul_f32 v22, v246, v22
    v_mul_f32 v23, v246, v23
    v_mul_f32 v24, v246, v24
    v_mul_f32 v25, v246, v25
    v_mul_f32 v26, v246, v26
    v_mul_f32 v27, v246, v27
    v_mul_f32 v28, v246, v28
    v_mul_f32 v29, v246, v29
    v_mul_f32 v30, v246, v30
    v_mul_f32 v31, v246, v31
    v_mul_f32 v32, v246, v32
    v_mul_f32 v33, v246, v33
    v_mul_f32 v34, v246, v34
    v_mul_f32 v35, v246, v35
    v_mul_f32 v36, v246, v36
    v_mul_f32 v37, v246, v37
    v_mul_f32 v38, v246, v38
    v_mul_f32 v39, v246, v39
    v_cvt_pk_bf16_f32 v110, v20, v21
    v_cvt_pk_bf16_f32 v111, v22, v23
    v_cvt_pk_bf16_f32 v112, v24, v25
    v_cvt_pk_bf16_f32 v113, v26, v27
    v_cvt_pk_bf16_f32 v114, v28, v29
    v_cvt_pk_bf16_f32 v115, v30, v31
    v_cvt_pk_bf16_f32 v116, v32, v33
    v_cvt_pk_bf16_f32 v117, v34, v35
    v_cvt_pk_bf16_f32 v118, v36, v37
    v_cvt_pk_bf16_f32 v119, v38, v39
    buffer_store_dwordx4 v[110:113], v144, s[16:19], s5 offen sc1
    buffer_store_dwordx4 v[114:117], v144, s[16:19], s5 offen offset:512 sc1
    buffer_store_dwordx2 v[118:119], v145, s[16:19], s6 offen sc1
    s_add_u32 s5, s5, 65536
    s_add_u32 s6, s6, 16384
    v_mul_f32 v40, v246, v40
    v_mul_f32 v41, v246, v41
    v_mul_f32 v42, v246, v42
    v_mul_f32 v43, v246, v43
    v_mul_f32 v44, v246, v44
    v_mul_f32 v45, v246, v45
    v_mul_f32 v46, v246, v46
    v_mul_f32 v47, v246, v47
    v_mul_f32 v48, v246, v48
    v_mul_f32 v49, v246, v49
    v_mul_f32 v50, v246, v50
    v_mul_f32 v51, v246, v51
    v_mul_f32 v52, v246, v52
    v_mul_f32 v53, v246, v53
    v_mul_f32 v54, v246, v54
    v_mul_f32 v55, v246, v55
    v_mul_f32 v56, v246, v56
    v_mul_f32 v57, v246, v57
    v_mul_f32 v58, v246, v58
    v_mul_f32 v59, v246, v59
    v_cvt_pk_bf16_f32 v120, v40, v41
    v_cvt_pk_bf16_f32 v121, v42, v43
    v_cvt_pk_bf16_f32 v122, v44, v45
    v_cvt_pk_bf16_f32 v123, v46, v47
    v_cvt_pk_bf16_f32 v124, v48, v49
    v_cvt_pk_bf16_f32 v125, v50, v51
    v_cvt_pk_bf16_f32 v126, v52, v53
    v_cvt_pk_bf16_f32 v127, v54, v55
    v_cvt_pk_bf16_f32 v128, v56, v57
    v_cvt_pk_bf16_f32 v129, v58, v59
    buffer_store_dwordx4 v[120:123], v144, s[16:19], s5 offen sc1
    buffer_store_dwordx4 v[124:127], v144, s[16:19], s5 offen offset:512 sc1
    buffer_store_dwordx2 v[128:129], v145, s[16:19], s6 offen sc1
    s_add_u32 s5, s5, 65536
    s_add_u32 s6, s6, 16384
    v_mul_f32 v60, v246, v60
    v_mul_f32 v61, v246, v61
    v_mul_f32 v62, v246, v62
    v_mul_f32 v63, v246, v63
    v_mul_f32 v64, v246, v64
    v_mul_f32 v65, v246, v65
    v_mul_f32 v66, v246, v66
    v_mul_f32 v67, v246, v67
    v_mul_f32 v68, v246, v68
    v_mul_f32 v69, v246, v69
    v_mul_f32 v70, v246, v70
    v_mul_f32 v71, v246, v71
    v_mul_f32 v72, v246, v72
    v_mul_f32 v73, v246, v73
    v_mul_f32 v74, v246, v74
    v_mul_f32 v75, v246, v75
    v_mul_f32 v76, v246, v76
    v_mul_f32 v77, v246, v77
    v_mul_f32 v78, v246, v78
    v_mul_f32 v79, v246, v79
    v_cvt_pk_bf16_f32 v130, v60, v61
    v_cvt_pk_bf16_f32 v131, v62, v63
    v_cvt_pk_bf16_f32 v132, v64, v65
    v_cvt_pk_bf16_f32 v133, v66, v67
    v_cvt_pk_bf16_f32 v134, v68, v69
    v_cvt_pk_bf16_f32 v135, v70, v71
    v_cvt_pk_bf16_f32 v136, v72, v73
    v_cvt_pk_bf16_f32 v137, v74, v75
    v_cvt_pk_bf16_f32 v138, v76, v77
    v_cvt_pk_bf16_f32 v139, v78, v79
    buffer_store_dwordx4 v[130:133], v144, s[16:19], s5 offen sc1
    buffer_store_dwordx4 v[134:137], v144, s[16:19], s5 offen offset:512 sc1
    buffer_store_dwordx2 v[138:139], v145, s[16:19], s6 offen sc1
    s_add_u32 s5, s5, 65536
    s_add_u32 s6, s6, 16384
    s_branch KF_PUB
KF_SPARE:
    s_mov_b32 s12, s54
    s_mov_b32 s13, s55
    s_mov_b32 s14, 2457600
    s_mov_b32 s15, 0x00020000
    s_mov_b32 s36, s54
    s_mov_b32 s37, s55
    s_mov_b32 s38, 2457600
    s_mov_b32 s39, 0x00020000
    s_mov_b32 s16, s72
    s_mov_b32 s17, s73
    s_mov_b32 s18, 20971520
    s_mov_b32 s19, 0x00020000
    s_mov_b32 s20, s70
    s_mov_b32 s21, s71
    s_mov_b32 s22, 256
    s_mov_b32 s23, 0x00020000
    s_mov_b32 s32, s56
    s_mov_b32 s33, s57
    s_mov_b32 s34, 25600
    s_mov_b32 s35, 0x00020000
    s_lshr_b32 s52, s31, 8
    s_and_b32 s31, s31, 0xff
    s_lshr_b32 s0, s29, 8
    s_and_b32 s29, s29, 0xff
    s_mov_b32 s32, s54
    s_mov_b32 s33, s55
    s_mov_b32 s34, 2457600
    s_mov_b32 s35, 0x00020000
    s_or_b32 s3, s25, s40
    s_cmp_lg_u32 s3, 0
    s_cbranch_scc1 KF_NOTOK
    s_memrealtime s[4:5]
    s_waitcnt lgkmcnt(0)
    s_mul_i32 s5, s5, 0x9e3779b1
    s_xor_b32 s4, s4, s5
    s_or_b32 s4, s4, 1
    v_mov_b32 v1, s4
    s_mov_b64 exec, 1
    buffer_store_dword v1, v254, s[20:23], 0 offen sc1
    s_mov_b64 exec, -1
KF_NOTOK:
    s_getpc_b64 s[4:5]
KF_PCW1:
    s_sub_u32 s4, s4, KF_PCW1-recurrent_scan__linear_kernel_hedgehog__glu_gated_geglu__prompt_kernel
    s_subb_u32 s5, s5, 0
    s_and_b32 s3, s25, 1
    s_lshl_b32 s3, s3, 3
    s_add_u32 s3, s3, s40
    s_lshl_b32 s3, s3, 10
    v_add_u32 v1, s3, v251
    s_mov_b32 s6, KF_TAB-recurrent_scan__linear_kernel_hedgehog__glu_gated_geglu__prompt_kernel-16
    v_min_u32 v2, s6, v1
    global_load_dwordx4 v[232:235], v2, s[4:5]
    v_add_u32 v1, 16384, v1
    v_min_u32 v2, s6, v1
    global_load_dwordx4 v[232:235], v2, s[4:5]
    v_add_u32 v1, 16384, v1
    s_bfe_u32 s3, s27, 0x80010
    s_lshl_b32 s3, s3, 3
    s_lshl_b32 s5, s25, 7
    s_add_u32 s5, s5, s3
    s_add_u32 s44, s5, s40
    s_mul_i32 s3, s44, 1280
    buffer_load_dwordx4 v[166:169], v251, s[8:11], s3 offen
    buffer_load_dword v170, v177, s[8:11], s3 offen offset:1024
    s_mov_b32 s60, 3840
    s_sub_u32 s3, s26, 9
    s_lshl_b32 s45, s3, 2
    s_min_u32 s4, s3, 2
    s_add_u32 s45, s45, s4
    s_add_u32 s51, s45, 3
    s_lshl_b32 s4, s45, 7
    s_add_u32 s5, s4, 384
    s_cmp_lt_u32 s3, 2
    s_cselect_b32 s74, 5, 4
    s_cmp_ge_u32 s26, 9
    s_cbranch_scc1 KF_SP2
    s_mov_b32 s60, 3456
    s_mov_b32 s12, s62
    s_mov_b32 s13, s63
    s_mov_b32 s14, 2211840
    s_mov_b32 s32, s64
    s_mov_b32 s33, s65
    s_mov_b32 s34, 2211840
    s_mul_i32 s3, s26, 3
    s_add_u32 s45, s3, 30
    s_add_u32 s51, s3, 57
    s_lshl_b32 s4, s3, 7
    s_mov_b32 s5, s4
    s_mov_b32 s74, 6
KF_SP2:
    v_lshrrev_b32 v1, 3, v250
    s_lshl_b32 s3, s40, 3
    v_add_u32 v1, s3, v1
    v_mul_u32_u24 v1, s60, v1
    v_and_b32 v2, 7, v250
    v_lshl_add_u32 v1, v2, 4, v1
    v_add_u32 v246, s4, v1
    v_add_u32 v247, s5, v1
    s_lshl_b32 s61, s60, 6
    s_mul_i32 s41, s61, 9
    v_and_b32 v1, 1, v250
    v_lshlrev_b32 v1, 4, v1
    v_mov_b32 v2, 0x3f80
    v_lshlrev_b32 v1, v1, v2
    v_bfe_u32 v2, v250, 1, 3
    v_cmp_eq_u32 vcc, 0, v2
    s_nop 1
    v_cndmask_b32 v28, 0, v1, vcc
    v_cmp_eq_u32 vcc, 1, v2
    s_nop 1
    v_cndmask_b32 v29, 0, v1, vcc
    v_cmp_eq_u32 vcc, 2, v2
    s_nop 1
    v_cndmask_b32 v30, 0, v1, vcc
    v_cmp_eq_u32 vcc, 3, v2
    s_nop 1
    v_cndmask_b32 v31, 0, v1, vcc
    v_mov_b32 v4, 0
    v_mov_b32 v5, 0
    v_mov_b32 v6, 0
    v_mov_b32 v7, 0
    v_mov_b32 v8, 0
    v_mov_b32 v9, 0
    v_mov_b32 v10, 0
    v_mov_b32 v11, 0
    v_mov_b32 v12, 0
    v_mov_b32 v13, 0
    v_mov_b32 v14, 0
    v_mov_b32 v15, 0
    v_mov_b32 v16, 0
    v_mov_b32 v17, 0
    v_mov_b32 v18, 0
    v_mov_b32 v19, 0
    v_mov_b32 v20, 0
    v_mov_b32 v21, 0
    v_mov_b32 v22, 0
    v_mov_b32 v23, 0
    v_mov_b32 v24, 0
    v_mov_b32 v25, 0
    v_mov_b32 v26, 0
    v_mov_b32 v27, 0
    s_cmp_eq_u32 s74, 5
    s_cbranch_scc1 KF_S5
    s_cmp_eq_u32 s74, 4
    s_cbranch_scc1 KF_S4L
    buffer_load_dwordx4 v[32:35], v246, s[12:15], s41 offen offset:0
    buffer_load_dwordx4 v[36:39], v246, s[12:15], s41 offen offset:128
    buffer_load_dwordx4 v[40:43], v246, s[12:15], s41 offen offset:256
    buffer_load_dwordx4 v[44:47], v247, s[32:35], s41 offen offset:0
    buffer_load_dwordx4 v[48:51], v247, s[32:35], s41 offen offset:128
    buffer_load_dwordx4 v[52:55], v247, s[32:35], s41 offen offset:256
    s_sub_u32 s41, s41, s61
    buffer_load_dwordx4 v[56:59], v246, s[12:15], s41 offen offset:0
    buffer_load_dwordx4 v[60:63], v246, s[12:15], s41 offen offset:128
    buffer_load_dwordx4 v[64:67], v246, s[12:15], s41 offen offset:256
    buffer_load_dwordx4 v[68:71], v247, s[32:35], s41 offen offset:0
    buffer_load_dwordx4 v[72:75], v247, s[32:35], s41 offen offset:128
    buffer_load_dwordx4 v[76:79], v247, s[32:35], s41 offen offset:256
    s_sub_u32 s41, s41, s61
    s_waitcnt vmcnt(12)
    s_branch KF_SM
KF_S5:
    buffer_load_dwordx4 v[32:35], v246, s[12:15], s41 offen offset:0
    buffer_load_dwordx4 v[36:39], v246, s[12:15], s41 offen offset:128
    buffer_load_dwordx4 v[40:43], v246, s[12:15], s41 offen offset:256
    buffer_load_dwordx4 v[44:47], v247, s[32:35], s41 offen offset:0
    buffer_load_dwordx4 v[48:51], v247, s[32:35], s41 offen offset:128
    s_sub_u32 s41, s41, s61
    buffer_load_dwordx4 v[56:59], v246, s[12:15], s41 offen offset:0
    buffer_load_dwordx4 v[60:63], v246, s[12:15], s41 offen offset:128
    buffer_load_dwordx4 v[64:67], v246, s[12:15], s41 offen offset:256
    buffer_load_dwordx4 v[68:71], v247, s[32:35], s41 offen offset:0
    buffer_load_dwordx4 v[72:75], v247, s[32:35], s41 offen offset:128
    s_sub_u32 s41, s41, s61
    s_waitcnt vmcnt(10)
    s_branch KF_SM
KF_S4L:
    buffer_load_dwordx4 v[32:35], v246, s[12:15], s41 offen offset:0
    buffer_load_dwordx4 v[36:39], v246, s[12:15], s41 offen offset:128
    buffer_load_dwordx4 v[40:43], v246, s[12:15], s41 offen offset:256
    buffer_load_dwordx4 v[44:47], v247, s[32:35], s41 offen offset:0
    s_sub_u32 s41, s41, s61
    buffer_load_dwordx4 v[56:59], v246, s[12:15], s41 offen offset:0
    buffer_load_dwordx4 v[60:63], v246, s[12:15], s41 offen offset:128
    buffer_load_dwordx4 v[64:67], v246, s[12:15], s41 offen offset:256
    buffer_load_dwordx4 v[68:71], v247, s[32:35], s41 offen offset:0
    s_sub_u32 s41, s41, s61
    s_waitcnt vmcnt(8)
KF_SM:
    v_lshlrev_b32 v174, 16, v166
    v_and_b32 v175, 0xffff0000, v166
    v_add_f32 v172, v174, v175
    v_mul_f32 v173, v174, v174
    v_fmac_f32 v173, v175, v175
    v_lshlrev_b32 v174, 16, v167
    v_and_b32 v175, 0xffff0000, v167
    v_add_f32 v172, v172, v174
    v_fmac_f32 v173, v174, v174
    v_add_f32 v172, v172, v175
    v_fmac_f32 v173, v175, v175
    v_lshlrev_b32 v174, 16, v168
    v_and_b32 v175, 0xffff0000, v168
    v_add_f32 v172, v172, v174
    v_fmac_f32 v173, v174, v174
    v_add_f32 v172, v172, v175
    v_fmac_f32 v173, v175, v175
    v_lshlrev_b32 v174, 16, v169
    v_and_b32 v175, 0xffff0000, v169
    v_add_f32 v172, v172, v174
    v_fmac_f32 v173, v174, v174
    v_add_f32 v172, v172, v175
    v_fmac_f32 v173, v175, v175
    v_lshlrev_b32 v174, 16, v170
    v_and_b32 v175, 0xffff0000, v170
    v_add_f32 v172, v172, v174
    v_fmac_f32 v173, v174, v174
    v_add_f32 v172, v172, v175
    v_fmac_f32 v173, v175, v175
    s_lshl_b32 s3, s40, 5
    v_add_f32_dpp v172, v172, v172 quad_perm:[1,0,3,2] row_mask:0xf bank_mask:0xf
    v_add_f32_dpp v173, v173, v173 quad_perm:[1,0,3,2] row_mask:0xf bank_mask:0xf
    s_add_u32 s3, s3, 163328
    v_add_f32_dpp v172, v172, v172 quad_perm:[2,3,0,1] row_mask:0xf bank_mask:0xf
    v_add_f32_dpp v173, v173, v173 quad_perm:[2,3,0,1] row_mask:0xf bank_mask:0xf
    v_lshrrev_b32 v174, 4, v250
    v_add_f32_dpp v172, v172, v172 row_half_mirror row_mask:0xf bank_mask:0xf
    v_add_f32_dpp v173, v173, v173 row_half_mirror row_mask:0xf bank_mask:0xf
    v_lshl_add_u32 v174, v174, 3, s3
    v_add_f32_dpp v172, v172, v172 row_mirror row_mask:0xf bank_mask:0xf
    v_add_f32_dpp v173, v173, v173 row_mirror row_mask:0xf bank_mask:0xf
    ds_write_b64 v174, v[172:173]
    buffer_load_dword v253, v254, s[20:23], 0 offen sc1
    s_waitcnt lgkmcnt(0)
    s_barrier
    s_sub_u32 s44, s44, 7
    s_cmp_lg_u32 s40, 7
    s_cbranch_scc1 KF_SST
    v_and_b32 v174, 7, v250
    v_lshlrev_b32 v174, 5, v174
    v_add_u32 v174, 163328, v174
    ds_read_b128 v[166:169], v174
    ds_read_b128 v[170:173], v174 offset:16
    v_lshlrev_b32 v175, 3, v250
    v_lshlrev_b32 v174, 26, v250
    v_and_b32 v174, 0xc0000000, v174
    v_lshrrev_b32 v174, 1, v174
    v_or_b32 v175, v174, v175
    s_lshl_b32 s3, s44, 4
    s_add_u32 s3, s3, 19922944
    s_waitcnt lgkmcnt(0)
    v_add_f32 v166, v166, v168
    v_add_f32 v167, v167, v169
    v_add_f32 v170, v170, v172
    v_add_f32 v171, v171, v173
    v_add_f32 v166, v166, v170
    v_add_f32 v167, v167, v171
    v_mul_f32 v166, 0xbacccccd, v166
    v_mul_f32 v174, v166, v166
    v_cvt_pk_bf16_f32 v168, v166, v166
    v_mul_f32 v167, 0x3acccccd, v167
    v_sub_f32 v167, v167, v174
    v_max_f32 v167, 0, v167
    v_cvt_pk_bf16_f32 v174, v167, v167
    v_and_b32 v174, 0xffff0000, v174
    v_add_f32 v174, 0x3727c5ac, v174
    v_cvt_pk_bf16_f32 v174, v174, v174
    v_and_b32 v174, 0xffff0000, v174
    v_sqrt_f32 v174, v174
    s_nop 0
    v_cvt_pk_bf16_f32 v174, v174, v174
    v_and_b32 v169, 0xffff0000, v174
    buffer_store_dwordx2 v[168:169], v175, s[16:19], s3 offen sc1
KF_SST:
    s_cmp_eq_u32 s74, 5
    s_cbranch_scc1 KF_S5B
    s_cmp_eq_u32 s74, 4
    s_cbranch_scc1 KF_S4B
    buffer_load_dwordx4 v[80:83], v246, s[12:15], s41 offen offset:0
    buffer_load_dwordx4 v[84:87], v246, s[12:15], s41 offen offset:128
    buffer_load_dwordx4 v[88:91], v246, s[12:15], s41 offen offset:256
    buffer_load_dwordx4 v[92:95], v247, s[32:35], s41 offen offset:0
    buffer_load_dwordx4 v[96:99], v247, s[32:35], s41 offen offset:128
    buffer_load_dwordx4 v[100:103], v247, s[32:35], s41 offen offset:256
    s_sub_u32 s41, s41, s61
    buffer_load_dwordx4 v[104:107], v246, s[12:15], s41 offen offset:0
    buffer_load_dwordx4 v[108:111], v246, s[12:15], s41 offen offset:128
    buffer_load_dwordx4 v[112:115], v246, s[12:15], s41 offen offset:256
    buffer_load_dwordx4 v[116:119], v247, s[32:35], s41 offen offset:0
    buffer_load_dwordx4 v[120:123], v247, s[32:35], s41 offen offset:128
    buffer_load_dwordx4 v[124:127], v247, s[32:35], s41 offen offset:256
    s_sub_u32 s41, s41, s61
    s_waitcnt vmcnt(18)
    v_mfma_f32_16x16x32_bf16 v[4:7], v[32:35], v[28:31], v[4:7]
    v_mfma_f32_16x16x32_bf16 v[8:11], v[36:39], v[28:31], v[8:11]
    v_mfma_f32_16x16x32_bf16 v[12:15], v[40:43], v[28:31], v[12:15]
    v_mfma_f32_16x16x32_bf16 v[16:19], v[44:47], v[28:31], v[16:19]
    v_mfma_f32_16x16x32_bf16 v[20:23], v[48:51], v[28:31], v[20:23]
    v_mfma_f32_16x16x32_bf16 v[24:27], v[52:55], v[28:31], v[24:27]
    buffer_load_dwordx4 v[128:131], v246, s[12:15], s41 offen offset:0
    buffer_load_dwordx4 v[132:135], v246, s[12:15], s41 offen offset:128
    buffer_load_dwordx4 v[136:139], v246, s[12:15], s41 offen offset:256
    buffer_load_dwordx4 v[140:143], v247, s[32:35], s41 offen offset:0
    buffer_load_dwordx4 v[144:147], v247, s[32:35], s41 offen offset:128
    buffer_load_dwordx4 v[148:151], v247, s[32:35], s41 offen offset:256
    s_sub_u32 s41, s41, s61
    s_waitcnt vmcnt(18)
    v_mfma_f32_16x16x32_bf16 v[4:7], v[56:59], v[28:31], v[4:7]
    v_mfma_f32_16x16x32_bf16 v[8:11], v[60:63], v[28:31], v[8:11]
    v_mfma_f32_16x16x32_bf16 v[12:15], v[64:67], v[28:31], v[12:15]
    v_mfma_f32_16x16x32_bf16 v[16:19], v[68:71], v[28:31], v[16:19]
    v_mfma_f32_16x16x32_bf16 v[20:23], v[72:75], v[28:31], v[20:23]
    v_mfma_f32_16x16x32_bf16 v[24:27], v[76:79], v[28:31], v[24:27]
    buffer_load_dwordx4 v[32:35], v246, s[12:15], s41 offen offset:0
    buffer_load_dwordx4 v[36:39], v246, s[12:15], s41 offen offset:128
    buffer_load_dwordx4 v[40:43], v246, s[12:15], s41 offen offset:256
    buffer_load_dwordx4 v[44:47], v247, s[32:35], s41 offen offset:0
    buffer_load_dwordx4 v[48:51], v247, s[32:35], s41 offen offset:128
    buffer_load_dwordx4 v[52:55], v247, s[32:35], s41 offen offset:256
    s_sub_u32 s41, s41, s61
    s_waitcnt vmcnt(18)
    v_mfma_f32_16x16x32_bf16 v[4:7], v[80:83], v[28:31], v[4:7]
    v_mfma_f32_16x16x32_bf16 v[8:11], v[84:87], v[28:31], v[8:11]
    v_mfma_f32_16x16x32_bf16 v[12:15], v[88:91], v[28:31], v[12:15]
    v_mfma_f32_16x16x32_bf16 v[16:19], v[92:95], v[28:31], v[16:19]
    v_mfma_f32_16x16x32_bf16 v[20:23], v[96:99], v[28:31], v[20:23]
    v_mfma_f32_16x16x32_bf16 v[24:27], v[100:103], v[28:31], v[24:27]
    s_call_b64 s[6:7], KF_SF0
    s_waitcnt vmcnt(12)
    v_mfma_f32_16x16x32_bf16 v[4:7], v[104:107], v[28:31], v[4:7]
    v_mfma_f32_16x16x32_bf16 v[8:11], v[108:111], v[28:31], v[8:11]
    v_mfma_f32_16x16x32_bf16 v[12:15], v[112:115], v[28:31], v[12:15]
    v_mfma_f32_16x16x32_bf16 v[16:19], v[116:119], v[28:31], v[16:19]
    v_mfma_f32_16x16x32_bf16 v[20:23], v[120:123], v[28:31], v[20:23]
    v_mfma_f32_16x16x32_bf16 v[24:27], v[124:127], v[28:31], v[24:27]
    s_waitcnt vmcnt(6)
    v_mfma_f32_16x16x32_bf16 v[4:7], v[128:131], v[28:31], v[4:7]
    v_mfma_f32_16x16x32_bf16 v[8:11], v[132:135], v[28:31], v[8:11]
    v_mfma_f32_16x16x32_bf16 v[12:15], v[136:139], v[28:31], v[12:15]
    v_mfma_f32_16x16x32_bf16 v[16:19], v[140:143], v[28:31], v[16:19]
    v_mfma_f32_16x16x32_bf16 v[20:23], v[144:147], v[28:31], v[20:23]
    v_mfma_f32_16x16x32_bf16 v[24:27], v[148:151], v[28:31], v[24:27]
    s_waitcnt vmcnt(0)
    v_mfma_f32_16x16x32_bf16 v[4:7], v[32:35], v[28:31], v[4:7]
    v_mfma_f32_16x16x32_bf16 v[8:11], v[36:39], v[28:31], v[8:11]
    v_mfma_f32_16x16x32_bf16 v[12:15], v[40:43], v[28:31], v[12:15]
    v_mfma_f32_16x16x32_bf16 v[16:19], v[44:47], v[28:31], v[16:19]
    v_mfma_f32_16x16x32_bf16 v[20:23], v[48:51], v[28:31], v[20:23]
    v_mfma_f32_16x16x32_bf16 v[24:27], v[52:55], v[28:31], v[24:27]
    s_branch KF_SN
KF_S5B:
    buffer_load_dwordx4 v[80:83], v246, s[12:15], s41 offen offset:0
    buffer_load_dwordx4 v[84:87], v246, s[12:15], s41 offen offset:128
    buffer_load_dwordx4 v[88:91], v246, s[12:15], s41 offen offset:256
    buffer_load_dwordx4 v[92:95], v247, s[32:35], s41 offen offset:0
    buffer_load_dwordx4 v[96:99], v247, s[32:35], s41 offen offset:128
    s_sub_u32 s41, s41, s61
    buffer_load_dwordx4 v[104:107], v246, s[12:15], s41 offen offset:0
    buffer_load_dwordx4 v[108:111], v246, s[12:15], s41 offen offset:128
    buffer_load_dwordx4 v[112:115], v246, s[12:15], s41 offen offset:256
    buffer_load_dwordx4 v[116:119], v247, s[32:35], s41 offen offset:0
    buffer_load_dwordx4 v[120:123], v247, s[32:35], s41 offen offset:128
    s_sub_u32 s41, s41, s61
    s_waitcnt vmcnt(15)
    v_mfma_f32_16x16x32_bf16 v[4:7], v[32:35], v[28:31], v[4:7]
    v_mfma_f32_16x16x32_bf16 v[8:11], v[36:39], v[28:31], v[8:11]
    v_mfma_f32_16x16x32_bf16 v[12:15], v[40:43], v[28:31], v[12:15]
    v_mfma_f32_16x16x32_bf16 v[16:19], v[44:47], v[28:31], v[16:19]
    v_mfma_f32_16x16x32_bf16 v[20:23], v[48:51], v[28:31], v[20:23]
    buffer_load_dwordx4 v[128:131], v246, s[12:15], s41 offen offset:0
    buffer_load_dwordx4 v[132:135], v246, s[12:15], s41 offen offset:128
    buffer_load_dwordx4 v[136:139], v246, s[12:15], s41 offen offset:256
    buffer_load_dwordx4 v[140:143], v247, s[32:35], s41 offen offset:0
    buffer_load_dwordx4 v[144:147], v247, s[32:35], s41 offen offset:128
    s_sub_u32 s41, s41, s61
    s_waitcnt vmcnt(15)
    v_mfma_f32_16x16x32_bf16 v[4:7], v[56:59], v[28:31], v[4:7]
    v_mfma_f32_16x16x32_bf16 v[8:11], v[60:63], v[28:31], v[8:11]
    v_mfma_f32_16x16x32_bf16 v[12:15], v[64:67], v[28:31], v[12:15]
    v_mfma_f32_16x16x32_bf16 v[16:19], v[68:71], v[28:31], v[16:19]
    v_mfma_f32_16x16x32_bf16 v[20:23], v[72:75], v[28:31], v[20:23]
    buffer_load_dwordx4 v[32:35], v246, s[12:15], s41 offen offset:0
    buffer_load_dwordx4 v[36:39], v246, s[12:15], s41 offen offset:128
    buffer_load_dwordx4 v[40:43], v246, s[12:15], s41 offen offset:256
    buffer_load_dwordx4 v[44:47], v247, s[32:35], s41 offen offset:0
    buffer_load_dwordx4 v[48:51], v247, s[32:35], s41 offen offset:128
    s_sub_u32 s41, s41, s61
    s_waitcnt vmcnt(15)
    v_mfma_f32_16x16x32_bf16 v[4:7], v[80:83], v[28:31], v[4:7]
    v_mfma_f32_16x16x32_bf16 v[8:11], v[84:87], v[28:31], v[8:11]
    v_mfma_f32_16x16x32_bf16 v[12:15], v[88:91], v[28:31], v[12:15]
    v_mfma_f32_16x16x32_bf16 v[16:19], v[92:95], v[28:31], v[16:19]
    v_mfma_f32_16x16x32_bf16 v[20:23], v[96:99], v[28:31], v[20:23]
    buffer_load_dwordx4 v[56:59], v246, s[12:15], s41 offen offset:0
    buffer_load_dwordx4 v[60:63], v246, s[12:15], s41 offen offset:128
    buffer_load_dwordx4 v[64:67], v246, s[12:15], s41 offen offset:256
    buffer_load_dwordx4 v[68:71], v247, s[32:35], s41 offen offset:0
    buffer_load_dwordx4 v[72:75], v247, s[32:35], s41 offen offset:128
    s_sub_u32 s41, s41, s61
    s_call_b64 s[6:7], KF_SF0
    s_waitcnt vmcnt(15)
    v_mfma_f32_16x16x32_bf16 v[4:7], v[104:107], v[28:31], v[4:7]
    v_mfma_f32_16x16x32_bf16 v[8:11], v[108:111], v[28:31], v[8:11]
    v_mfma_f32_16x16x32_bf16 v[12:15], v[112:115], v[28:31], v[12:15]
    v_mfma_f32_16x16x32_bf16 v[16:19], v[116:119], v[28:31], v[16:19]
    v_mfma_f32_16x16x32_bf16 v[20:23], v[120:123], v[28:31], v[20:23]
    buffer_load_dwordx4 v[80:83], v246, s[12:15], s41 offen offset:0
    buffer_load_dwordx4 v[84:87], v246, s[12:15], s41 offen offset:128
    buffer_load_dwordx4 v[88:91], v246, s[12:15], s41 offen offset:256
    buffer_load_dwordx4 v[92:95], v247, s[32:35], s41 offen offset:0
    buffer_load_dwordx4 v[96:99], v247, s[32:35], s41 offen offset:128
    s_sub_u32 s41, s41, s61
    s_waitcnt vmcnt(15)
    v_mfma_f32_16x16x32_bf16 v[4:7], v[128:131], v[28:31], v[4:7]
    v_mfma_f32_16x16x32_bf16 v[8:11], v[132:135], v[28:31], v[8:11]
    v_mfma_f32_16x16x32_bf16 v[12:15], v[136:139], v[28:31], v[12:15]
    v_mfma_f32_16x16x32_bf16 v[16:19], v[140:143], v[28:31], v[16:19]
    v_mfma_f32_16x16x32_bf16 v[20:23], v[144:147], v[28:31], v[20:23]
    buffer_load_dwordx4 v[104:107], v246, s[12:15], s41 offen offset:0
    buffer_load_dwordx4 v[108:111], v246, s[12:15], s41 offen offset:128
    buffer_load_dwordx4 v[112:115], v246, s[12:15], s41 offen offset:256
    buffer_load_dwordx4 v[116:119], v247, s[32:35], s41 offen offset:0
    buffer_load_dwordx4 v[120:123], v247, s[32:35], s41 offen offset:128
    s_sub_u32 s41, s41, s61
    s_waitcnt vmcnt(15)
    v_mfma_f32_16x16x32_bf16 v[4:7], v[32:35], v[28:31], v[4:7]
    v_mfma_f32_16x16x32_bf16 v[8:11], v[36:39], v[28:31], v[8:11]
    v_mfma_f32_16x16x32_bf16 v[12:15], v[40:43], v[28:31], v[12:15]
    v_mfma_f32_16x16x32_bf16 v[16:19], v[44:47], v[28:31], v[16:19]
    v_mfma_f32_16x16x32_bf16 v[20:23], v[48:51], v[28:31], v[20:23]
    buffer_load_dwordx4 v[128:131], v246, s[12:15], s41 offen offset:0
    buffer_load_dwordx4 v[132:135], v246, s[12:15], s41 offen offset:128
    buffer_load_dwordx4 v[136:139], v246, s[12:15], s41 offen offset:256
    buffer_load_dwordx4 v[140:143], v247, s[32:35], s41 offen offset:0
    buffer_load_dwordx4 v[144:147], v247, s[32:35], s41 offen offset:128
    s_sub_u32 s41, s41, s61
    s_waitcnt vmcnt(15)
    v_mfma_f32_16x16x32_bf16 v[4:7], v[56:59], v[28:31], v[4:7]
    v_mfma_f32_16x16x32_bf16 v[8:11], v[60:63], v[28:31], v[8:11]
    v_mfma_f32_16x16x32_bf16 v[12:15], v[64:67], v[28:31], v[12:15]
    v_mfma_f32_16x16x32_bf16 v[16:19], v[68:71], v[28:31], v[16:19]
    v_mfma_f32_16x16x32_bf16 v[20:23], v[72:75], v[28:31], v[20:23]
    s_waitcnt vmcnt(10)
    v_mfma_f32_16x16x32_bf16 v[4:7], v[80:83], v[28:31], v[4:7]
    v_mfma_f32_16x16x32_bf16 v[8:11], v[84:87], v[28:31], v[8:11]
    v_mfma_f32_16x16x32_bf16 v[12:15], v[88:91], v[28:31], v[12:15]
    v_mfma_f32_16x16x32_bf16 v[16:19], v[92:95], v[28:31], v[16:19]
    v_mfma_f32_16x16x32_bf16 v[20:23], v[96:99], v[28:31], v[20:23]
    s_waitcnt vmcnt(5)
    v_mfma_f32_16x16x32_bf16 v[4:7], v[104:107], v[28:31], v[4:7]
    v_mfma_f32_16x16x32_bf16 v[8:11], v[108:111], v[28:31], v[8:11]
    v_mfma_f32_16x16x32_bf16 v[12:15], v[112:115], v[28:31], v[12:15]
    v_mfma_f32_16x16x32_bf16 v[16:19], v[116:119], v[28:31], v[16:19]
    v_mfma_f32_16x16x32_bf16 v[20:23], v[120:123], v[28:31], v[20:23]
    s_waitcnt vmcnt(0)
    v_mfma_f32_16x16x32_bf16 v[4:7], v[128:131], v[28:31], v[4:7]
    v_mfma_f32_16x16x32_bf16 v[8:11], v[132:135], v[28:31], v[8:11]
    v_mfma_f32_16x16x32_bf16 v[12:15], v[136:139], v[28:31], v[12:15]
    v_mfma_f32_16x16x32_bf16 v[16:19], v[140:143], v[28:31], v[16:19]
    v_mfma_f32_16x16x32_bf16 v[20:23], v[144:147], v[28:31], v[20:23]
    s_branch KF_SN
KF_SF0:
KF_SET:
    v_readfirstlane_b32 s65, v253
    s_nop 3
    s_cmp_lg_u32 s65, 0
    s_cbranch_scc1 KF_SET_X
    s_add_u32 s77, s77, 1
    s_cmp_gt_u32 s77, 100000
    s_cbranch_scc1 KF_SET_X
    s_sleep 8
    buffer_load_dword v253, v254, s[20:23], 0 offen sc1
    s_waitcnt vmcnt(0)
    s_branch KF_SET
KF_SET_X:
    s_cmp_lg_u32 s40, 7
    s_cbranch_scc1 KF_SE
    s_bfe_u32 s4, s27, 0x80010
    s_lshl_b32 s4, s4, 4
    s_add_u32 s4, s4, s25
    s_lshl_b32 s4, s4, 7
    s_add_u32 s4, s4, 20086784
    v_lshlrev_b32 v166, 2, v250
    v_mov_b32 v167, s65
    s_mov_b32 exec_hi, 0
    buffer_store_dword v167, v166, s[16:19], s4 offen sc1
    s_mov_b32 exec_hi, -1
KF_SE:
    s_setpc_b64 s[6:7]
KF_S4B:
    buffer_load_dwordx4 v[80:83], v246, s[12:15], s41 offen offset:0
    buffer_load_dwordx4 v[84:87], v246, s[12:15], s41 offen offset:128
    buffer_load_dwordx4 v[88:91], v246, s[12:15], s41 offen offset:256
    buffer_load_dwordx4 v[92:95], v247, s[32:35], s41 offen offset:0
    s_sub_u32 s41, s41, s61
    buffer_load_dwordx4 v[104:107], v246, s[12:15], s41 offen offset:0
    buffer_load_dwordx4 v[108:111], v246, s[12:15], s41 offen offset:128
    buffer_load_dwordx4 v[112:115], v246, s[12:15], s41 offen offset:256
    buffer_load_dwordx4 v[116:119], v247, s[32:35], s41 offen offset:0
    s_sub_u32 s41, s41, s61
    s_waitcnt vmcnt(12)
    v_mfma_f32_16x16x32_bf16 v[4:7], v[32:35], v[28:31], v[4:7]
    v_mfma_f32_16x16x32_bf16 v[8:11], v[36:39], v[28:31], v[8:11]
    v_mfma_f32_16x16x32_bf16 v[12:15], v[40:43], v[28:31], v[12:15]
    v_mfma_f32_16x16x32_bf16 v[16:19], v[44:47], v[28:31], v[16:19]
    buffer_load_dwordx4 v[128:131], v246, s[12:15], s41 offen offset:0
    buffer_load_dwordx4 v[132:135], v246, s[12:15], s41 offen offset:128
    buffer_load_dwordx4 v[136:139], v246, s[12:15], s41 offen offset:256
    buffer_load_dwordx4 v[140:143], v247, s[32:35], s41 offen offset:0
    s_sub_u32 s41, s41, s61
    s_waitcnt vmcnt(12)
    v_mfma_f32_16x16x32_bf16 v[4:7], v[56:59], v[28:31], v[4:7]
    v_mfma_f32_16x16x32_bf16 v[8:11], v[60:63], v[28:31], v[8:11]
    v_mfma_f32_16x16x32_bf16 v[12:15], v[64:67], v[28:31], v[12:15]
    v_mfma_f32_16x16x32_bf16 v[16:19], v[68:71], v[28:31], v[16:19]
    buffer_load_dwordx4 v[32:35], v246, s[12:15], s41 offen offset:0
    buffer_load_dwordx4 v[36:39], v246, s[12:15], s41 offen offset:128
    buffer_load_dwordx4 v[40:43], v246, s[12:15], s41 offen offset:256
    buffer_load_dwordx4 v[44:47], v247, s[32:35], s41 offen offset:0
    s_sub_u32 s41, s41, s61
    s_waitcnt vmcnt(12)
    v_mfma_f32_16x16x32_bf16 v[4:7], v[80:83], v[28:31], v[4:7]
    v_mfma_f32_16x16x32_bf16 v[8:11], v[84:87], v[28:31], v[8:11]
    v_mfma_f32_16x16x32_bf16 v[12:15], v[88:91], v[28:31], v[12:15]
    v_mfma_f32_16x16x32_bf16 v[16:19], v[92:95], v[28:31], v[16:19]
    buffer_load_dwordx4 v[56:59], v246, s[12:15], s41 offen offset:0
    buffer_load_dwordx4 v[60:63], v246, s[12:15], s41 offen offset:128
    buffer_load_dwordx4 v[64:67], v246, s[12:15], s41 offen offset:256
    buffer_load_dwordx4 v[68:71], v247, s[32:35], s41 offen offset:0
    s_sub_u32 s41, s41, s61
    s_call_b64 s[6:7], KF_SF0
    s_waitcnt vmcnt(12)
    v_mfma_f32_16x16x32_bf16 v[4:7], v[104:107], v[28:31], v[4:7]
    v_mfma_f32_16x16x32_bf16 v[8:11], v[108:111], v[28:31], v[8:11]
    v_mfma_f32_16x16x32_bf16 v[12:15], v[112:115], v[28:31], v[12:15]
    v_mfma_f32_16x16x32_bf16 v[16:19], v[116:119], v[28:31], v[16:19]
    buffer_load_dwordx4 v[80:83], v246, s[12:15], s41 offen offset:0
    buffer_load_dwordx4 v[84:87], v246, s[12:15], s41 offen offset:128
    buffer_load_dwordx4 v[88:91], v246, s[12:15], s41 offen offset:256
    buffer_load_dwordx4 v[92:95], v247, s[32:35], s41 offen offset:0
    s_sub_u32 s41, s41, s61
    s_waitcnt vmcnt(12)
    v_mfma_f32_16x16x32_bf16 v[4:7], v[128:131], v[28:31], v[4:7]
    v_mfma_f32_16x16x32_bf16 v[8:11], v[132:135], v[28:31], v[8:11]
    v_mfma_f32_16x16x32_bf16 v[12:15], v[136:139], v[28:31], v[12:15]
    v_mfma_f32_16x16x32_bf16 v[16:19], v[140:143], v[28:31], v[16:19]
    buffer_load_dwordx4 v[104:107], v246, s[12:15], s41 offen offset:0
    buffer_load_dwordx4 v[108:111], v246, s[12:15], s41 offen offset:128
    buffer_load_dwordx4 v[112:115], v246, s[12:15], s41 offen offset:256
    buffer_load_dwordx4 v[116:119], v247, s[32:35], s41 offen offset:0
    s_sub_u32 s41, s41, s61
    s_waitcnt vmcnt(12)
    v_mfma_f32_16x16x32_bf16 v[4:7], v[32:35], v[28:31], v[4:7]
    v_mfma_f32_16x16x32_bf16 v[8:11], v[36:39], v[28:31], v[8:11]
    v_mfma_f32_16x16x32_bf16 v[12:15], v[40:43], v[28:31], v[12:15]
    v_mfma_f32_16x16x32_bf16 v[16:19], v[44:47], v[28:31], v[16:19]
    buffer_load_dwordx4 v[128:131], v246, s[12:15], s41 offen offset:0
    buffer_load_dwordx4 v[132:135], v246, s[12:15], s41 offen offset:128
    buffer_load_dwordx4 v[136:139], v246, s[12:15], s41 offen offset:256
    buffer_load_dwordx4 v[140:143], v247, s[32:35], s41 offen offset:0
    s_sub_u32 s41, s41, s61
    s_waitcnt vmcnt(12)
    v_mfma_f32_16x16x32_bf16 v[4:7], v[56:59], v[28:31], v[4:7]
    v_mfma_f32_16x16x32_bf16 v[8:11], v[60:63], v[28:31], v[8:11]
    v_mfma_f32_16x16x32_bf16 v[12:15], v[64:67], v[28:31], v[12:15]
    v_mfma_f32_16x16x32_bf16 v[16:19], v[68:71], v[28:31], v[16:19]
    s_waitcnt vmcnt(8)
    v_mfma_f32_16x16x32_bf16 v[4:7], v[80:83], v[28:31], v[4:7]
    v_mfma_f32_16x16x32_bf16 v[8:11], v[84:87], v[28:31], v[8:11]
    v_mfma_f32_16x16x32_bf16 v[12:15], v[88:91], v[28:31], v[12:15]
    v_mfma_f32_16x16x32_bf16 v[16:19], v[92:95], v[28:31], v[16:19]
    s_waitcnt vmcnt(4)
    v_mfma_f32_16x16x32_bf16 v[4:7], v[104:107], v[28:31], v[4:7]
    v_mfma_f32_16x16x32_bf16 v[8:11], v[108:111], v[28:31], v[8:11]
    v_mfma_f32_16x16x32_bf16 v[12:15], v[112:115], v[28:31], v[12:15]
    v_mfma_f32_16x16x32_bf16 v[16:19], v[116:119], v[28:31], v[16:19]
    s_waitcnt vmcnt(0)
    v_mfma_f32_16x16x32_bf16 v[4:7], v[128:131], v[28:31], v[4:7]
    v_mfma_f32_16x16x32_bf16 v[8:11], v[132:135], v[28:31], v[8:11]
    v_mfma_f32_16x16x32_bf16 v[12:15], v[136:139], v[28:31], v[12:15]
    v_mfma_f32_16x16x32_bf16 v[16:19], v[140:143], v[28:31], v[16:19]
KF_SN:
    v_and_b32 v1, 7, v250
    v_lshlrev_b32 v1, 5, v1
    v_bfe_u32 v2, v250, 4, 1
    v_lshl_add_u32 v1, v2, 4, v1
    v_lshrrev_b32 v2, 5, v250
    v_lshl_add_u32 v1, v2, 8, v1
    s_lshl_b32 s3, s40, 9
    v_add_u32 v1, s3, v1
    s_mov_b32 exec_lo, 0x00ff00ff
    s_mov_b32 exec_hi, 0x00ff00ff
    ds_write_b128 v1, v[4:7] offset:0
    ds_write_b128 v1, v[8:11] offset:4096
    ds_write_b128 v1, v[12:15] offset:8192
    ds_write_b128 v1, v[16:19] offset:12288
    ds_write_b128 v1, v[20:23] offset:16384
    ds_write_b128 v1, v[24:27] offset:20480
    s_mov_b64 exec, -1
    s_waitcnt lgkmcnt(0)
    s_barrier
    s_cmp_ge_u32 s40, s74
    s_cbranch_scc1 KF_CSDONE
    v_and_b32 v1, 7, v250
    v_lshlrev_b32 v1, 5, v1
    v_lshrrev_b32 v2, 3, v250
    v_lshl_add_u32 v1, v2, 2, v1
    s_lshl_b32 s3, s40, 12
    v_add_u32 v1, s3, v1
    ds_read2st64_b32 v[10:11], v1 offset0:0 offset1:1
    ds_read2st64_b32 v[12:13], v1 offset0:2 offset1:3
    ds_read2st64_b32 v[14:15], v1 offset0:4 offset1:5
    ds_read2st64_b32 v[16:17], v1 offset0:6 offset1:7
    ds_read2st64_b32 v[18:19], v1 offset0:8 offset1:9
    ds_read2st64_b32 v[20:21], v1 offset0:10 offset1:11
    ds_read2st64_b32 v[22:23], v1 offset0:12 offset1:13
    ds_read2st64_b32 v[24:25], v1 offset0:14 offset1:15
    s_waitcnt lgkmcnt(0)
    v_pk_add_f32 v[10:11], v[10:11], v[18:19]
    v_pk_add_f32 v[12:13], v[12:13], v[20:21]
    v_pk_add_f32 v[14:15], v[14:15], v[22:23]
    v_pk_add_f32 v[16:17], v[16:17], v[24:25]
    v_pk_add_f32 v[10:11], v[10:11], v[14:15]
    v_pk_add_f32 v[12:13], v[12:13], v[16:17]
    v_pk_add_f32 v[10:11], v[10:11], v[12:13]
    v_add_f32 v10, v10, v11
    s_cmp_lg_u32 s74, 6
    s_cbranch_scc1 KF_SNG
    v_and_b32 v1, 15, v250
    v_lshlrev_b32 v1, 7, v1
    s_lshl_b32 s4, s26, 11
    s_add_u32 s4, s4, 20086784
KF_SGW:
    s_sleep 4
    buffer_load_dword v2, v1, s[16:19], s4 offen sc1
    s_waitcnt vmcnt(0)
    v_cmp_ne_u32 vcc, s65, v2
    s_add_u32 s77, s77, 1
    s_cmp_gt_u32 s77, 100000
    s_cbranch_scc1 KF_SGX
    s_nop 2
    s_cbranch_vccnz KF_SGW
KF_SGX:
    s_cmp_ge_u32 s40, 3
    s_cselect_b32 s3, 24, 0
    s_cselect_b32 s6, 3, 0
    s_cselect_b32 s7, 192, 0
    s_add_u32 s3, s40, s3
    s_mul_i32 s4, s26, 3
    s_add_u32 s3, s3, s4
    s_lshl_b32 s3, s3, 8
    s_add_u32 s5, s3, 19972096
    s_sub_u32 s6, s40, s6
    s_lshl_b32 s6, s6, 2
    v_lshrrev_b32 v1, 4, v250
    v_add_u32 v1, s6, v1
    v_mul_u32_u24 v2, 86, v1
    v_lshrrev_b32 v2, 8, v2
    v_mul_u32_u24 v3, 3, v2
    v_sub_u32 v1, v1, v3
    v_lshlrev_b32 v1, 6, v1
    v_lshl_add_u32 v1, v2, 12, v1
    v_and_b32 v2, 15, v250
    v_lshl_add_u32 v1, v2, 2, v1
    s_lshl_b32 s3, s26, 14
    s_add_u32 s3, s3, s7
    s_add_u32 s3, s3, 20152320
    buffer_load_dword v12, v1, s[16:19], s3 offen offset:0 sc1
    buffer_load_dword v13, v1, s[16:19], s3 offen offset:512 sc1
    buffer_load_dword v14, v1, s[16:19], s3 offen offset:1024 sc1
    buffer_load_dword v15, v1, s[16:19], s3 offen offset:1536 sc1
    buffer_load_dword v16, v1, s[16:19], s3 offen offset:2048 sc1
    buffer_load_dword v17, v1, s[16:19], s3 offen offset:2560 sc1
    buffer_load_dword v18, v1, s[16:19], s3 offen offset:3072 sc1
    buffer_load_dword v19, v1, s[16:19], s3 offen offset:3584 sc1
    s_waitcnt vmcnt(0)
    v_add_f32 v10, v10, v12
    v_add_f32 v10, v10, v13
    v_add_f32 v10, v10, v14
    v_add_f32 v10, v10, v15
    v_add_f32 v10, v10, v16
    v_add_f32 v10, v10, v17
    v_add_f32 v10, v10, v18
    v_add_f32 v10, v10, v19
    v_lshlrev_b32 v1, 2, v250
    buffer_store_dword v10, v1, s[16:19], s5 offen sc1
    s_branch KF_CSDONE
KF_SNG:
    v_cvt_pk_bf16_f32 v2, v10, v10
    v_and_b32 v3, 0xffff0000, v2
    v_sub_f32 v10, v10, v3
    v_cvt_pk_bf16_f32 v4, v10, v10
    v_and_b32 v3, 0xffff0000, v4
    v_sub_f32 v10, v10, v3
    v_and_b32 v2, 0xffff, v2
    v_or_b32 v4, v2, v3
    v_cvt_pk_bf16_f32 v5, v10, v254
    s_sub_u32 s4, s51, 3
    s_cmp_lt_u32 s40, 3
    s_cselect_b32 s3, s45, s4
    s_add_u32 s3, s3, s40
    s_lshl_b32 s3, s3, 9
    s_add_u32 s3, s3, 19955712
    v_lshlrev_b32 v1, 3, v250
    buffer_store_dwordx2 v[4:5], v1, s[16:19], s3 offen sc1
KF_CSDONE:
    s_waitcnt vmcnt(0)
    s_barrier
    s_cmp_lg_u32 s40, 0
    s_cbranch_scc1 KF_SSIG
    s_add_u32 s4, s26, 1
    s_lshl_b32 s4, s4, 7
    s_add_u32 s4, s4, 20119552
    v_lshlrev_b32 v166, 2, v250
    v_mov_b32 v167, s65
    s_mov_b32 exec_hi, 0
    buffer_store_dword v167, v166, s[16:19], s4 offen sc1
    s_mov_b32 exec_hi, -1
KF_SSIG:
    s_cmp_lg_u32 s40, 0
    s_cbranch_scc1 KF_SPOLLED
    s_mov_b32 s44, 20119552
    s_cmp_lg_u32 s26, 15
    s_cbranch_scc1 KF_SPOLL
    v_lshlrev_b32 v1, 7, v250
    s_mov_b32 s4, 20086784
    v_add_u32 v6, 8192, v1
    v_add_u32 v7, 16384, v1
    v_add_u32 v8, 24576, v1
KF_AGG:
    buffer_load_dword v2, v1, s[16:19], s4 offen sc1
    buffer_load_dword v3, v6, s[16:19], s4 offen sc1
    buffer_load_dword v4, v7, s[16:19], s4 offen sc1
    buffer_load_dword v5, v8, s[16:19], s4 offen sc1
    s_waitcnt vmcnt(0)
    v_xor_b32 v2, s65, v2
    v_xor_b32 v3, s65, v3
    v_xor_b32 v4, s65, v4
    v_xor_b32 v5, s65, v5
    v_or3_b32 v2, v2, v3, v4
    v_or_b32 v2, v2, v5
    v_cmp_ne_u32 vcc, 0, v2
    s_add_u32 s77, s77, 1
    s_cmp_gt_u32 s77, 100000
    s_cbranch_scc1 KF_AGGX
    s_nop 2
    s_cbranch_vccnz KF_AGG
KF_AGGX:
    v_lshlrev_b32 v246, 2, v250
    v_mov_b32 v247, s65
    s_mov_b32 exec_hi, 0
    buffer_store_dword v247, v246, s[16:19], s44 offen sc1
    s_mov_b32 exec_hi, -1
KF_SPOLL:
    s_sleep 8
    buffer_load_dword v253, v254, s[16:19], s44 offen sc1
    s_waitcnt vmcnt(0)
    v_readfirstlane_b32 s3, v253
    s_add_u32 s77, s77, 1
    s_cmp_gt_u32 s77, 100000
    s_cbranch_scc1 KF_SPOLLED
    s_nop 0
    s_cmp_lg_u32 s3, s65
    s_cbranch_scc1 KF_SPOLL
KF_SPOLLED:
    s_barrier
    s_getpc_b64 s[4:5]
KF_PCW2:
    s_sub_u32 s4, s4, KF_PCW2-recurrent_scan__linear_kernel_hedgehog__glu_gated_geglu__prompt_kernel
    s_subb_u32 s5, s5, 0
    s_and_b32 s3, s25, 1
    s_lshl_b32 s3, s3, 3
    s_add_u32 s3, s3, s40
    s_lshl_b32 s3, s3, 10
    v_add_u32 v1, s3, v251
    s_mov_b32 s6, KF_TAB-recurrent_scan__linear_kernel_hedgehog__glu_gated_geglu__prompt_kernel-16
    v_min_u32 v2, s6, v1
    global_load_dwordx4 v[232:235], v2, s[4:5]
    v_add_u32 v1, 16384, v1
    v_min_u32 v2, s6, v1
    global_load_dwordx4 v[232:235], v2, s[4:5]
    v_add_u32 v1, 16384, v1
    v_min_u32 v2, s6, v1
    global_load_dwordx4 v[232:235], v2, s[4:5]
    v_add_u32 v1, 16384, v1
    s_mul_i32 s3, s40, 14
    s_cmp_eq_u32 s40, 3
    s_cselect_b32 s3, 41, s3
    s_mul_i32 s4, s40, 5
    s_add_u32 s4, s4, 34
    s_cmp_ge_u32 s40, 4
    s_cselect_b32 s76, s4, s3
    s_mul_i32 s75, s29, 5120
    s_mul_i32 s4, s76, 40960
    s_add_u32 s75, s75, s4
    s_add_u32 s75, s75, 10485760
    buffer_load_dwordx4 v[166:169], v251, s[16:19], s75 offen offset:0 sc1
    buffer_load_dwordx4 v[170:173], v251, s[16:19], s75 offen offset:1024 sc1
    buffer_load_dwordx4 v[174:177], v251, s[16:19], s75 offen offset:2048 sc1
    buffer_load_dwordx4 v[178:181], v251, s[16:19], s75 offen offset:3072 sc1
    buffer_load_dwordx4 v[182:185], v252, s[16:19], s75 offen sc1
    s_add_u32 s75, s75, 40960
    buffer_load_dwordx4 v[186:189], v251, s[16:19], s75 offen offset:0 sc1
    buffer_load_dwordx4 v[190:193], v251, s[16:19], s75 offen offset:1024 sc1
    buffer_load_dwordx4 v[194:197], v251, s[16:19], s75 offen offset:2048 sc1
    buffer_load_dwordx4 v[198:201], v251, s[16:19], s75 offen offset:3072 sc1
    buffer_load_dwordx4 v[202:205], v252, s[16:19], s75 offen sc1
    s_add_u32 s75, s75, 40960
    buffer_load_dwordx4 v[206:209], v251, s[16:19], s75 offen offset:0 sc1
    buffer_load_dwordx4 v[210:213], v251, s[16:19], s75 offen offset:1024 sc1
    buffer_load_dwordx4 v[214:217], v251, s[16:19], s75 offen offset:2048 sc1
    buffer_load_dwordx4 v[218:221], v251, s[16:19], s75 offen offset:3072 sc1
    buffer_load_dwordx4 v[222:225], v252, s[16:19], s75 offen sc1
    s_add_u32 s75, s75, 40960
    buffer_load_dwordx4 v[146:149], v251, s[16:19], s75 offen offset:0 sc1
    buffer_load_dwordx4 v[150:153], v251, s[16:19], s75 offen offset:1024 sc1
    buffer_load_dwordx4 v[154:157], v251, s[16:19], s75 offen offset:2048 sc1
    buffer_load_dwordx4 v[158:161], v251, s[16:19], s75 offen offset:3072 sc1
    buffer_load_dwordx4 v[162:165], v252, s[16:19], s75 offen sc1
    s_add_u32 s75, s75, 40960
KF_PUB:
    s_mov_b32 s36, s16
    s_mov_b32 s37, s17
    s_mov_b32 s38, 20971520
    s_mov_b32 s39, 0x00020000
    s_mul_i32 s41, s28, 303104
    s_lshl_b32 s4, s76, 12
    s_add_u32 s41, s41, s4
    s_mul_i32 s48, s40, 20480
    s_bfe_u32 s4, s27, 0x80010
    s_lshl_b32 s4, s4, 4
    s_add_u32 s4, s4, s25
    s_lshl_b32 s4, s4, 7
    s_add_u32 s4, s4, 20021248
    v_mov_b32 v253, 1
    v_add_u32 v249, s48, v251
    v_lshlrev_b32 v248, 7, v250
    s_lshr_b32 s1, s0, 16
    s_mov_b32 s53, 0
    s_cmp_lt_u32 s40, 4
    s_cbranch_scc1 KF_PUB1
    s_cmp_eq_u32 s1, 0
    s_cbranch_scc1 KF_PUB1
    s_bfe_u32 s51, s0, 0x80008
    s_lshr_b32 s5, s0, 16
    s_sub_u32 s5, s5, 1
    s_lshr_b32 s3, s30, 4
    s_add_u32 s3, s3, 13
    s_lshl_b32 s3, s3, 4
    s_add_u32 s3, s3, s51
    s_lshl_b32 s3, s3, 7
    s_add_u32 s44, s3, 20021248
    v_min_u32 v231, s5, v250
    v_lshlrev_b32 v231, 7, v231
    v_mov_b32 v230, 0
    buffer_load_dword v230, v231, s[16:19], s44 offen sc1
KF_PUB0:
    s_mov_b32 s32, s56
    s_mov_b32 s33, s57
    s_mov_b32 s34, 25600
    s_mov_b32 s35, 0x00020000
    v_and_b32 v240, 31, v250
    v_lshrrev_b32 v241, 5, v250
    v_bfe_u32 v226, v240, 2, 1
    v_and_b32 v227, 3, v240
    v_lshrrev_b32 v228, 3, v240
    v_lshl_add_u32 v227, v228, 2, v227
    v_lshl_add_u32 v228, v226, 3, v227
    v_lshl_add_u32 v229, v226, 1, v227
    v_add_u32 v229, 8, v229
    v_cmp_lt_u32 vcc, 7, v227
    s_nop 1
    v_cndmask_b32 v228, v228, v229, vcc
    v_min_u32 v228, 19, v228
    v_lshlrev_b32 v228, 1, v228
    v_mul_u32_u24 v229, 320, v241
    v_add_u32 v229, v229, v228
    v_lshl_add_u32 v228, v241, 30, v228
    s_mul_i32 s3, s30, 800
    s_sub_u32 s45, s40, 4
    s_lshl_b32 s51, s51, 2
    s_add_u32 s51, s51, s45
    s_lshl_b32 s5, s30, 6
    s_add_u32 s5, s5, s51
    s_lshl_b32 s74, s5, 10
    s_add_u32 s74, s74, 14680064
    s_lshl_b32 s46, s5, 8
    s_add_u32 s46, s46, 16777216
    v_lshlrev_b32 v244, 3, v240
    buffer_load_ushort v40, v229, s[32:35], s3 offen offset:0
    buffer_load_ushort v41, v229, s[32:35], s3 offen offset:40
    buffer_load_ushort v42, v229, s[32:35], s3 offen offset:80
    buffer_load_ushort v43, v229, s[32:35], s3 offen offset:120
    buffer_load_ushort v44, v229, s[32:35], s3 offen offset:160
    buffer_load_ushort v45, v229, s[32:35], s3 offen offset:200
    buffer_load_ushort v46, v229, s[32:35], s3 offen offset:240
    buffer_load_ushort v47, v229, s[32:35], s3 offen offset:280
    buffer_load_ushort v48, v228, s[32:35], s3 offen offset:640
    buffer_load_ushort v49, v228, s[32:35], s3 offen offset:680
    buffer_load_ushort v50, v228, s[32:35], s3 offen offset:720
    buffer_load_ushort v51, v228, s[32:35], s3 offen offset:760
    s_branch KF_PUB1
    s_cmp_lg_u32 s24, 0
    s_cbranch_scc1 KF_PUB3
    s_waitcnt vmcnt(12)
    v_cmp_ne_u32 vcc, s65, v230
    s_nop 4
    s_cbranch_vccnz KF_PUB3
    s_mov_b32 s53, 1
    buffer_load_dwordx4 v[0:3], v251, s[16:19], s74 offen sc1
    buffer_load_dwordx2 v[4:5], v244, s[16:19], s46 offen offset:0 sc1
    s_add_u32 s74, s74, 4096
    buffer_load_dwordx4 v[6:9], v251, s[16:19], s74 offen sc1
    buffer_load_dwordx2 v[10:11], v244, s[16:19], s46 offen offset:1024 sc1
    s_add_u32 s74, s74, 4096
    s_cmp_le_u32 s1, 2
    s_cbranch_scc1 KF_Q2
    buffer_load_dwordx4 v[12:15], v251, s[16:19], s74 offen sc1
    buffer_load_dwordx2 v[16:17], v244, s[16:19], s46 offen offset:2048 sc1
    s_add_u32 s74, s74, 4096
    s_cmp_le_u32 s1, 3
    s_cbranch_scc1 KF_Q2
    buffer_load_dwordx4 v[18:21], v251, s[16:19], s74 offen sc1
    buffer_load_dwordx2 v[22:23], v244, s[16:19], s46 offen offset:3072 sc1
    s_add_u32 s74, s74, 4096
KF_Q2:
    s_waitcnt vmcnt(16)
    s_branch KF_PUB4
KF_PUB3:
    s_waitcnt vmcnt(12)
    s_branch KF_PUB4
KF_PUB1:
    s_waitcnt vmcnt(0)
KF_PUB4:
    s_waitcnt lgkmcnt(0)
    v_mov_b32 v246, 163604
    s_mov_b64 exec, 1
    ds_add_rtn_u32 v247, v246, v253
    s_mov_b64 exec, -1
    s_waitcnt lgkmcnt(0)
    v_readfirstlane_b32 s3, v247
    s_nop 3
    s_cmp_lg_u32 s3, 7
    s_cbranch_scc1 KF_PUB2
    v_lshlrev_b32 v246, 2, v250
    v_mov_b32 v247, s65
    s_mov_b32 exec_hi, 0
    buffer_store_dword v247, v246, s[16:19], s4 offen sc1
    s_mov_b32 exec_hi, -1
    v_mov_b32 v246, 163604
    s_mov_b64 exec, 1
    ds_add_u32 v246, v253
    s_mov_b64 exec, -1
KF_PUB2:
    v_mov_b32 v246, 163604
    s_cmp_lt_u32 s40, 4
    s_cselect_b32 s3, 0, s1
    s_cmp_lg_u32 s3, 0
    s_cbranch_scc1 KF_PS_X
KF_PS:
    ds_read_b32 v247, v246
    s_waitcnt lgkmcnt(0)
    v_readfirstlane_b32 s3, v247
    s_add_u32 s77, s77, 1
    s_cmp_gt_u32 s77, 6400000
    s_cbranch_scc1 KF_PS_X
    s_nop 0
    s_cmp_ge_u32 s3, 9
    s_cbranch_scc1 KF_PS_X
    s_sleep 1
    s_branch KF_PS
KF_PS_X:
    s_add_u32 s3, s40, 0
    s_and_b32 s3, s3, 3
    s_lshl_b32 s3, s3, 10
    v_add_u32 v232, s3, v251
    s_add_u32 s3, s40, 1
    s_and_b32 s3, s3, 3
    s_lshl_b32 s3, s3, 10
    v_add_u32 v233, s3, v251
    s_add_u32 s3, s40, 2
    s_and_b32 s3, s3, 3
    s_lshl_b32 s3, s3, 10
    v_add_u32 v234, s3, v251
    s_add_u32 s3, s40, 3
    s_and_b32 s3, s3, 3
    s_lshl_b32 s3, s3, 10
    v_add_u32 v235, s3, v251
    s_cmp_ge_u32 s40, 4
    s_cbranch_scc1 KF_SW
    s_cmp_lg_u32 s24, 2
    s_cbranch_scc1 KF_NQW
    buffer_load_dwordx4 v[206:209], v251, s[16:19], s75 offen offset:0 sc1
    s_waitcnt vmcnt(12)
    buffer_load_dwordx4 v[210:213], v251, s[16:19], s75 offen offset:1024 sc1
    s_waitcnt vmcnt(12)
    buffer_load_dwordx4 v[214:217], v251, s[16:19], s75 offen offset:2048 sc1
    s_waitcnt vmcnt(12)
    buffer_load_dwordx4 v[218:221], v251, s[16:19], s75 offen offset:3072 sc1
    s_waitcnt vmcnt(12)
    buffer_load_dwordx4 v[222:225], v252, s[16:19], s75 offen sc1
    s_add_u32 s75, s75, 40960
    s_waitcnt vmcnt(12)
    buffer_load_dwordx4 v[146:149], v251, s[16:19], s75 offen offset:0 sc1
    s_waitcnt vmcnt(12)
    buffer_load_dwordx4 v[150:153], v251, s[16:19], s75 offen offset:1024 sc1
    s_waitcnt vmcnt(12)
    buffer_load_dwordx4 v[154:157], v251, s[16:19], s75 offen offset:2048 sc1
    s_waitcnt vmcnt(12)
    buffer_load_dwordx4 v[158:161], v251, s[16:19], s75 offen offset:3072 sc1
    s_waitcnt vmcnt(12)
    buffer_load_dwordx4 v[162:165], v252, s[16:19], s75 offen sc1
    s_add_u32 s75, s75, 40960
    s_waitcnt vmcnt(12)
KF_NQW:
    v_add_u32 v245, 81920, v249
    v_min_u32 v243, 8, v250
    v_lshlrev_b32 v243, 11, v243
    s_lshr_b32 s3, s28, 1
    s_lshl_b32 s3, s3, 7
    s_add_u32 s51, s3, 20021248
    s_sub_u32 s3, s40, 1
    s_and_b32 s3, s3, 3
    s_mul_i32 s3, s3, 20480
    s_add_u32 s3, s3, 0
    v_add_u32 v240, s3, v251
    s_sub_u32 s3, s40, 2
    s_and_b32 s3, s3, 3
    s_mul_i32 s3, s3, 20480
    s_add_u32 s3, s3, 5120
    v_add_u32 v241, s3, v251
    s_sub_u32 s3, s40, 3
    s_and_b32 s3, s3, 3
    s_mul_i32 s3, s3, 20480
    s_add_u32 s3, s3, 10240
    v_add_u32 v242, s3, v251
    s_add_u32 m0, s48, 0
    s_nop 0
    buffer_load_dwordx4 v251, s[16:19], s75 offen offset:0 sc1 lds
    s_waitcnt vmcnt(12)
    s_add_u32 m0, s48, 0
    s_nop 0
    buffer_load_dwordx4 v251, s[16:19], s75 offen offset:1024 sc1 lds
    s_waitcnt vmcnt(12)
    s_add_u32 m0, s48, 0
    s_nop 0
    buffer_load_dwordx4 v251, s[16:19], s75 offen offset:2048 sc1 lds
    s_waitcnt vmcnt(12)
    s_add_u32 m0, s48, 0
    s_nop 0
    buffer_load_dwordx4 v251, s[16:19], s75 offen offset:3072 sc1 lds
    s_waitcnt vmcnt(12)
    s_add_u32 m0, s48, 4096
    s_nop 0
    buffer_load_dwordx4 v252, s[16:19], s75 offen sc1 lds
    s_waitcnt vmcnt(12)
    s_add_u32 s75, s75, 40960
    s_add_u32 m0, s48, 5120
    s_nop 0
    buffer_load_dwordx4 v251, s[16:19], s75 offen offset:0 sc1 lds
    s_waitcnt vmcnt(12)
    s_add_u32 m0, s48, 5120
    s_nop 0
    buffer_load_dwordx4 v251, s[16:19], s75 offen offset:1024 sc1 lds
    s_waitcnt vmcnt(12)
    s_add_u32 m0, s48, 5120
    s_nop 0
    buffer_load_dwordx4 v251, s[16:19], s75 offen offset:2048 sc1 lds
    s_waitcnt vmcnt(12)
    s_add_u32 m0, s48, 5120
    s_nop 0
    buffer_load_dwordx4 v251, s[16:19], s75 offen offset:3072 sc1 lds
    s_waitcnt vmcnt(12)
    s_add_u32 m0, s48, 9216
    s_nop 0
    buffer_load_dwordx4 v252, s[16:19], s75 offen sc1 lds
    s_waitcnt vmcnt(12)
    s_add_u32 s75, s75, 40960
    s_add_u32 m0, s48, 10240
    s_nop 0
    buffer_load_dwordx4 v251, s[16:19], s75 offen offset:0 sc1 lds
    s_waitcnt vmcnt(12)
    s_add_u32 m0, s48, 10240
    s_nop 0
    buffer_load_dwordx4 v251, s[16:19], s75 offen offset:1024 sc1 lds
    s_waitcnt vmcnt(12)
    s_add_u32 m0, s48, 10240
    s_nop 0
    buffer_load_dwordx4 v251, s[16:19], s75 offen offset:2048 sc1 lds
    s_waitcnt vmcnt(12)
    s_add_u32 m0, s48, 10240
    s_nop 0
    buffer_load_dwordx4 v251, s[16:19], s75 offen offset:3072 sc1 lds
    s_waitcnt vmcnt(12)
    s_add_u32 m0, s48, 14336
    s_nop 0
    buffer_load_dwordx4 v252, s[16:19], s75 offen sc1 lds
    s_waitcnt vmcnt(12)
    s_add_u32 s75, s75, 40960
    s_add_u32 m0, s48, 15360
    s_nop 0
    buffer_load_dwordx4 v251, s[16:19], s75 offen offset:0 sc1 lds
    s_waitcnt vmcnt(12)
    s_add_u32 m0, s48, 15360
    s_nop 0
    buffer_load_dwordx4 v251, s[16:19], s75 offen offset:1024 sc1 lds
    s_waitcnt vmcnt(12)
    s_add_u32 m0, s48, 15360
    s_nop 0
    buffer_load_dwordx4 v251, s[16:19], s75 offen offset:2048 sc1 lds
    s_waitcnt vmcnt(12)
    s_add_u32 m0, s48, 15360
    s_nop 0
    buffer_load_dwordx4 v251, s[16:19], s75 offen offset:3072 sc1 lds
    s_waitcnt vmcnt(12)
    s_add_u32 m0, s48, 19456
    s_nop 0
    buffer_load_dwordx4 v252, s[16:19], s75 offen sc1 lds
    s_waitcnt vmcnt(12)
    s_add_u32 s75, s75, 40960
    s_cmp_lg_u32 s24, 0
    s_cbranch_scc1 KF_S4
    s_add_u32 s75, s75, 81920
    s_branch KF_SK
KF_S4:
    s_add_u32 m0, s48, 81920
    s_nop 0
    buffer_load_dwordx4 v251, s[16:19], s75 offen offset:0 sc1 lds
    s_waitcnt vmcnt(12)
    s_add_u32 m0, s48, 81920
    s_nop 0
    buffer_load_dwordx4 v251, s[16:19], s75 offen offset:1024 sc1 lds
    s_waitcnt vmcnt(12)
    s_add_u32 m0, s48, 81920
    s_nop 0
    buffer_load_dwordx4 v251, s[16:19], s75 offen offset:2048 sc1 lds
    s_waitcnt vmcnt(12)
    s_add_u32 m0, s48, 81920
    s_nop 0
    buffer_load_dwordx4 v251, s[16:19], s75 offen offset:3072 sc1 lds
    s_waitcnt vmcnt(12)
    s_add_u32 m0, s48, 86016
    s_nop 0
    buffer_load_dwordx4 v252, s[16:19], s75 offen sc1 lds
    s_waitcnt vmcnt(12)
    s_add_u32 s75, s75, 40960
    s_add_u32 m0, s48, 87040
    s_nop 0
    buffer_load_dwordx4 v251, s[16:19], s75 offen offset:0 sc1 lds
    s_waitcnt vmcnt(12)
    s_add_u32 m0, s48, 87040
    s_nop 0
    buffer_load_dwordx4 v251, s[16:19], s75 offen offset:1024 sc1 lds
    s_waitcnt vmcnt(12)
    s_add_u32 m0, s48, 87040
    s_nop 0
    buffer_load_dwordx4 v251, s[16:19], s75 offen offset:2048 sc1 lds
    s_waitcnt vmcnt(12)
    s_add_u32 m0, s48, 87040
    s_nop 0
    buffer_load_dwordx4 v251, s[16:19], s75 offen offset:3072 sc1 lds
    s_waitcnt vmcnt(12)
    s_add_u32 m0, s48, 91136
    s_nop 0
    buffer_load_dwordx4 v252, s[16:19], s75 offen sc1 lds
    s_waitcnt vmcnt(12)
    s_add_u32 s75, s75, 40960
KF_SK:
    s_add_u32 m0, s48, 92160
    s_nop 0
    buffer_load_dwordx4 v251, s[16:19], s75 offen offset:0 sc1 lds
    s_waitcnt vmcnt(12)
    s_add_u32 m0, s48, 92160
    s_nop 0
    buffer_load_dwordx4 v251, s[16:19], s75 offen offset:1024 sc1 lds
    s_waitcnt vmcnt(12)
    s_add_u32 m0, s48, 92160
    s_nop 0
    buffer_load_dwordx4 v251, s[16:19], s75 offen offset:2048 sc1 lds
    s_waitcnt vmcnt(12)
    s_add_u32 m0, s48, 92160
    s_nop 0
    buffer_load_dwordx4 v251, s[16:19], s75 offen offset:3072 sc1 lds
    s_waitcnt vmcnt(12)
    s_add_u32 m0, s48, 96256
    s_nop 0
    buffer_load_dwordx4 v252, s[16:19], s75 offen sc1 lds
    s_waitcnt vmcnt(12)
    s_add_u32 s75, s75, 40960
    s_cmp_ge_u32 s40, 2
    s_cbranch_scc1 KF_NOS6
    s_add_u32 m0, s48, 97280
    s_nop 0
    buffer_load_dwordx4 v251, s[16:19], s75 offen offset:0 sc1 lds
    s_waitcnt vmcnt(12)
    s_add_u32 m0, s48, 97280
    s_nop 0
    buffer_load_dwordx4 v251, s[16:19], s75 offen offset:1024 sc1 lds
    s_waitcnt vmcnt(12)
    s_add_u32 m0, s48, 97280
    s_nop 0
    buffer_load_dwordx4 v251, s[16:19], s75 offen offset:2048 sc1 lds
    s_waitcnt vmcnt(12)
    s_add_u32 m0, s48, 97280
    s_nop 0
    buffer_load_dwordx4 v251, s[16:19], s75 offen offset:3072 sc1 lds
    s_waitcnt vmcnt(12)
    s_add_u32 m0, s48, 101376
    s_nop 0
    buffer_load_dwordx4 v252, s[16:19], s75 offen sc1 lds
    s_waitcnt vmcnt(12)
    s_add_u32 s75, s75, 40960
KF_NOS6:
    v_mov_b32 v246, 163584
    s_cmp_lg_u32 s40, 0
    s_cbranch_scc1 KF_WH_F
    s_mov_b64 exec, 0x1ff
KF_WH_L:
    buffer_load_dword v247, v243, s[16:19], s51 offen sc1
    s_waitcnt vmcnt(0)
    v_cmp_ne_u32 vcc, s65, v247
    s_add_u32 s77, s77, 1
    s_cmp_gt_u32 s77, 100000
    s_cbranch_scc1 KF_WH_X
    s_nop 2
    s_cbranch_vccz KF_WH_X
    s_mov_b64 exec, vcc
    s_sleep 3
    s_branch KF_WH_L
KF_WH_X:
    s_mov_b64 exec, -1
    v_mov_b32 v247, 1
    ds_write_b32 v246, v247
    s_branch KF_WH_D
KF_WH_F:
KF_WH_S:
    ds_read_b32 v247, v246
    s_waitcnt lgkmcnt(0)
    v_readfirstlane_b32 s3, v247
    s_add_u32 s77, s77, 1
    s_cmp_gt_u32 s77, 6400000
    s_cbranch_scc1 KF_WH_S_X
    s_nop 0
    s_cmp_ge_u32 s3, 1
    s_cbranch_scc1 KF_WH_S_X
    s_sleep 1
    s_branch KF_WH_S
KF_WH_S_X:
KF_WH_D:
    s_setprio 2
    buffer_load_dwordx4 v[80:83], v232, s[36:39], s41 offen sc1
    buffer_load_dwordx4 v[84:87], v233, s[36:39], s41 offen sc1
    buffer_load_dwordx4 v[88:91], v234, s[36:39], s41 offen sc1
    buffer_load_dwordx4 v[92:95], v235, s[36:39], s41 offen sc1
    s_add_u32 s41, s41, 4096
    buffer_load_dwordx4 v[96:99], v232, s[36:39], s41 offen sc1
    buffer_load_dwordx4 v[100:103], v233, s[36:39], s41 offen sc1
    buffer_load_dwordx4 v[104:107], v234, s[36:39], s41 offen sc1
    buffer_load_dwordx4 v[108:111], v235, s[36:39], s41 offen sc1
    s_add_u32 s41, s41, 4096
    buffer_load_dwordx4 v[112:115], v232, s[36:39], s41 offen sc1
    buffer_load_dwordx4 v[116:119], v233, s[36:39], s41 offen sc1
    buffer_load_dwordx4 v[120:123], v234, s[36:39], s41 offen sc1
    buffer_load_dwordx4 v[124:127], v235, s[36:39], s41 offen sc1
    s_add_u32 s41, s41, 4096
    s_waitcnt vmcnt(8)
    v_mfma_f32_16x16x32_bf16 v[0:3], v[166:169], v[80:83], 0
    v_mfma_f32_16x16x32_bf16 v[20:23], v[166:169], v[84:87], 0
    buffer_load_dwordx4 v[128:131], v232, s[36:39], s41 offen sc1
    v_mfma_f32_16x16x32_bf16 v[40:43], v[166:169], v[88:91], 0
    v_mfma_f32_16x16x32_bf16 v[60:63], v[166:169], v[92:95], 0
    buffer_load_dwordx4 v[132:135], v233, s[36:39], s41 offen sc1
    v_mfma_f32_16x16x32_bf16 v[4:7], v[170:173], v[80:83], 0
    v_mfma_f32_16x16x32_bf16 v[24:27], v[170:173], v[84:87], 0
    buffer_load_dwordx4 v[136:139], v234, s[36:39], s41 offen sc1
    v_mfma_f32_16x16x32_bf16 v[44:47], v[170:173], v[88:91], 0
    v_mfma_f32_16x16x32_bf16 v[64:67], v[170:173], v[92:95], 0
    buffer_load_dwordx4 v[140:143], v235, s[36:39], s41 offen sc1
    s_add_u32 s41, s41, 4096
    v_mfma_f32_16x16x32_bf16 v[8:11], v[174:177], v[80:83], 0
    v_mfma_f32_16x16x32_bf16 v[28:31], v[174:177], v[84:87], 0
    v_mfma_f32_16x16x32_bf16 v[48:51], v[174:177], v[88:91], 0
    v_mfma_f32_16x16x32_bf16 v[68:71], v[174:177], v[92:95], 0
    v_mfma_f32_16x16x32_bf16 v[12:15], v[178:181], v[80:83], 0
    v_mfma_f32_16x16x32_bf16 v[32:35], v[178:181], v[84:87], 0
    v_mfma_f32_16x16x32_bf16 v[52:55], v[178:181], v[88:91], 0
    v_mfma_f32_16x16x32_bf16 v[72:75], v[178:181], v[92:95], 0
    v_mfma_f32_16x16x32_bf16 v[16:19], v[182:185], v[80:83], 0
    v_mfma_f32_16x16x32_bf16 v[36:39], v[182:185], v[84:87], 0
    v_mfma_f32_16x16x32_bf16 v[56:59], v[182:185], v[88:91], 0
    v_mfma_f32_16x16x32_bf16 v[76:79], v[182:185], v[92:95], 0
    s_waitcnt vmcnt(8)
    v_mfma_f32_16x16x32_bf16 v[0:3], v[186:189], v[96:99], v[0:3]
    v_mfma_f32_16x16x32_bf16 v[20:23], v[186:189], v[100:103], v[20:23]
    buffer_load_dwordx4 v[80:83], v232, s[36:39], s41 offen sc1
    v_mfma_f32_16x16x32_bf16 v[40:43], v[186:189], v[104:107], v[40:43]
    v_mfma_f32_16x16x32_bf16 v[60:63], v[186:189], v[108:111], v[60:63]
    buffer_load_dwordx4 v[84:87], v233, s[36:39], s41 offen sc1
    v_mfma_f32_16x16x32_bf16 v[4:7], v[190:193], v[96:99], v[4:7]
    v_mfma_f32_16x16x32_bf16 v[24:27], v[190:193], v[100:103], v[24:27]
    buffer_load_dwordx4 v[88:91], v234, s[36:39], s41 offen sc1
    v_mfma_f32_16x16x32_bf16 v[44:47], v[190:193], v[104:107], v[44:47]
    v_mfma_f32_16x16x32_bf16 v[64:67], v[190:193], v[108:111], v[64:67]
    buffer_load_dwordx4 v[92:95], v235, s[36:39], s41 offen sc1
    s_add_u32 s41, s41, 4096
    v_mfma_f32_16x16x32_bf16 v[8:11], v[194:197], v[96:99], v[8:11]
    v_mfma_f32_16x16x32_bf16 v[28:31], v[194:197], v[100:103], v[28:31]
    ds_read_b128 v[166:169], v249 offset:0
    v_mfma_f32_16x16x32_bf16 v[48:51], v[194:197], v[104:107], v[48:51]
    v_mfma_f32_16x16x32_bf16 v[68:71], v[194:197], v[108:111], v[68:71]
    ds_read_b128 v[170:173], v249 offset:1024
    v_mfma_f32_16x16x32_bf16 v[12:15], v[198:201], v[96:99], v[12:15]
    v_mfma_f32_16x16x32_bf16 v[32:35], v[198:201], v[100:103], v[32:35]
    ds_read_b128 v[174:177], v249 offset:2048
    v_mfma_f32_16x16x32_bf16 v[52:55], v[198:201], v[104:107], v[52:55]
    v_mfma_f32_16x16x32_bf16 v[72:75], v[198:201], v[108:111], v[72:75]
    ds_read_b128 v[178:181], v249 offset:3072
    v_mfma_f32_16x16x32_bf16 v[16:19], v[202:205], v[96:99], v[16:19]
    v_mfma_f32_16x16x32_bf16 v[36:39], v[202:205], v[100:103], v[36:39]
    ds_read_b128 v[182:185], v249 offset:4096
    v_mfma_f32_16x16x32_bf16 v[56:59], v[202:205], v[104:107], v[56:59]
    v_mfma_f32_16x16x32_bf16 v[76:79], v[202:205], v[108:111], v[76:79]
    s_waitcnt vmcnt(8)
    v_mfma_f32_16x16x32_bf16 v[0:3], v[206:209], v[112:115], v[0:3]
    v_mfma_f32_16x16x32_bf16 v[20:23], v[206:209], v[116:119], v[20:23]
    buffer_load_dwordx4 v[96:99], v232, s[36:39], s41 offen sc1
    v_mfma_f32_16x16x32_bf16 v[40:43], v[206:209], v[120:123], v[40:43]
    v_mfma_f32_16x16x32_bf16 v[60:63], v[206:209], v[124:127], v[60:63]
    buffer_load_dwordx4 v[100:103], v233, s[36:39], s41 offen sc1
    v_mfma_f32_16x16x32_bf16 v[4:7], v[210:213], v[112:115], v[4:7]
    v_mfma_f32_16x16x32_bf16 v[24:27], v[210:213], v[116:119], v[24:27]
    buffer_load_dwordx4 v[104:107], v234, s[36:39], s41 offen sc1
    v_mfma_f32_16x16x32_bf16 v[44:47], v[210:213], v[120:123], v[44:47]
    v_mfma_f32_16x16x32_bf16 v[64:67], v[210:213], v[124:127], v[64:67]
    buffer_load_dwordx4 v[108:111], v235, s[36:39], s41 offen sc1
    s_add_u32 s41, s41, 4096
    v_mfma_f32_16x16x32_bf16 v[8:11], v[214:217], v[112:115], v[8:11]
    v_mfma_f32_16x16x32_bf16 v[28:31], v[214:217], v[116:119], v[28:31]
    ds_read_b128 v[186:189], v249 offset:5120
    v_mfma_f32_16x16x32_bf16 v[48:51], v[214:217], v[120:123], v[48:51]
    v_mfma_f32_16x16x32_bf16 v[68:71], v[214:217], v[124:127], v[68:71]
    ds_read_b128 v[190:193], v249 offset:6144
    v_mfma_f32_16x16x32_bf16 v[12:15], v[218:221], v[112:115], v[12:15]
    v_mfma_f32_16x16x32_bf16 v[32:35], v[218:221], v[116:119], v[32:35]
    ds_read_b128 v[194:197], v249 offset:7168
    v_mfma_f32_16x16x32_bf16 v[52:55], v[218:221], v[120:123], v[52:55]
    v_mfma_f32_16x16x32_bf16 v[72:75], v[218:221], v[124:127], v[72:75]
    ds_read_b128 v[198:201], v249 offset:8192
    v_mfma_f32_16x16x32_bf16 v[16:19], v[222:225], v[112:115], v[16:19]
    v_mfma_f32_16x16x32_bf16 v[36:39], v[222:225], v[116:119], v[36:39]
    ds_read_b128 v[202:205], v249 offset:9216
    v_mfma_f32_16x16x32_bf16 v[56:59], v[222:225], v[120:123], v[56:59]
    v_mfma_f32_16x16x32_bf16 v[76:79], v[222:225], v[124:127], v[76:79]
    s_waitcnt vmcnt(8)
    v_mfma_f32_16x16x32_bf16 v[0:3], v[146:149], v[128:131], v[0:3]
    v_mfma_f32_16x16x32_bf16 v[20:23], v[146:149], v[132:135], v[20:23]
    buffer_load_dwordx4 v[112:115], v232, s[36:39], s41 offen sc1
    v_mfma_f32_16x16x32_bf16 v[40:43], v[146:149], v[136:139], v[40:43]
    v_mfma_f32_16x16x32_bf16 v[60:63], v[146:149], v[140:143], v[60:63]
    buffer_load_dwordx4 v[116:119], v233, s[36:39], s41 offen sc1
    v_mfma_f32_16x16x32_bf16 v[4:7], v[150:153], v[128:131], v[4:7]
    v_mfma_f32_16x16x32_bf16 v[24:27], v[150:153], v[132:135], v[24:27]
    buffer_load_dwordx4 v[120:123], v234, s[36:39], s41 offen sc1
    v_mfma_f32_16x16x32_bf16 v[44:47], v[150:153], v[136:139], v[44:47]
    v_mfma_f32_16x16x32_bf16 v[64:67], v[150:153], v[140:143], v[64:67]
    buffer_load_dwordx4 v[124:127], v235, s[36:39], s41 offen sc1
    s_add_u32 s41, s41, 4096
    v_mfma_f32_16x16x32_bf16 v[8:11], v[154:157], v[128:131], v[8:11]
    v_mfma_f32_16x16x32_bf16 v[28:31], v[154:157], v[132:135], v[28:31]
    ds_read_b128 v[206:209], v249 offset:10240
    v_mfma_f32_16x16x32_bf16 v[48:51], v[154:157], v[136:139], v[48:51]
    v_mfma_f32_16x16x32_bf16 v[68:71], v[154:157], v[140:143], v[68:71]
    ds_read_b128 v[210:213], v249 offset:11264
    v_mfma_f32_16x16x32_bf16 v[12:15], v[158:161], v[128:131], v[12:15]
    v_mfma_f32_16x16x32_bf16 v[32:35], v[158:161], v[132:135], v[32:35]
    ds_read_b128 v[214:217], v249 offset:12288
    v_mfma_f32_16x16x32_bf16 v[52:55], v[158:161], v[136:139], v[52:55]
    v_mfma_f32_16x16x32_bf16 v[72:75], v[158:161], v[140:143], v[72:75]
    ds_read_b128 v[218:221], v249 offset:13312
    v_mfma_f32_16x16x32_bf16 v[16:19], v[162:165], v[128:131], v[16:19]
    v_mfma_f32_16x16x32_bf16 v[36:39], v[162:165], v[132:135], v[36:39]
    ds_read_b128 v[222:225], v249 offset:14336
    v_mfma_f32_16x16x32_bf16 v[56:59], v[162:165], v[136:139], v[56:59]
    v_mfma_f32_16x16x32_bf16 v[76:79], v[162:165], v[140:143], v[76:79]
    s_waitcnt vmcnt(8) lgkmcnt(10)
    v_mfma_f32_16x16x32_bf16 v[0:3], v[166:169], v[80:83], v[0:3]
    v_mfma_f32_16x16x32_bf16 v[20:23], v[166:169], v[84:87], v[20:23]
    buffer_load_dwordx4 v[128:131], v232, s[36:39], s41 offen sc1
    v_mfma_f32_16x16x32_bf16 v[40:43], v[166:169], v[88:91], v[40:43]
    v_mfma_f32_16x16x32_bf16 v[60:63], v[166:169], v[92:95], v[60:63]
    buffer_load_dwordx4 v[132:135], v233, s[36:39], s41 offen sc1
    v_mfma_f32_16x16x32_bf16 v[4:7], v[170:173], v[80:83], v[4:7]
    v_mfma_f32_16x16x32_bf16 v[24:27], v[170:173], v[84:87], v[24:27]
    buffer_load_dwordx4 v[136:139], v234, s[36:39], s41 offen sc1
    v_mfma_f32_16x16x32_bf16 v[44:47], v[170:173], v[88:91], v[44:47]
    v_mfma_f32_16x16x32_bf16 v[64:67], v[170:173], v[92:95], v[64:67]
    buffer_load_dwordx4 v[140:143], v235, s[36:39], s41 offen sc1
    s_add_u32 s41, s41, 4096
    v_mfma_f32_16x16x32_bf16 v[8:11], v[174:177], v[80:83], v[8:11]
    v_mfma_f32_16x16x32_bf16 v[28:31], v[174:177], v[84:87], v[28:31]
    ds_read_b128 v[146:149], v249 offset:15360
    v_mfma_f32_16x16x32_bf16 v[48:51], v[174:177], v[88:91], v[48:51]
    v_mfma_f32_16x16x32_bf16 v[68:71], v[174:177], v[92:95], v[68:71]
    ds_read_b128 v[150:153], v249 offset:16384
    v_mfma_f32_16x16x32_bf16 v[12:15], v[178:181], v[80:83], v[12:15]
    v_mfma_f32_16x16x32_bf16 v[32:35], v[178:181], v[84:87], v[32:35]
    ds_read_b128 v[154:157], v249 offset:17408
    v_mfma_f32_16x16x32_bf16 v[52:55], v[178:181], v[88:91], v[52:55]
    v_mfma_f32_16x16x32_bf16 v[72:75], v[178:181], v[92:95], v[72:75]
    ds_read_b128 v[158:161], v249 offset:18432
    v_mfma_f32_16x16x32_bf16 v[16:19], v[182:185], v[80:83], v[16:19]
    v_mfma_f32_16x16x32_bf16 v[36:39], v[182:185], v[84:87], v[36:39]
    ds_read_b128 v[162:165], v249 offset:19456
    v_mfma_f32_16x16x32_bf16 v[56:59], v[182:185], v[88:91], v[56:59]
    v_mfma_f32_16x16x32_bf16 v[76:79], v[182:185], v[92:95], v[76:79]
    s_waitcnt vmcnt(8) lgkmcnt(10)
    v_mfma_f32_16x16x32_bf16 v[0:3], v[186:189], v[96:99], v[0:3]
    v_mfma_f32_16x16x32_bf16 v[20:23], v[186:189], v[100:103], v[20:23]
    buffer_load_dwordx4 v[80:83], v232, s[36:39], s41 offen sc1
    v_mfma_f32_16x16x32_bf16 v[40:43], v[186:189], v[104:107], v[40:43]
    v_mfma_f32_16x16x32_bf16 v[60:63], v[186:189], v[108:111], v[60:63]
    buffer_load_dwordx4 v[84:87], v233, s[36:39], s41 offen sc1
    v_mfma_f32_16x16x32_bf16 v[4:7], v[190:193], v[96:99], v[4:7]
    v_mfma_f32_16x16x32_bf16 v[24:27], v[190:193], v[100:103], v[24:27]
    buffer_load_dwordx4 v[88:91], v234, s[36:39], s41 offen sc1
    v_mfma_f32_16x16x32_bf16 v[44:47], v[190:193], v[104:107], v[44:47]
    v_mfma_f32_16x16x32_bf16 v[64:67], v[190:193], v[108:111], v[64:67]
    buffer_load_dwordx4 v[92:95], v235, s[36:39], s41 offen sc1
    s_add_u32 s41, s41, 4096
    v_mfma_f32_16x16x32_bf16 v[8:11], v[194:197], v[96:99], v[8:11]
    v_mfma_f32_16x16x32_bf16 v[28:31], v[194:197], v[100:103], v[28:31]
    ds_read_b128 v[166:169], v245 offset:0
    v_mfma_f32_16x16x32_bf16 v[48:51], v[194:197], v[104:107], v[48:51]
    v_mfma_f32_16x16x32_bf16 v[68:71], v[194:197], v[108:111], v[68:71]
    ds_read_b128 v[170:173], v245 offset:1024
    v_mfma_f32_16x16x32_bf16 v[12:15], v[198:201], v[96:99], v[12:15]
    v_mfma_f32_16x16x32_bf16 v[32:35], v[198:201], v[100:103], v[32:35]
    ds_read_b128 v[174:177], v245 offset:2048
    v_mfma_f32_16x16x32_bf16 v[52:55], v[198:201], v[104:107], v[52:55]
    v_mfma_f32_16x16x32_bf16 v[72:75], v[198:201], v[108:111], v[72:75]
    ds_read_b128 v[178:181], v245 offset:3072
    v_mfma_f32_16x16x32_bf16 v[16:19], v[202:205], v[96:99], v[16:19]
    v_mfma_f32_16x16x32_bf16 v[36:39], v[202:205], v[100:103], v[36:39]
    ds_read_b128 v[182:185], v245 offset:4096
    v_mfma_f32_16x16x32_bf16 v[56:59], v[202:205], v[104:107], v[56:59]
    v_mfma_f32_16x16x32_bf16 v[76:79], v[202:205], v[108:111], v[76:79]
    s_waitcnt vmcnt(8) lgkmcnt(10)
    v_mfma_f32_16x16x32_bf16 v[0:3], v[206:209], v[112:115], v[0:3]
    v_mfma_f32_16x16x32_bf16 v[20:23], v[206:209], v[116:119], v[20:23]
    buffer_load_dwordx4 v[96:99], v232, s[36:39], s41 offen sc1
    v_mfma_f32_16x16x32_bf16 v[40:43], v[206:209], v[120:123], v[40:43]
    v_mfma_f32_16x16x32_bf16 v[60:63], v[206:209], v[124:127], v[60:63]
    buffer_load_dwordx4 v[100:103], v233, s[36:39], s41 offen sc1
    v_mfma_f32_16x16x32_bf16 v[4:7], v[210:213], v[112:115], v[4:7]
    v_mfma_f32_16x16x32_bf16 v[24:27], v[210:213], v[116:119], v[24:27]
    buffer_load_dwordx4 v[104:107], v234, s[36:39], s41 offen sc1
    v_mfma_f32_16x16x32_bf16 v[44:47], v[210:213], v[120:123], v[44:47]
    v_mfma_f32_16x16x32_bf16 v[64:67], v[210:213], v[124:127], v[64:67]
    buffer_load_dwordx4 v[108:111], v235, s[36:39], s41 offen sc1
    s_add_u32 s41, s41, 4096
    v_mfma_f32_16x16x32_bf16 v[8:11], v[214:217], v[112:115], v[8:11]
    v_mfma_f32_16x16x32_bf16 v[28:31], v[214:217], v[116:119], v[28:31]
    ds_read_b128 v[186:189], v245 offset:5120
    v_mfma_f32_16x16x32_bf16 v[48:51], v[214:217], v[120:123], v[48:51]
    v_mfma_f32_16x16x32_bf16 v[68:71], v[214:217], v[124:127], v[68:71]
    ds_read_b128 v[190:193], v245 offset:6144
    v_mfma_f32_16x16x32_bf16 v[12:15], v[218:221], v[112:115], v[12:15]
    v_mfma_f32_16x16x32_bf16 v[32:35], v[218:221], v[116:119], v[32:35]
    ds_read_b128 v[194:197], v245 offset:7168
    v_mfma_f32_16x16x32_bf16 v[52:55], v[218:221], v[120:123], v[52:55]
    v_mfma_f32_16x16x32_bf16 v[72:75], v[218:221], v[124:127], v[72:75]
    ds_read_b128 v[198:201], v245 offset:8192
    v_mfma_f32_16x16x32_bf16 v[16:19], v[222:225], v[112:115], v[16:19]
    v_mfma_f32_16x16x32_bf16 v[36:39], v[222:225], v[116:119], v[36:39]
    ds_read_b128 v[202:205], v245 offset:9216
    v_mfma_f32_16x16x32_bf16 v[56:59], v[222:225], v[120:123], v[56:59]
    v_mfma_f32_16x16x32_bf16 v[76:79], v[222:225], v[124:127], v[76:79]
    s_waitcnt vmcnt(8) lgkmcnt(10)
    v_mfma_f32_16x16x32_bf16 v[0:3], v[146:149], v[128:131], v[0:3]
    v_mfma_f32_16x16x32_bf16 v[20:23], v[146:149], v[132:135], v[20:23]
    buffer_load_dwordx4 v[112:115], v232, s[36:39], s41 offen sc1
    v_mfma_f32_16x16x32_bf16 v[40:43], v[146:149], v[136:139], v[40:43]
    v_mfma_f32_16x16x32_bf16 v[60:63], v[146:149], v[140:143], v[60:63]
    buffer_load_dwordx4 v[116:119], v233, s[36:39], s41 offen sc1
    v_mfma_f32_16x16x32_bf16 v[4:7], v[150:153], v[128:131], v[4:7]
    v_mfma_f32_16x16x32_bf16 v[24:27], v[150:153], v[132:135], v[24:27]
    buffer_load_dwordx4 v[120:123], v234, s[36:39], s41 offen sc1
    v_mfma_f32_16x16x32_bf16 v[44:47], v[150:153], v[136:139], v[44:47]
    v_mfma_f32_16x16x32_bf16 v[64:67], v[150:153], v[140:143], v[64:67]
    buffer_load_dwordx4 v[124:127], v235, s[36:39], s41 offen sc1
    s_add_u32 s41, s41, 4096
    v_mfma_f32_16x16x32_bf16 v[8:11], v[154:157], v[128:131], v[8:11]
    v_mfma_f32_16x16x32_bf16 v[28:31], v[154:157], v[132:135], v[28:31]
    ds_read_b128 v[206:209], v245 offset:10240
    v_mfma_f32_16x16x32_bf16 v[48:51], v[154:157], v[136:139], v[48:51]
    v_mfma_f32_16x16x32_bf16 v[68:71], v[154:157], v[140:143], v[68:71]
    ds_read_b128 v[210:213], v245 offset:11264
    v_mfma_f32_16x16x32_bf16 v[12:15], v[158:161], v[128:131], v[12:15]
    v_mfma_f32_16x16x32_bf16 v[32:35], v[158:161], v[132:135], v[32:35]
    ds_read_b128 v[214:217], v245 offset:12288
    v_mfma_f32_16x16x32_bf16 v[52:55], v[158:161], v[136:139], v[52:55]
    v_mfma_f32_16x16x32_bf16 v[72:75], v[158:161], v[140:143], v[72:75]
    ds_read_b128 v[218:221], v245 offset:13312
    v_mfma_f32_16x16x32_bf16 v[16:19], v[162:165], v[128:131], v[16:19]
    v_mfma_f32_16x16x32_bf16 v[36:39], v[162:165], v[132:135], v[36:39]
    ds_read_b128 v[222:225], v245 offset:14336
    v_mfma_f32_16x16x32_bf16 v[56:59], v[162:165], v[136:139], v[56:59]
    v_mfma_f32_16x16x32_bf16 v[76:79], v[162:165], v[140:143], v[76:79]
    s_waitcnt vmcnt(8) lgkmcnt(10)
    v_mfma_f32_16x16x32_bf16 v[0:3], v[166:169], v[80:83], v[0:3]
    v_mfma_f32_16x16x32_bf16 v[20:23], v[166:169], v[84:87], v[20:23]
    buffer_load_dwordx4 v[128:131], v232, s[36:39], s41 offen sc1
    v_mfma_f32_16x16x32_bf16 v[40:43], v[166:169], v[88:91], v[40:43]
    v_mfma_f32_16x16x32_bf16 v[60:63], v[166:169], v[92:95], v[60:63]
    buffer_load_dwordx4 v[132:135], v233, s[36:39], s41 offen sc1
    v_mfma_f32_16x16x32_bf16 v[4:7], v[170:173], v[80:83], v[4:7]
    v_mfma_f32_16x16x32_bf16 v[24:27], v[170:173], v[84:87], v[24:27]
    buffer_load_dwordx4 v[136:139], v234, s[36:39], s41 offen sc1
    v_mfma_f32_16x16x32_bf16 v[44:47], v[170:173], v[88:91], v[44:47]
    v_mfma_f32_16x16x32_bf16 v[64:67], v[170:173], v[92:95], v[64:67]
    buffer_load_dwordx4 v[140:143], v235, s[36:39], s41 offen sc1
    s_add_u32 s41, s41, 4096
    s_cmp_ge_u32 s40, 2
    s_cselect_b32 s3, 4096, 0
    s_sub_u32 s41, s41, s3
    v_mfma_f32_16x16x32_bf16 v[8:11], v[174:177], v[80:83], v[8:11]
    v_mfma_f32_16x16x32_bf16 v[28:31], v[174:177], v[84:87], v[28:31]
    ds_read_b128 v[146:149], v245 offset:15360
    v_mfma_f32_16x16x32_bf16 v[48:51], v[174:177], v[88:91], v[48:51]
    v_mfma_f32_16x16x32_bf16 v[68:71], v[174:177], v[92:95], v[68:71]
    ds_read_b128 v[150:153], v245 offset:16384
    v_mfma_f32_16x16x32_bf16 v[12:15], v[178:181], v[80:83], v[12:15]
    v_mfma_f32_16x16x32_bf16 v[32:35], v[178:181], v[84:87], v[32:35]
    ds_read_b128 v[154:157], v245 offset:17408
    v_mfma_f32_16x16x32_bf16 v[52:55], v[178:181], v[88:91], v[52:55]
    v_mfma_f32_16x16x32_bf16 v[72:75], v[178:181], v[92:95], v[72:75]
    ds_read_b128 v[158:161], v245 offset:18432
    v_mfma_f32_16x16x32_bf16 v[16:19], v[182:185], v[80:83], v[16:19]
    v_mfma_f32_16x16x32_bf16 v[36:39], v[182:185], v[84:87], v[36:39]
    ds_read_b128 v[162:165], v245 offset:19456
    v_mfma_f32_16x16x32_bf16 v[56:59], v[182:185], v[88:91], v[56:59]
    v_mfma_f32_16x16x32_bf16 v[76:79], v[182:185], v[92:95], v[76:79]
    v_mov_b32 v246, 163620
    s_mov_b64 exec, 1
    ds_add_u32 v246, v253
    s_mov_b64 exec, -1
    s_waitcnt vmcnt(8) lgkmcnt(10)
    v_mfma_f32_16x16x32_bf16 v[0:3], v[186:189], v[96:99], v[0:3]
    v_mfma_f32_16x16x32_bf16 v[20:23], v[186:189], v[100:103], v[20:23]
    buffer_load_dwordx4 v[80:83], v232, s[36:39], s41 offen sc1
    v_mfma_f32_16x16x32_bf16 v[40:43], v[186:189], v[104:107], v[40:43]
    v_mfma_f32_16x16x32_bf16 v[60:63], v[186:189], v[108:111], v[60:63]
    buffer_load_dwordx4 v[84:87], v233, s[36:39], s41 offen sc1
    v_mfma_f32_16x16x32_bf16 v[4:7], v[190:193], v[96:99], v[4:7]
    v_mfma_f32_16x16x32_bf16 v[24:27], v[190:193], v[100:103], v[24:27]
    buffer_load_dwordx4 v[88:91], v234, s[36:39], s41 offen sc1
    v_mfma_f32_16x16x32_bf16 v[44:47], v[190:193], v[104:107], v[44:47]
    v_mfma_f32_16x16x32_bf16 v[64:67], v[190:193], v[108:111], v[64:67]
    buffer_load_dwordx4 v[92:95], v235, s[36:39], s41 offen sc1
    s_add_u32 s41, s41, 4096
    v_mfma_f32_16x16x32_bf16 v[8:11], v[194:197], v[96:99], v[8:11]
    v_mfma_f32_16x16x32_bf16 v[28:31], v[194:197], v[100:103], v[28:31]
    buffer_load_dwordx4 v[166:169], v251, s[16:19], s75 offen offset:0 sc1
    v_mfma_f32_16x16x32_bf16 v[48:51], v[194:197], v[104:107], v[48:51]
    v_mfma_f32_16x16x32_bf16 v[68:71], v[194:197], v[108:111], v[68:71]
    buffer_load_dwordx4 v[170:173], v251, s[16:19], s75 offen offset:1024 sc1
    v_mfma_f32_16x16x32_bf16 v[12:15], v[198:201], v[96:99], v[12:15]
    v_mfma_f32_16x16x32_bf16 v[32:35], v[198:201], v[100:103], v[32:35]
    buffer_load_dwordx4 v[174:177], v251, s[16:19], s75 offen offset:2048 sc1
    v_mfma_f32_16x16x32_bf16 v[52:55], v[198:201], v[104:107], v[52:55]
    v_mfma_f32_16x16x32_bf16 v[72:75], v[198:201], v[108:111], v[72:75]
    buffer_load_dwordx4 v[178:181], v251, s[16:19], s75 offen offset:3072 sc1
    v_mfma_f32_16x16x32_bf16 v[16:19], v[202:205], v[96:99], v[16:19]
    v_mfma_f32_16x16x32_bf16 v[36:39], v[202:205], v[100:103], v[36:39]
    buffer_load_dwordx4 v[182:185], v252, s[16:19], s75 offen sc1
    s_add_u32 s75, s75, 40960
    v_mfma_f32_16x16x32_bf16 v[56:59], v[202:205], v[104:107], v[56:59]
    v_mfma_f32_16x16x32_bf16 v[76:79], v[202:205], v[108:111], v[76:79]
    s_waitcnt vmcnt(13) lgkmcnt(5)
    v_mfma_f32_16x16x32_bf16 v[0:3], v[206:209], v[112:115], v[0:3]
    v_mfma_f32_16x16x32_bf16 v[20:23], v[206:209], v[116:119], v[20:23]
    buffer_load_dwordx4 v[96:99], v232, s[36:39], s41 offen sc1
    v_mfma_f32_16x16x32_bf16 v[40:43], v[206:209], v[120:123], v[40:43]
    v_mfma_f32_16x16x32_bf16 v[60:63], v[206:209], v[124:127], v[60:63]
    buffer_load_dwordx4 v[100:103], v233, s[36:39], s41 offen sc1
    v_mfma_f32_16x16x32_bf16 v[4:7], v[210:213], v[112:115], v[4:7]
    v_mfma_f32_16x16x32_bf16 v[24:27], v[210:213], v[116:119], v[24:27]
    buffer_load_dwordx4 v[104:107], v234, s[36:39], s41 offen sc1
    v_mfma_f32_16x16x32_bf16 v[44:47], v[210:213], v[120:123], v[44:47]
    v_mfma_f32_16x16x32_bf16 v[64:67], v[210:213], v[124:127], v[64:67]
    buffer_load_dwordx4 v[108:111], v235, s[36:39], s41 offen sc1
    s_add_u32 s41, s41, 4096
    v_mfma_f32_16x16x32_bf16 v[8:11], v[214:217], v[112:115], v[8:11]
    v_mfma_f32_16x16x32_bf16 v[28:31], v[214:217], v[116:119], v[28:31]
    buffer_load_dwordx4 v[186:189], v251, s[16:19], s75 offen offset:0 sc1
    v_mfma_f32_16x16x32_bf16 v[48:51], v[214:217], v[120:123], v[48:51]
    v_mfma_f32_16x16x32_bf16 v[68:71], v[214:217], v[124:127], v[68:71]
    buffer_load_dwordx4 v[190:193], v251, s[16:19], s75 offen offset:1024 sc1
    v_mfma_f32_16x16x32_bf16 v[12:15], v[218:221], v[112:115], v[12:15]
    v_mfma_f32_16x16x32_bf16 v[32:35], v[218:221], v[116:119], v[32:35]
    buffer_load_dwordx4 v[194:197], v251, s[16:19], s75 offen offset:2048 sc1
    v_mfma_f32_16x16x32_bf16 v[52:55], v[218:221], v[120:123], v[52:55]
    v_mfma_f32_16x16x32_bf16 v[72:75], v[218:221], v[124:127], v[72:75]
    buffer_load_dwordx4 v[198:201], v251, s[16:19], s75 offen offset:3072 sc1
    v_mfma_f32_16x16x32_bf16 v[16:19], v[222:225], v[112:115], v[16:19]
    v_mfma_f32_16x16x32_bf16 v[36:39], v[222:225], v[116:119], v[36:39]
    buffer_load_dwordx4 v[202:205], v252, s[16:19], s75 offen sc1
    s_add_u32 s75, s75, 40960
    v_mfma_f32_16x16x32_bf16 v[56:59], v[222:225], v[120:123], v[56:59]
    v_mfma_f32_16x16x32_bf16 v[76:79], v[222:225], v[124:127], v[76:79]
    v_mov_b32 v246, 163620
    s_mov_b64 exec, 1
    ds_add_u32 v246, v253
    s_mov_b64 exec, -1
    s_waitcnt vmcnt(18) lgkmcnt(0)
    s_cmp_ge_u32 s40, 2
    s_cbranch_scc1 KF_SKIP10
    v_mfma_f32_16x16x32_bf16 v[0:3], v[146:149], v[128:131], v[0:3]
    v_mfma_f32_16x16x32_bf16 v[20:23], v[146:149], v[132:135], v[20:23]
    v_mfma_f32_16x16x32_bf16 v[40:43], v[146:149], v[136:139], v[40:43]
    v_mfma_f32_16x16x32_bf16 v[60:63], v[146:149], v[140:143], v[60:63]
    v_mfma_f32_16x16x32_bf16 v[4:7], v[150:153], v[128:131], v[4:7]
    v_mfma_f32_16x16x32_bf16 v[24:27], v[150:153], v[132:135], v[24:27]
    v_mfma_f32_16x16x32_bf16 v[44:47], v[150:153], v[136:139], v[44:47]
    v_mfma_f32_16x16x32_bf16 v[64:67], v[150:153], v[140:143], v[64:67]
    v_mfma_f32_16x16x32_bf16 v[8:11], v[154:157], v[128:131], v[8:11]
    v_mfma_f32_16x16x32_bf16 v[28:31], v[154:157], v[132:135], v[28:31]
    v_mfma_f32_16x16x32_bf16 v[48:51], v[154:157], v[136:139], v[48:51]
    v_mfma_f32_16x16x32_bf16 v[68:71], v[154:157], v[140:143], v[68:71]
    v_mfma_f32_16x16x32_bf16 v[12:15], v[158:161], v[128:131], v[12:15]
    v_mfma_f32_16x16x32_bf16 v[32:35], v[158:161], v[132:135], v[32:35]
    v_mfma_f32_16x16x32_bf16 v[52:55], v[158:161], v[136:139], v[52:55]
    v_mfma_f32_16x16x32_bf16 v[72:75], v[158:161], v[140:143], v[72:75]
    v_mfma_f32_16x16x32_bf16 v[16:19], v[162:165], v[128:131], v[16:19]
    v_mfma_f32_16x16x32_bf16 v[36:39], v[162:165], v[132:135], v[36:39]
    v_mfma_f32_16x16x32_bf16 v[56:59], v[162:165], v[136:139], v[56:59]
    v_mfma_f32_16x16x32_bf16 v[76:79], v[162:165], v[140:143], v[76:79]
KF_SKIP10:
    s_waitcnt vmcnt(9)
    v_mfma_f32_16x16x32_bf16 v[0:3], v[166:169], v[80:83], v[0:3]
    v_mfma_f32_16x16x32_bf16 v[20:23], v[166:169], v[84:87], v[20:23]
    v_mfma_f32_16x16x32_bf16 v[40:43], v[166:169], v[88:91], v[40:43]
    v_mfma_f32_16x16x32_bf16 v[60:63], v[166:169], v[92:95], v[60:63]
    v_mfma_f32_16x16x32_bf16 v[4:7], v[170:173], v[80:83], v[4:7]
    v_mfma_f32_16x16x32_bf16 v[24:27], v[170:173], v[84:87], v[24:27]
    v_mfma_f32_16x16x32_bf16 v[44:47], v[170:173], v[88:91], v[44:47]
    v_mfma_f32_16x16x32_bf16 v[64:67], v[170:173], v[92:95], v[64:67]
    v_mfma_f32_16x16x32_bf16 v[8:11], v[174:177], v[80:83], v[8:11]
    v_mfma_f32_16x16x32_bf16 v[28:31], v[174:177], v[84:87], v[28:31]
    v_mfma_f32_16x16x32_bf16 v[48:51], v[174:177], v[88:91], v[48:51]
    v_mfma_f32_16x16x32_bf16 v[68:71], v[174:177], v[92:95], v[68:71]
    v_mfma_f32_16x16x32_bf16 v[12:15], v[178:181], v[80:83], v[12:15]
    v_mfma_f32_16x16x32_bf16 v[32:35], v[178:181], v[84:87], v[32:35]
    v_mfma_f32_16x16x32_bf16 v[52:55], v[178:181], v[88:91], v[52:55]
    v_mfma_f32_16x16x32_bf16 v[72:75], v[178:181], v[92:95], v[72:75]
    v_mfma_f32_16x16x32_bf16 v[16:19], v[182:185], v[80:83], v[16:19]
    v_mfma_f32_16x16x32_bf16 v[36:39], v[182:185], v[84:87], v[36:39]
    v_mfma_f32_16x16x32_bf16 v[56:59], v[182:185], v[88:91], v[56:59]
    v_mfma_f32_16x16x32_bf16 v[76:79], v[182:185], v[92:95], v[76:79]
    s_waitcnt vmcnt(0)
    v_mfma_f32_16x16x32_bf16 v[20:23], v[186:189], v[100:103], v[20:23]
    v_mfma_f32_16x16x32_bf16 v[24:27], v[190:193], v[100:103], v[24:27]
    v_mfma_f32_16x16x32_bf16 v[28:31], v[194:197], v[100:103], v[28:31]
    v_mfma_f32_16x16x32_bf16 v[32:35], v[198:201], v[100:103], v[32:35]
    v_mfma_f32_16x16x32_bf16 v[36:39], v[202:205], v[100:103], v[36:39]
    v_mfma_f32_16x16x32_bf16 v[40:43], v[186:189], v[104:107], v[40:43]
    s_nop 2
    ds_write_b128 v249, v[20:23] offset:0
    v_mfma_f32_16x16x32_bf16 v[44:47], v[190:193], v[104:107], v[44:47]
    ds_write_b128 v249, v[24:27] offset:1024
    v_mfma_f32_16x16x32_bf16 v[48:51], v[194:197], v[104:107], v[48:51]
    ds_write_b128 v249, v[28:31] offset:2048
    v_mfma_f32_16x16x32_bf16 v[52:55], v[198:201], v[104:107], v[52:55]
    ds_write_b128 v249, v[32:35] offset:3072
    v_mfma_f32_16x16x32_bf16 v[56:59], v[202:205], v[104:107], v[56:59]
    ds_write_b128 v249, v[36:39] offset:4096
    v_mfma_f32_16x16x32_bf16 v[60:63], v[186:189], v[108:111], v[60:63]
    ds_write_b128 v249, v[40:43] offset:5120
    v_mfma_f32_16x16x32_bf16 v[64:67], v[190:193], v[108:111], v[64:67]
    ds_write_b128 v249, v[44:47] offset:6144
    v_mfma_f32_16x16x32_bf16 v[68:71], v[194:197], v[108:111], v[68:71]
    ds_write_b128 v249, v[48:51] offset:7168
    v_mfma_f32_16x16x32_bf16 v[72:75], v[198:201], v[108:111], v[72:75]
    ds_write_b128 v249, v[52:55] offset:8192
    v_mfma_f32_16x16x32_bf16 v[76:79], v[202:205], v[108:111], v[76:79]
    ds_write_b128 v249, v[56:59] offset:9216
    v_mfma_f32_16x16x32_bf16 v[0:3], v[186:189], v[96:99], v[0:3]
    ds_write_b128 v249, v[60:63] offset:10240
    v_mfma_f32_16x16x32_bf16 v[4:7], v[190:193], v[96:99], v[4:7]
    ds_write_b128 v249, v[64:67] offset:11264
    v_mfma_f32_16x16x32_bf16 v[8:11], v[194:197], v[96:99], v[8:11]
    ds_write_b128 v249, v[68:71] offset:12288
    v_mfma_f32_16x16x32_bf16 v[12:15], v[198:201], v[96:99], v[12:15]
    ds_write_b128 v249, v[72:75] offset:13312
    v_mfma_f32_16x16x32_bf16 v[16:19], v[202:205], v[96:99], v[16:19]
    ds_write_b128 v249, v[76:79] offset:14336
    v_mov_b32 v246, 163600
    s_mov_b64 exec, 1
    ds_add_u32 v246, v253
    s_mov_b64 exec, -1
    s_setprio 0
KF_DS:
    ds_read_b32 v247, v246
    s_waitcnt lgkmcnt(0)
    v_readfirstlane_b32 s3, v247
    s_add_u32 s77, s77, 1
    s_cmp_gt_u32 s77, 6400000
    s_cbranch_scc1 KF_DS_X
    s_nop 0
    s_cmp_ge_u32 s3, 4
    s_cbranch_scc1 KF_DS_X
    s_sleep 0
    s_branch KF_DS
KF_DS_X:
    ds_read_b128 v[80:83], v240 offset:0
    ds_read_b128 v[84:87], v241 offset:0
    ds_read_b128 v[88:91], v242 offset:0
    ds_read_b128 v[92:95], v240 offset:1024
    ds_read_b128 v[96:99], v241 offset:1024
    ds_read_b128 v[100:103], v242 offset:1024
    ds_read_b128 v[104:107], v240 offset:2048
    ds_read_b128 v[108:111], v241 offset:2048
    ds_read_b128 v[112:115], v242 offset:2048
    ds_read_b128 v[116:119], v240 offset:3072
    ds_read_b128 v[120:123], v241 offset:3072
    ds_read_b128 v[124:127], v242 offset:3072
    ds_read_b128 v[128:131], v240 offset:4096
    ds_read_b128 v[132:135], v241 offset:4096
    ds_read_b128 v[136:139], v242 offset:4096
    s_waitcnt lgkmcnt(12)
    v_add_f32 v0, v0, v80
    v_add_f32 v1, v1, v81
    v_add_f32 v2, v2, v82
    v_add_f32 v3, v3, v83
    v_add_f32 v0, v0, v84
    v_add_f32 v1, v1, v85
    v_add_f32 v2, v2, v86
    v_add_f32 v3, v3, v87
    v_add_f32 v0, v0, v88
    v_add_f32 v1, v1, v89
    v_add_f32 v2, v2, v90
    v_add_f32 v3, v3, v91
    s_waitcnt lgkmcnt(9)
    v_add_f32 v4, v4, v92
    v_add_f32 v5, v5, v93
    v_add_f32 v6, v6, v94
    v_add_f32 v7, v7, v95
    v_add_f32 v4, v4, v96
    v_add_f32 v5, v5, v97
    v_add_f32 v6, v6, v98
    v_add_f32 v7, v7, v99
    v_add_f32 v4, v4, v100
    v_add_f32 v5, v5, v101
    v_add_f32 v6, v6, v102
    v_add_f32 v7, v7, v103
    s_waitcnt lgkmcnt(6)
    v_add_f32 v8, v8, v104
    v_add_f32 v9, v9, v105
    v_add_f32 v10, v10, v106
    v_add_f32 v11, v11, v107
    v_add_f32 v8, v8, v108
    v_add_f32 v9, v9, v109
    v_add_f32 v10, v10, v110
    v_add_f32 v11, v11, v111
    v_add_f32 v8, v8, v112
    v_add_f32 v9, v9, v113
    v_add_f32 v10, v10, v114
    v_add_f32 v11, v11, v115
    s_waitcnt lgkmcnt(3)
    v_add_f32 v12, v12, v116
    v_add_f32 v13, v13, v117
    v_add_f32 v14, v14, v118
    v_add_f32 v15, v15, v119
    v_add_f32 v12, v12, v120
    v_add_f32 v13, v13, v121
    v_add_f32 v14, v14, v122
    v_add_f32 v15, v15, v123
    v_add_f32 v12, v12, v124
    v_add_f32 v13, v13, v125
    v_add_f32 v14, v14, v126
    v_add_f32 v15, v15, v127
    s_waitcnt lgkmcnt(0)
    v_add_f32 v16, v16, v128
    v_add_f32 v17, v17, v129
    v_add_f32 v18, v18, v130
    v_add_f32 v19, v19, v131
    v_add_f32 v16, v16, v132
    v_add_f32 v17, v17, v133
    v_add_f32 v18, v18, v134
    v_add_f32 v19, v19, v135
    v_add_f32 v16, v16, v136
    v_add_f32 v17, v17, v137
    v_add_f32 v18, v18, v138
    v_add_f32 v19, v19, v139
    v_mul_f32 v40, 0xbfb8aa3b, v0
    v_mul_f32 v41, 0xbfb8aa3b, v1
    v_mul_f32 v42, 0xbfb8aa3b, v2
    v_mul_f32 v43, 0xbfb8aa3b, v3
    v_exp_f32 v40, v40
    v_exp_f32 v41, v41
    v_exp_f32 v42, v42
    v_exp_f32 v43, v43
    v_add_f32 v40, 1.0, v40
    v_add_f32 v41, 1.0, v41
    v_add_f32 v42, 1.0, v42
    v_add_f32 v43, 1.0, v43
    v_rcp_f32 v40, v40
    v_rcp_f32 v41, v41
    v_rcp_f32 v42, v42
    v_rcp_f32 v43, v43
    v_mul_f32 v0, v0, v40
    v_mul_f32 v1, v1, v41
    v_mul_f32 v2, v2, v42
    v_mul_f32 v3, v3, v43
    ds_write_b128 v249, v[0:3] offset:15360
    v_mul_f32 v40, 0xbfb8aa3b, v4
    v_mul_f32 v41, 0xbfb8aa3b, v5
    v_mul_f32 v42, 0xbfb8aa3b, v6
    v_mul_f32 v43, 0xbfb8aa3b, v7
    v_exp_f32 v40, v40
    v_exp_f32 v41, v41
    v_exp_f32 v42, v42
    v_exp_f32 v43, v43
    v_add_f32 v40, 1.0, v40
    v_add_f32 v41, 1.0, v41
    v_add_f32 v42, 1.0, v42
    v_add_f32 v43, 1.0, v43
    v_rcp_f32 v40, v40
    v_rcp_f32 v41, v41
    v_rcp_f32 v42, v42
    v_rcp_f32 v43, v43
    v_mul_f32 v4, v4, v40
    v_mul_f32 v5, v5, v41
    v_mul_f32 v6, v6, v42
    v_mul_f32 v7, v7, v43
    ds_write_b128 v249, v[4:7] offset:16384
    v_mul_f32 v40, 0xbfb8aa3b, v8
    v_mul_f32 v41, 0xbfb8aa3b, v9
    v_mul_f32 v42, 0xbfb8aa3b, v10
    v_mul_f32 v43, 0xbfb8aa3b, v11
    v_exp_f32 v40, v40
    v_exp_f32 v41, v41
    v_exp_f32 v42, v42
    v_exp_f32 v43, v43
    v_add_f32 v40, 1.0, v40
    v_add_f32 v41, 1.0, v41
    v_add_f32 v42, 1.0, v42
    v_add_f32 v43, 1.0, v43
    v_rcp_f32 v40, v40
    v_rcp_f32 v41, v41
    v_rcp_f32 v42, v42
    v_rcp_f32 v43, v43
    v_mul_f32 v8, v8, v40
    v_mul_f32 v9, v9, v41
    v_mul_f32 v10, v10, v42
    v_mul_f32 v11, v11, v43
    ds_write_b128 v249, v[8:11] offset:17408
    v_mul_f32 v40, 0xbfb8aa3b, v12
    v_mul_f32 v41, 0xbfb8aa3b, v13
    v_mul_f32 v42, 0xbfb8aa3b, v14
    v_mul_f32 v43, 0xbfb8aa3b, v15
    v_exp_f32 v40, v40
    v_exp_f32 v41, v41
    v_exp_f32 v42, v42
    v_exp_f32 v43, v43
    v_add_f32 v40, 1.0, v40
    v_add_f32 v41, 1.0, v41
    v_add_f32 v42, 1.0, v42
    v_add_f32 v43, 1.0, v43
    v_rcp_f32 v40, v40
    v_rcp_f32 v41, v41
    v_rcp_f32 v42, v42
    v_rcp_f32 v43, v43
    v_mul_f32 v12, v12, v40
    v_mul_f32 v13, v13, v41
    v_mul_f32 v14, v14, v42
    v_mul_f32 v15, v15, v43
    ds_write_b128 v249, v[12:15] offset:18432
    v_mul_f32 v40, 0xbfb8aa3b, v16
    v_mul_f32 v41, 0xbfb8aa3b, v17
    v_mul_f32 v42, 0xbfb8aa3b, v18
    v_mul_f32 v43, 0xbfb8aa3b, v19
    v_exp_f32 v40, v40
    v_exp_f32 v41, v41
    v_exp_f32 v42, v42
    v_exp_f32 v43, v43
    v_add_f32 v40, 1.0, v40
    v_add_f32 v41, 1.0, v41
    v_add_f32 v42, 1.0, v42
    v_add_f32 v43, 1.0, v43
    v_rcp_f32 v40, v40
    v_rcp_f32 v41, v41
    v_rcp_f32 v42, v42
    v_rcp_f32 v43, v43
    v_mul_f32 v16, v16, v40
    v_mul_f32 v17, v17, v41
    v_mul_f32 v18, v18, v42
    v_mul_f32 v19, v19, v43
    ds_write_b128 v249, v[16:19] offset:19456
    v_mov_b32 v246, 163608
    s_mov_b64 exec, 1
    ds_add_u32 v246, v253
    s_mov_b64 exec, -1
    s_branch KF_FIN
KF_SW:
    s_setprio 3
    s_cmp_eq_u32 s1, 0
    s_cbranch_scc1 KF_NOITEM
    s_cmp_eq_u32 s53, 1
    s_cbranch_scc1 KF_Q3
KF_WQ:
    v_cmp_ne_u32 vcc, s65, v230
    s_add_u32 s77, s77, 1
    s_cmp_gt_u32 s77, 100000
    s_cbranch_scc1 KF_WQX
    s_nop 2
    s_cbranch_vccz KF_WQX
    s_sleep 3
    buffer_load_dword v230, v231, s[16:19], s44 offen sc1
    s_waitcnt vmcnt(0)
    s_branch KF_WQ
KF_WQX:
    buffer_load_dwordx4 v[0:3], v251, s[16:19], s74 offen sc1
    buffer_load_dwordx2 v[4:5], v244, s[16:19], s46 offen offset:0 sc1
    s_add_u32 s74, s74, 4096
    buffer_load_dwordx4 v[6:9], v251, s[16:19], s74 offen sc1
    buffer_load_dwordx2 v[10:11], v244, s[16:19], s46 offen offset:1024 sc1
    s_add_u32 s74, s74, 4096
    s_cmp_le_u32 s1, 2
    s_cbranch_scc1 KF_Q3
    buffer_load_dwordx4 v[12:15], v251, s[16:19], s74 offen sc1
    buffer_load_dwordx2 v[16:17], v244, s[16:19], s46 offen offset:2048 sc1
    s_add_u32 s74, s74, 4096
    s_cmp_le_u32 s1, 3
    s_cbranch_scc1 KF_Q3
    buffer_load_dwordx4 v[18:21], v251, s[16:19], s74 offen sc1
    buffer_load_dwordx2 v[22:23], v244, s[16:19], s46 offen offset:3072 sc1
    s_add_u32 s74, s74, 4096
KF_Q3:
    s_mul_i32 s74, s30, 30720
    s_add_u32 s74, s74, 17825792
    s_lshl_b32 s3, s45, 9
    s_add_u32 s74, s74, s3
    v_and_b32 v226, 15, v250
    v_lshrrev_b32 v227, 4, v250
    v_mul_u32_u24 v243, 1920, v227
    v_lshl_add_u32 v243, v226, 4, v243
    s_lshl_b32 s3, s45, 5
    s_add_u32 s3, s3, 0
    v_add_u32 v228, s3, v226
    v_and_b32 v229, 1, v227
    v_mul_u32_u24 v230, 171, v228
    v_lshrrev_b32 v230, 12, v230
    v_mul_u32_u24 v231, 24, v230
    v_sub_u32 v231, v228, v231
    v_and_b32 v238, 2, v230
    v_add_u32 v238, v238, v229
    v_and_b32 v230, 1, v230
    v_lshl_add_u32 v230, v238, 1, v230
    v_subrev_u32 v238, 96, v228
    v_lshl_add_u32 v238, v238, 1, v229
    v_cmp_lt_i32 vcc, 23, v238
    s_nop 1
    v_cndmask_b32 v239, 8, 9, vcc
    v_cndmask_b32 v229, 0, 24, vcc
    v_sub_u32 v238, v238, v229
    v_cmp_lt_u32 vcc, 95, v228
    s_nop 1
    v_cndmask_b32 v230, v230, v239, vcc
    v_cndmask_b32 v231, v231, v238, vcc
    v_mul_u32_u24 v231, 80, v231
    v_cmp_lt_u32 vcc, 4, v230
    s_nop 1
    v_cndmask_b32 v238, 0, 1, vcc
    v_mul_u32_u24 v229, 5, v238
    v_sub_u32 v230, v230, v229
    v_lshrrev_b32 v229, 1, v230
    v_lshlrev_b32 v229, 5, v229
    v_and_b32 v239, 1, v230
    v_lshl_add_u32 v229, v239, 3, v229
    v_cmp_eq_u32 vcc, 4, v230
    s_nop 1
    v_cndmask_b32 v239, 4, 3, vcc
    v_lshlrev_b32 v238, v239, v238
    v_add3_u32 v245, v231, v238, v229
    v_lshl_add_u32 v228, v241, 7, v228
    v_mov_b32 v229, 2000
    v_cmp_gt_u32 vcc, 120, v228
    s_nop 1
    v_cndmask_b32 v245, v229, v245, vcc
    v_add_u32 v245, 158720, v245
    s_lshl_b32 s3, s45, 5
    s_add_u32 s3, s3, 16
    v_add_u32 v228, s3, v226
    v_and_b32 v229, 1, v227
    v_mul_u32_u24 v230, 171, v228
    v_lshrrev_b32 v230, 12, v230
    v_mul_u32_u24 v231, 24, v230
    v_sub_u32 v231, v228, v231
    v_and_b32 v238, 2, v230
    v_add_u32 v238, v238, v229
    v_and_b32 v230, 1, v230
    v_lshl_add_u32 v230, v238, 1, v230
    v_subrev_u32 v238, 96, v228
    v_lshl_add_u32 v238, v238, 1, v229
    v_cmp_lt_i32 vcc, 23, v238
    s_nop 1
    v_cndmask_b32 v239, 8, 9, vcc
    v_cndmask_b32 v229, 0, 24, vcc
    v_sub_u32 v238, v238, v229
    v_cmp_lt_u32 vcc, 95, v228
    s_nop 1
    v_cndmask_b32 v230, v230, v239, vcc
    v_cndmask_b32 v231, v231, v238, vcc
    v_mul_u32_u24 v231, 80, v231
    v_cmp_lt_u32 vcc, 4, v230
    s_nop 1
    v_cndmask_b32 v238, 0, 1, vcc
    v_mul_u32_u24 v229, 5, v238
    v_sub_u32 v230, v230, v229
    v_lshrrev_b32 v229, 1, v230
    v_lshlrev_b32 v229, 5, v229
    v_and_b32 v239, 1, v230
    v_lshl_add_u32 v229, v239, 3, v229
    v_cmp_eq_u32 vcc, 4, v230
    s_nop 1
    v_cndmask_b32 v239, 4, 3, vcc
    v_lshlrev_b32 v238, v239, v238
    v_add3_u32 v242, v231, v238, v229
    v_lshl_add_u32 v228, v241, 7, v228
    v_mov_b32 v229, 2000
    v_cmp_gt_u32 vcc, 120, v228
    s_nop 1
    v_cndmask_b32 v242, v229, v242, vcc
    v_add_u32 v242, 158720, v242
    v_bfe_u32 v226, v240, 2, 1
    v_and_b32 v227, 3, v240
    v_lshrrev_b32 v228, 3, v240
    v_lshl_add_u32 v227, v228, 2, v227
    v_lshl_add_u32 v229, v226, 3, v227
    v_add_u32 v230, 8, v227
    v_cmp_lt_u32 vcc, 7, v227
    s_nop 1
    v_cndmask_b32 v229, v229, v230, vcc
    v_min_u32 v229, 20, v229
    v_mul_u32_u24 v229, 80, v229
    v_add_u32 v229, 158720, v229
    v_lshl_add_u32 v238, v241, 4, v229
    v_lshl_add_u32 v239, v241, 3, v229
    v_and_b32 v226, 15, v240
    v_lshrrev_b32 v227, 4, v240
    v_lshlrev_b32 v227, 10, v227
    v_lshl_add_u32 v228, v226, 4, v227
    v_lshl_add_u32 v236, v241, 8, v228
    v_lshl_add_u32 v228, v226, 3, v227
    s_bfe_u32 s3, s30, 0x20001
    s_sub_u32 s4, 4, s3
    s_lshl_b32 s4, s4, 12
    s_lshl_b32 s5, s3, 7
    s_add_u32 s4, s4, s5
    v_add_u32 v228, s4, v228
    v_cmp_gt_u32 vcc, 32, v250
    s_nop 1
    v_cndmask_b32 v237, v255, v228, vcc
    s_lshr_b32 s4, s30, 3
    s_mul_i32 s4, s4, 5
    s_add_u32 s4, s4, s3
    s_add_u32 s4, s4, 54
    s_lshl_b32 s4, s4, 12
    s_and_b32 s5, s30, 1
    s_lshl_b32 s5, s5, 9
    s_add_u32 s4, s4, s5
    s_lshr_b32 s5, s51, 1
    s_mul_i32 s5, s5, 303104
    s_add_u32 s4, s4, s5
    s_and_b32 s5, s51, 1
    s_lshl_b32 s5, s5, 11
    s_add_u32 s46, s4, s5
    s_lshr_b32 s3, s30, 3
    s_add_u32 s3, s3, 9
    s_lshl_b32 s3, s3, 11
    s_add_u32 s44, s3, 20021248
    s_waitcnt vmcnt(0)
    v_lshl_or_b32 v24, v41, 16, v40
    v_lshl_or_b32 v25, v43, 16, v42
    v_lshl_or_b32 v26, v45, 16, v44
    v_lshl_or_b32 v27, v47, 16, v46
    v_lshl_or_b32 v28, v49, 16, v48
    v_lshl_or_b32 v29, v51, 16, v50
    s_cmp_lg_u32 s24, 2
    s_cbranch_scc1 KF_NQW2
    buffer_load_dwordx4 v[206:209], v251, s[16:19], s75 offen offset:0 sc1
    buffer_load_dwordx4 v[210:213], v251, s[16:19], s75 offen offset:1024 sc1
    buffer_load_dwordx4 v[214:217], v251, s[16:19], s75 offen offset:2048 sc1
    buffer_load_dwordx4 v[218:221], v251, s[16:19], s75 offen offset:3072 sc1
    buffer_load_dwordx4 v[222:225], v252, s[16:19], s75 offen sc1
    s_add_u32 s75, s75, 40960
    buffer_load_dwordx4 v[146:149], v251, s[16:19], s75 offen offset:0 sc1
    buffer_load_dwordx4 v[150:153], v251, s[16:19], s75 offen offset:1024 sc1
    buffer_load_dwordx4 v[154:157], v251, s[16:19], s75 offen offset:2048 sc1
    buffer_load_dwordx4 v[158:161], v251, s[16:19], s75 offen offset:3072 sc1
    buffer_load_dwordx4 v[162:165], v252, s[16:19], s75 offen sc1
    s_add_u32 s75, s75, 40960
KF_NQW2:
    v_and_b32 v231, 15, v250
    v_lshlrev_b32 v231, 7, v231
    v_mfma_f32_32x32x16_bf16 v[80:95], v[24:27], v[0:3], 0
    v_mfma_f32_32x32x8_bf16 v[80:95], v[28:29], v[4:5], v[80:95]
    v_mfma_f32_32x32x16_bf16 v[96:111], v[24:27], v[6:9], 0
    v_mfma_f32_32x32x8_bf16 v[96:111], v[28:29], v[10:11], v[96:111]
    v_mfma_f32_32x32x16_bf16 v[112:127], v[24:27], v[12:15], 0
    v_mfma_f32_32x32x8_bf16 v[112:127], v[28:29], v[16:17], v[112:127]
    v_mfma_f32_32x32x16_bf16 v[128:143], v[24:27], v[18:21], 0
    v_mfma_f32_32x32x8_bf16 v[128:143], v[28:29], v[22:23], v[128:143]
    s_nop 5
    v_max3_f32 v226, v80, v81, v82
    v_min3_f32 v227, v80, v81, v82
    v_max3_f32 v226, v226, v83, v84
    v_min3_f32 v227, v227, v83, v84
    v_max3_f32 v226, v226, v85, v86
    v_min3_f32 v227, v227, v85, v86
    v_max3_f32 v226, v226, v87, v88
    v_min3_f32 v227, v227, v87, v88
    v_max_f32 v226, v226, v89
    v_min_f32 v227, v227, v89
    v_mov_b32 v228, v226
    v_mov_b32 v229, v227
    s_nop 0
    v_permlane32_swap_b32 v226, v228
    v_permlane32_swap_b32 v227, v229
    v_max_f32 v226, v226, v228
    v_min_f32 v227, v227, v229
    v_mul_f32 v226, 0xbfb8aa3b, v226
    v_mul_f32 v228, 0x3fb8aa3b, v227
    v_fmamk_f32 v30, v80, 0xbfb8aa3b, v228
    v_fmamk_f32 v80, v80, 0x3fb8aa3b, v226
    v_fmamk_f32 v31, v81, 0xbfb8aa3b, v228
    v_fmamk_f32 v81, v81, 0x3fb8aa3b, v226
    v_fmamk_f32 v32, v82, 0xbfb8aa3b, v228
    v_fmamk_f32 v82, v82, 0x3fb8aa3b, v226
    v_fmamk_f32 v33, v83, 0xbfb8aa3b, v228
    v_fmamk_f32 v83, v83, 0x3fb8aa3b, v226
    v_fmamk_f32 v34, v84, 0xbfb8aa3b, v228
    v_fmamk_f32 v84, v84, 0x3fb8aa3b, v226
    v_fmamk_f32 v35, v85, 0xbfb8aa3b, v228
    v_fmamk_f32 v85, v85, 0x3fb8aa3b, v226
    v_fmamk_f32 v36, v86, 0xbfb8aa3b, v228
    v_fmamk_f32 v86, v86, 0x3fb8aa3b, v226
    v_fmamk_f32 v37, v87, 0xbfb8aa3b, v228
    v_fmamk_f32 v87, v87, 0x3fb8aa3b, v226
    v_fmamk_f32 v38, v88, 0xbfb8aa3b, v228
    v_fmamk_f32 v88, v88, 0x3fb8aa3b, v226
    v_fmamk_f32 v39, v89, 0xbfb8aa3b, v228
    v_fmamk_f32 v89, v89, 0x3fb8aa3b, v226
    v_exp_f32 v30, v30
    v_exp_f32 v80, v80
    v_exp_f32 v31, v31
    v_exp_f32 v81, v81
    v_exp_f32 v32, v32
    v_exp_f32 v82, v82
    v_exp_f32 v33, v33
    v_exp_f32 v83, v83
    v_exp_f32 v34, v34
    v_exp_f32 v84, v84
    v_exp_f32 v35, v35
    v_exp_f32 v85, v85
    v_exp_f32 v36, v36
    v_exp_f32 v86, v86
    v_exp_f32 v37, v37
    v_exp_f32 v87, v87
    v_exp_f32 v38, v38
    v_exp_f32 v88, v88
    v_exp_f32 v39, v39
    v_exp_f32 v89, v89
    v_add_f32 v227, v30, v31
    v_add_f32 v226, v80, v81
    v_add_f32 v227, v227, v32
    v_add_f32 v226, v226, v82
    v_add_f32 v227, v227, v33
    v_add_f32 v226, v226, v83
    v_add_f32 v227, v227, v34
    v_add_f32 v226, v226, v84
    v_add_f32 v227, v227, v35
    v_add_f32 v226, v226, v85
    v_add_f32 v227, v227, v36
    v_add_f32 v226, v226, v86
    v_add_f32 v227, v227, v37
    v_add_f32 v226, v226, v87
    v_add_f32 v227, v227, v38
    v_add_f32 v226, v226, v88
    v_add_f32 v227, v227, v39
    v_add_f32 v226, v226, v89
    v_mov_b32 v228, v226
    v_mov_b32 v229, v227
    s_nop 0
    v_permlane32_swap_b32 v226, v228
    v_permlane32_swap_b32 v227, v229
    v_add_f32 v226, v226, v228
    v_add_f32 v227, v227, v229
    v_rcp_f32 v226, v226
    v_rcp_f32 v228, v227
    v_mul_f32 v80, v226, v80
    v_mul_f32 v30, v228, v30
    v_mul_f32 v81, v226, v81
    v_mul_f32 v31, v228, v31
    v_mul_f32 v82, v226, v82
    v_mul_f32 v32, v228, v32
    v_mul_f32 v83, v226, v83
    v_mul_f32 v33, v228, v33
    v_mul_f32 v84, v226, v84
    v_mul_f32 v34, v228, v34
    v_mul_f32 v85, v226, v85
    v_mul_f32 v35, v228, v35
    v_mul_f32 v86, v226, v86
    v_mul_f32 v36, v228, v36
    v_mul_f32 v87, v226, v87
    v_mul_f32 v37, v228, v37
    v_mul_f32 v88, v226, v88
    v_mul_f32 v38, v228, v38
    v_mul_f32 v89, v226, v89
    v_mul_f32 v39, v228, v39
    v_cvt_pk_bf16_f32 v40, v80, v81
    v_cvt_pk_bf16_f32 v45, v30, v31
    v_cvt_pk_bf16_f32 v41, v82, v83
    v_cvt_pk_bf16_f32 v46, v32, v33
    v_cvt_pk_bf16_f32 v42, v84, v85
    v_cvt_pk_bf16_f32 v47, v34, v35
    v_cvt_pk_bf16_f32 v43, v86, v87
    v_cvt_pk_bf16_f32 v48, v36, v37
    v_cvt_pk_bf16_f32 v44, v88, v89
    v_cvt_pk_bf16_f32 v49, v38, v39
    v_max3_f32 v226, v96, v97, v98
    v_min3_f32 v227, v96, v97, v98
    v_max3_f32 v226, v226, v99, v100
    v_min3_f32 v227, v227, v99, v100
    v_max3_f32 v226, v226, v101, v102
    v_min3_f32 v227, v227, v101, v102
    v_max3_f32 v226, v226, v103, v104
    v_min3_f32 v227, v227, v103, v104
    v_max_f32 v226, v226, v105
    v_min_f32 v227, v227, v105
    v_mov_b32 v228, v226
    v_mov_b32 v229, v227
    s_nop 0
    v_permlane32_swap_b32 v226, v228
    v_permlane32_swap_b32 v227, v229
    v_max_f32 v226, v226, v228
    v_min_f32 v227, v227, v229
    v_mul_f32 v226, 0xbfb8aa3b, v226
    v_mul_f32 v228, 0x3fb8aa3b, v227
    v_fmamk_f32 v30, v96, 0xbfb8aa3b, v228
    v_fmamk_f32 v96, v96, 0x3fb8aa3b, v226
    v_fmamk_f32 v31, v97, 0xbfb8aa3b, v228
    v_fmamk_f32 v97, v97, 0x3fb8aa3b, v226
    v_fmamk_f32 v32, v98, 0xbfb8aa3b, v228
    v_fmamk_f32 v98, v98, 0x3fb8aa3b, v226
    v_fmamk_f32 v33, v99, 0xbfb8aa3b, v228
    v_fmamk_f32 v99, v99, 0x3fb8aa3b, v226
    v_fmamk_f32 v34, v100, 0xbfb8aa3b, v228
    v_fmamk_f32 v100, v100, 0x3fb8aa3b, v226
    v_fmamk_f32 v35, v101, 0xbfb8aa3b, v228
    v_fmamk_f32 v101, v101, 0x3fb8aa3b, v226
    v_fmamk_f32 v36, v102, 0xbfb8aa3b, v228
    v_fmamk_f32 v102, v102, 0x3fb8aa3b, v226
    v_fmamk_f32 v37, v103, 0xbfb8aa3b, v228
    v_fmamk_f32 v103, v103, 0x3fb8aa3b, v226
    v_fmamk_f32 v38, v104, 0xbfb8aa3b, v228
    v_fmamk_f32 v104, v104, 0x3fb8aa3b, v226
    v_fmamk_f32 v39, v105, 0xbfb8aa3b, v228
    v_fmamk_f32 v105, v105, 0x3fb8aa3b, v226
    v_exp_f32 v30, v30
    v_exp_f32 v96, v96
    v_exp_f32 v31, v31
    v_exp_f32 v97, v97
    v_exp_f32 v32, v32
    v_exp_f32 v98, v98
    v_exp_f32 v33, v33
    v_exp_f32 v99, v99
    v_exp_f32 v34, v34
    v_exp_f32 v100, v100
    v_exp_f32 v35, v35
    v_exp_f32 v101, v101
    v_exp_f32 v36, v36
    v_exp_f32 v102, v102
    v_exp_f32 v37, v37
    v_exp_f32 v103, v103
    v_exp_f32 v38, v38
    v_exp_f32 v104, v104
    v_exp_f32 v39, v39
    v_exp_f32 v105, v105
    v_add_f32 v227, v30, v31
    v_add_f32 v226, v96, v97
    v_add_f32 v227, v227, v32
    v_add_f32 v226, v226, v98
    v_add_f32 v227, v227, v33
    v_add_f32 v226, v226, v99
    v_add_f32 v227, v227, v34
    v_add_f32 v226, v226, v100
    v_add_f32 v227, v227, v35
    v_add_f32 v226, v226, v101
    v_add_f32 v227, v227, v36
    v_add_f32 v226, v226, v102
    v_add_f32 v227, v227, v37
    v_add_f32 v226, v226, v103
    v_add_f32 v227, v227, v38
    v_add_f32 v226, v226, v104
    v_add_f32 v227, v227, v39
    v_add_f32 v226, v226, v105
    v_mov_b32 v228, v226
    v_mov_b32 v229, v227
    s_nop 0
    v_permlane32_swap_b32 v226, v228
    v_permlane32_swap_b32 v227, v229
    v_add_f32 v226, v226, v228
    v_add_f32 v227, v227, v229
    v_rcp_f32 v226, v226
    v_rcp_f32 v228, v227
    v_mul_f32 v96, v226, v96
    v_mul_f32 v30, v228, v30
    v_mul_f32 v97, v226, v97
    v_mul_f32 v31, v228, v31
    v_mul_f32 v98, v226, v98
    v_mul_f32 v32, v228, v32
    v_mul_f32 v99, v226, v99
    v_mul_f32 v33, v228, v33
    v_mul_f32 v100, v226, v100
    v_mul_f32 v34, v228, v34
    v_mul_f32 v101, v226, v101
    v_mul_f32 v35, v228, v35
    v_mul_f32 v102, v226, v102
    v_mul_f32 v36, v228, v36
    v_mul_f32 v103, v226, v103
    v_mul_f32 v37, v228, v37
    v_mul_f32 v104, v226, v104
    v_mul_f32 v38, v228, v38
    v_mul_f32 v105, v226, v105
    v_mul_f32 v39, v228, v39
    v_cvt_pk_bf16_f32 v50, v96, v97
    v_cvt_pk_bf16_f32 v55, v30, v31
    v_cvt_pk_bf16_f32 v51, v98, v99
    v_cvt_pk_bf16_f32 v56, v32, v33
    v_cvt_pk_bf16_f32 v52, v100, v101
    v_cvt_pk_bf16_f32 v57, v34, v35
    v_cvt_pk_bf16_f32 v53, v102, v103
    v_cvt_pk_bf16_f32 v58, v36, v37
    v_cvt_pk_bf16_f32 v54, v104, v105
    v_cvt_pk_bf16_f32 v59, v38, v39
    s_cmp_le_u32 s1, 2
    s_cbranch_scc1 KF_SM3
    v_max3_f32 v226, v112, v113, v114
    v_min3_f32 v227, v112, v113, v114
    v_max3_f32 v226, v226, v115, v116
    v_min3_f32 v227, v227, v115, v116
    v_max3_f32 v226, v226, v117, v118
    v_min3_f32 v227, v227, v117, v118
    v_max3_f32 v226, v226, v119, v120
    v_min3_f32 v227, v227, v119, v120
    v_max_f32 v226, v226, v121
    v_min_f32 v227, v227, v121
    v_mov_b32 v228, v226
    v_mov_b32 v229, v227
    s_nop 0
    v_permlane32_swap_b32 v226, v228
    v_permlane32_swap_b32 v227, v229
    v_max_f32 v226, v226, v228
    v_min_f32 v227, v227, v229
    v_mul_f32 v226, 0xbfb8aa3b, v226
    v_mul_f32 v228, 0x3fb8aa3b, v227
    v_fmamk_f32 v30, v112, 0xbfb8aa3b, v228
    v_fmamk_f32 v112, v112, 0x3fb8aa3b, v226
    v_fmamk_f32 v31, v113, 0xbfb8aa3b, v228
    v_fmamk_f32 v113, v113, 0x3fb8aa3b, v226
    v_fmamk_f32 v32, v114, 0xbfb8aa3b, v228
    v_fmamk_f32 v114, v114, 0x3fb8aa3b, v226
    v_fmamk_f32 v33, v115, 0xbfb8aa3b, v228
    v_fmamk_f32 v115, v115, 0x3fb8aa3b, v226
    v_fmamk_f32 v34, v116, 0xbfb8aa3b, v228
    v_fmamk_f32 v116, v116, 0x3fb8aa3b, v226
    v_fmamk_f32 v35, v117, 0xbfb8aa3b, v228
    v_fmamk_f32 v117, v117, 0x3fb8aa3b, v226
    v_fmamk_f32 v36, v118, 0xbfb8aa3b, v228
    v_fmamk_f32 v118, v118, 0x3fb8aa3b, v226
    v_fmamk_f32 v37, v119, 0xbfb8aa3b, v228
    v_fmamk_f32 v119, v119, 0x3fb8aa3b, v226
    v_fmamk_f32 v38, v120, 0xbfb8aa3b, v228
    v_fmamk_f32 v120, v120, 0x3fb8aa3b, v226
    v_fmamk_f32 v39, v121, 0xbfb8aa3b, v228
    v_fmamk_f32 v121, v121, 0x3fb8aa3b, v226
    v_exp_f32 v30, v30
    v_exp_f32 v112, v112
    v_exp_f32 v31, v31
    v_exp_f32 v113, v113
    v_exp_f32 v32, v32
    v_exp_f32 v114, v114
    v_exp_f32 v33, v33
    v_exp_f32 v115, v115
    v_exp_f32 v34, v34
    v_exp_f32 v116, v116
    v_exp_f32 v35, v35
    v_exp_f32 v117, v117
    v_exp_f32 v36, v36
    v_exp_f32 v118, v118
    v_exp_f32 v37, v37
    v_exp_f32 v119, v119
    v_exp_f32 v38, v38
    v_exp_f32 v120, v120
    v_exp_f32 v39, v39
    v_exp_f32 v121, v121
    v_add_f32 v227, v30, v31
    v_add_f32 v226, v112, v113
    v_add_f32 v227, v227, v32
    v_add_f32 v226, v226, v114
    v_add_f32 v227, v227, v33
    v_add_f32 v226, v226, v115
    v_add_f32 v227, v227, v34
    v_add_f32 v226, v226, v116
    v_add_f32 v227, v227, v35
    v_add_f32 v226, v226, v117
    v_add_f32 v227, v227, v36
    v_add_f32 v226, v226, v118
    v_add_f32 v227, v227, v37
    v_add_f32 v226, v226, v119
    v_add_f32 v227, v227, v38
    v_add_f32 v226, v226, v120
    v_add_f32 v227, v227, v39
    v_add_f32 v226, v226, v121
    v_mov_b32 v228, v226
    v_mov_b32 v229, v227
    s_nop 0
    v_permlane32_swap_b32 v226, v228
    v_permlane32_swap_b32 v227, v229
    v_add_f32 v226, v226, v228
    v_add_f32 v227, v227, v229
    v_rcp_f32 v226, v226
    v_rcp_f32 v228, v227
    v_mul_f32 v112, v226, v112
    v_mul_f32 v30, v228, v30
    v_mul_f32 v113, v226, v113
    v_mul_f32 v31, v228, v31
    v_mul_f32 v114, v226, v114
    v_mul_f32 v32, v228, v32
    v_mul_f32 v115, v226, v115
    v_mul_f32 v33, v228, v33
    v_mul_f32 v116, v226, v116
    v_mul_f32 v34, v228, v34
    v_mul_f32 v117, v226, v117
    v_mul_f32 v35, v228, v35
    v_mul_f32 v118, v226, v118
    v_mul_f32 v36, v228, v36
    v_mul_f32 v119, v226, v119
    v_mul_f32 v37, v228, v37
    v_mul_f32 v120, v226, v120
    v_mul_f32 v38, v228, v38
    v_mul_f32 v121, v226, v121
    v_mul_f32 v39, v228, v39
    v_cvt_pk_bf16_f32 v60, v112, v113
    v_cvt_pk_bf16_f32 v65, v30, v31
    v_cvt_pk_bf16_f32 v61, v114, v115
    v_cvt_pk_bf16_f32 v66, v32, v33
    v_cvt_pk_bf16_f32 v62, v116, v117
    v_cvt_pk_bf16_f32 v67, v34, v35
    v_cvt_pk_bf16_f32 v63, v118, v119
    v_cvt_pk_bf16_f32 v68, v36, v37
    v_cvt_pk_bf16_f32 v64, v120, v121
    v_cvt_pk_bf16_f32 v69, v38, v39
    s_cmp_le_u32 s1, 3
    s_cbranch_scc1 KF_SM3
    v_max3_f32 v226, v128, v129, v130
    v_min3_f32 v227, v128, v129, v130
    v_max3_f32 v226, v226, v131, v132
    v_min3_f32 v227, v227, v131, v132
    v_max3_f32 v226, v226, v133, v134
    v_min3_f32 v227, v227, v133, v134
    v_max3_f32 v226, v226, v135, v136
    v_min3_f32 v227, v227, v135, v136
    v_max_f32 v226, v226, v137
    v_min_f32 v227, v227, v137
    v_mov_b32 v228, v226
    v_mov_b32 v229, v227
    s_nop 0
    v_permlane32_swap_b32 v226, v228
    v_permlane32_swap_b32 v227, v229
    v_max_f32 v226, v226, v228
    v_min_f32 v227, v227, v229
    v_mul_f32 v226, 0xbfb8aa3b, v226
    v_mul_f32 v228, 0x3fb8aa3b, v227
    v_fmamk_f32 v30, v128, 0xbfb8aa3b, v228
    v_fmamk_f32 v128, v128, 0x3fb8aa3b, v226
    v_fmamk_f32 v31, v129, 0xbfb8aa3b, v228
    v_fmamk_f32 v129, v129, 0x3fb8aa3b, v226
    v_fmamk_f32 v32, v130, 0xbfb8aa3b, v228
    v_fmamk_f32 v130, v130, 0x3fb8aa3b, v226
    v_fmamk_f32 v33, v131, 0xbfb8aa3b, v228
    v_fmamk_f32 v131, v131, 0x3fb8aa3b, v226
    v_fmamk_f32 v34, v132, 0xbfb8aa3b, v228
    v_fmamk_f32 v132, v132, 0x3fb8aa3b, v226
    v_fmamk_f32 v35, v133, 0xbfb8aa3b, v228
    v_fmamk_f32 v133, v133, 0x3fb8aa3b, v226
    v_fmamk_f32 v36, v134, 0xbfb8aa3b, v228
    v_fmamk_f32 v134, v134, 0x3fb8aa3b, v226
    v_fmamk_f32 v37, v135, 0xbfb8aa3b, v228
    v_fmamk_f32 v135, v135, 0x3fb8aa3b, v226
    v_fmamk_f32 v38, v136, 0xbfb8aa3b, v228
    v_fmamk_f32 v136, v136, 0x3fb8aa3b, v226
    v_fmamk_f32 v39, v137, 0xbfb8aa3b, v228
    v_fmamk_f32 v137, v137, 0x3fb8aa3b, v226
    v_exp_f32 v30, v30
    v_exp_f32 v128, v128
    v_exp_f32 v31, v31
    v_exp_f32 v129, v129
    v_exp_f32 v32, v32
    v_exp_f32 v130, v130
    v_exp_f32 v33, v33
    v_exp_f32 v131, v131
    v_exp_f32 v34, v34
    v_exp_f32 v132, v132
    v_exp_f32 v35, v35
    v_exp_f32 v133, v133
    v_exp_f32 v36, v36
    v_exp_f32 v134, v134
    v_exp_f32 v37, v37
    v_exp_f32 v135, v135
    v_exp_f32 v38, v38
    v_exp_f32 v136, v136
    v_exp_f32 v39, v39
    v_exp_f32 v137, v137
    v_add_f32 v227, v30, v31
    v_add_f32 v226, v128, v129
    v_add_f32 v227, v227, v32
    v_add_f32 v226, v226, v130
    v_add_f32 v227, v227, v33
    v_add_f32 v226, v226, v131
    v_add_f32 v227, v227, v34
    v_add_f32 v226, v226, v132
    v_add_f32 v227, v227, v35
    v_add_f32 v226, v226, v133
    v_add_f32 v227, v227, v36
    v_add_f32 v226, v226, v134
    v_add_f32 v227, v227, v37
    v_add_f32 v226, v226, v135
    v_add_f32 v227, v227, v38
    v_add_f32 v226, v226, v136
    v_add_f32 v227, v227, v39
    v_add_f32 v226, v226, v137
    v_mov_b32 v228, v226
    v_mov_b32 v229, v227
    s_nop 0
    v_permlane32_swap_b32 v226, v228
    v_permlane32_swap_b32 v227, v229
    v_add_f32 v226, v226, v228
    v_add_f32 v227, v227, v229
    v_rcp_f32 v226, v226
    v_rcp_f32 v228, v227
    v_mul_f32 v128, v226, v128
    v_mul_f32 v30, v228, v30
    v_mul_f32 v129, v226, v129
    v_mul_f32 v31, v228, v31
    v_mul_f32 v130, v226, v130
    v_mul_f32 v32, v228, v32
    v_mul_f32 v131, v226, v131
    v_mul_f32 v33, v228, v33
    v_mul_f32 v132, v226, v132
    v_mul_f32 v34, v228, v34
    v_mul_f32 v133, v226, v133
    v_mul_f32 v35, v228, v35
    v_mul_f32 v134, v226, v134
    v_mul_f32 v36, v228, v36
    v_mul_f32 v135, v226, v135
    v_mul_f32 v37, v228, v37
    v_mul_f32 v136, v226, v136
    v_mul_f32 v38, v228, v38
    v_mul_f32 v137, v226, v137
    v_mul_f32 v39, v228, v39
    v_cvt_pk_bf16_f32 v70, v128, v129
    v_cvt_pk_bf16_f32 v75, v30, v31
    v_cvt_pk_bf16_f32 v71, v130, v131
    v_cvt_pk_bf16_f32 v76, v32, v33
    v_cvt_pk_bf16_f32 v72, v132, v133
    v_cvt_pk_bf16_f32 v77, v34, v35
    v_cvt_pk_bf16_f32 v73, v134, v135
    v_cvt_pk_bf16_f32 v78, v36, v37
    v_cvt_pk_bf16_f32 v74, v136, v137
    v_cvt_pk_bf16_f32 v79, v38, v39
KF_SM3:
    v_and_b32 v12, 1, v250
    v_lshlrev_b32 v12, 4, v12
    v_mov_b32 v13, 0x3f80
    v_lshlrev_b32 v12, v12, v13
    v_bfe_u32 v13, v250, 1, 3
    v_cmp_eq_u32 vcc, 0, v13
    s_nop 1
    v_cndmask_b32 v8, 0, v12, vcc
    v_cmp_eq_u32 vcc, 1, v13
    s_nop 1
    v_cndmask_b32 v9, 0, v12, vcc
    v_cmp_eq_u32 vcc, 2, v13
    s_nop 1
    v_cndmask_b32 v10, 0, v12, vcc
    v_cmp_eq_u32 vcc, 3, v13
    s_nop 1
    v_cndmask_b32 v11, 0, v12, vcc
    v_mov_b32 v246, 163588
    s_cmp_lg_u32 s40, 4
    s_cbranch_scc1 KF_WKV_F
    s_mov_b64 exec, 0xffff
KF_WKV_L:
    buffer_load_dword v247, v248, s[16:19], s44 offen sc1
    s_waitcnt vmcnt(0)
    v_cmp_ne_u32 vcc, s65, v247
    s_add_u32 s77, s77, 1
    s_cmp_gt_u32 s77, 100000
    s_cbranch_scc1 KF_WKV_X
    s_nop 2
    s_cbranch_vccz KF_WKV_X
    s_mov_b64 exec, vcc
    s_sleep 2
    s_branch KF_WKV_L
KF_WKV_X:
    s_mov_b64 exec, -1
    v_mov_b32 v247, 2
    ds_write_b32 v246, v247
    s_branch KF_WKV_D
KF_WKV_F:
KF_WKV_S:
    ds_read_b32 v247, v246
    s_waitcnt lgkmcnt(0)
    v_readfirstlane_b32 s3, v247
    s_add_u32 s77, s77, 1
    s_cmp_gt_u32 s77, 6400000
    s_cbranch_scc1 KF_WKV_S_X
    s_nop 0
    s_cmp_ge_u32 s3, 2
    s_cbranch_scc1 KF_WKV_S_X
    s_sleep 1
    s_branch KF_WKV_S
KF_WKV_S_X:
KF_WKV_D:
    buffer_load_dwordx4 v[80:83], v243, s[16:19], s74 offen sc1
    buffer_load_dwordx4 v[84:87], v243, s[16:19], s74 offen offset:256 sc1
    s_add_u32 s74, s74, 7680
    buffer_load_dwordx4 v[88:91], v243, s[16:19], s74 offen sc1
    buffer_load_dwordx4 v[92:95], v243, s[16:19], s74 offen offset:256 sc1
    s_add_u32 s74, s74, 7680
    buffer_load_dwordx4 v[96:99], v243, s[16:19], s74 offen sc1
    buffer_load_dwordx4 v[100:103], v243, s[16:19], s74 offen offset:256 sc1
    s_add_u32 s74, s74, 7680
    buffer_load_dwordx4 v[104:107], v243, s[16:19], s74 offen sc1
    buffer_load_dwordx4 v[108:111], v243, s[16:19], s74 offen offset:256 sc1
    s_add_u32 s74, s74, 7680
    s_waitcnt vmcnt(7)
    v_mfma_f32_16x16x32_bf16 v[0:3], v[8:11], v[80:83], 0
    s_waitcnt vmcnt(6)
    v_mfma_f32_16x16x32_bf16 v[4:7], v[8:11], v[84:87], 0
    s_waitcnt vmcnt(5)
    v_mfma_f32_16x16x32_bf16 v[0:3], v[8:11], v[88:91], v[0:3]
    s_waitcnt vmcnt(4)
    v_mfma_f32_16x16x32_bf16 v[4:7], v[8:11], v[92:95], v[4:7]
    s_waitcnt vmcnt(3)
    v_mfma_f32_16x16x32_bf16 v[0:3], v[8:11], v[96:99], v[0:3]
    s_waitcnt vmcnt(2)
    v_mfma_f32_16x16x32_bf16 v[4:7], v[8:11], v[100:103], v[4:7]
    s_waitcnt vmcnt(1)
    v_mfma_f32_16x16x32_bf16 v[0:3], v[8:11], v[104:107], v[0:3]
    s_waitcnt vmcnt(0)
    v_mfma_f32_16x16x32_bf16 v[4:7], v[8:11], v[108:111], v[4:7]
    s_nop 5
    v_cvt_pk_bf16_f32 v0, v0, v1
    v_cvt_pk_bf16_f32 v1, v2, v3
    ds_write_b64 v245, v[0:1]
    v_cvt_pk_bf16_f32 v4, v4, v5
    v_cvt_pk_bf16_f32 v5, v6, v7
    ds_write_b64 v242, v[4:5]
    v_mov_b32 v246, 163592
    s_mov_b64 exec, 1
    ds_add_u32 v246, v253
    s_mov_b64 exec, -1
KF_IS:
    ds_read_b32 v247, v246
    s_waitcnt lgkmcnt(0)
    v_readfirstlane_b32 s3, v247
    s_add_u32 s77, s77, 1
    s_cmp_gt_u32 s77, 6400000
    s_cbranch_scc1 KF_IS_X
    s_nop 0
    s_cmp_ge_u32 s3, 4
    s_cbranch_scc1 KF_IS_X
    s_sleep 0
    s_branch KF_IS
KF_IS_X:
    ds_read_b128 v[0:3], v238
    ds_read_b128 v[4:7], v238 offset:32
    ds_read_b64 v[8:9], v239 offset:64
    s_waitcnt lgkmcnt(0)
    v_mfma_f32_32x32x16_bf16 v[80:95], v[0:3], v[40:43], 0
    v_mfma_f32_32x32x16_bf16 v[80:95], v[4:7], v[44:47], v[80:95]
    v_mfma_f32_32x32x8_bf16 v[80:95], v[8:9], v[48:49], v[80:95]
    v_mfma_f32_32x32x16_bf16 v[96:111], v[0:3], v[50:53], 0
    v_mfma_f32_32x32x16_bf16 v[96:111], v[4:7], v[54:57], v[96:111]
    v_mfma_f32_32x32x8_bf16 v[96:111], v[8:9], v[58:59], v[96:111]
    s_nop 8
    v_add_f32 v92, 0x358637bd, v92
    v_rcp_f32 v92, v92
    s_nop 0
    v_mul_f32 v80, v92, v80
    v_mul_f32 v81, v92, v81
    v_mul_f32 v82, v92, v82
    v_mul_f32 v83, v92, v83
    v_mul_f32 v84, v92, v84
    v_mul_f32 v85, v92, v85
    v_mul_f32 v86, v92, v86
    v_mul_f32 v87, v92, v87
    v_mul_f32 v88, v92, v88
    v_mul_f32 v89, v92, v89
    v_mul_f32 v90, v92, v90
    v_mul_f32 v91, v92, v91
    v_cvt_pk_bf16_f32 v10, v80, v81
    v_cvt_pk_bf16_f32 v11, v82, v83
    v_cvt_pk_bf16_f32 v12, v84, v85
    v_cvt_pk_bf16_f32 v13, v86, v87
    v_cvt_pk_bf16_f32 v14, v88, v89
    v_cvt_pk_bf16_f32 v15, v90, v91
    buffer_store_dwordx4 v[10:13], v236, s[16:19], s46 offen sc1
    buffer_store_dwordx2 v[14:15], v237, s[16:19], s46 offen sc1
    s_add_u32 s46, s46, 606208
    s_cmp_gt_u32 s1, 2
    s_cbranch_scc1 KF_O3
    v_add_f32 v108, 0x358637bd, v108
    v_rcp_f32 v108, v108
    s_nop 0
    v_mul_f32 v96, v108, v96
    v_mul_f32 v97, v108, v97
    v_mul_f32 v98, v108, v98
    v_mul_f32 v99, v108, v99
    v_mul_f32 v100, v108, v100
    v_mul_f32 v101, v108, v101
    v_mul_f32 v102, v108, v102
    v_mul_f32 v103, v108, v103
    v_mul_f32 v104, v108, v104
    v_mul_f32 v105, v108, v105
    v_mul_f32 v106, v108, v106
    v_mul_f32 v107, v108, v107
    v_cvt_pk_bf16_f32 v16, v96, v97
    v_cvt_pk_bf16_f32 v17, v98, v99
    v_cvt_pk_bf16_f32 v18, v100, v101
    v_cvt_pk_bf16_f32 v19, v102, v103
    v_cvt_pk_bf16_f32 v20, v104, v105
    v_cvt_pk_bf16_f32 v21, v106, v107
    buffer_store_dwordx4 v[16:19], v236, s[16:19], s46 offen sc1
    buffer_store_dwordx2 v[20:21], v237, s[16:19], s46 offen sc1
    s_add_u32 s46, s46, 606208
    s_branch KF_O4
KF_O3:
    v_mfma_f32_32x32x16_bf16 v[112:127], v[0:3], v[60:63], 0
    v_mfma_f32_32x32x16_bf16 v[112:127], v[4:7], v[64:67], v[112:127]
    v_mfma_f32_32x32x8_bf16 v[112:127], v[8:9], v[68:69], v[112:127]
    v_add_f32 v108, 0x358637bd, v108
    v_rcp_f32 v108, v108
    s_nop 0
    v_mul_f32 v96, v108, v96
    v_mul_f32 v97, v108, v97
    v_mul_f32 v98, v108, v98
    v_mul_f32 v99, v108, v99
    v_mul_f32 v100, v108, v100
    v_mul_f32 v101, v108, v101
    v_mul_f32 v102, v108, v102
    v_mul_f32 v103, v108, v103
    v_mul_f32 v104, v108, v104
    v_mul_f32 v105, v108, v105
    v_mul_f32 v106, v108, v106
    v_mul_f32 v107, v108, v107
    v_cvt_pk_bf16_f32 v16, v96, v97
    v_cvt_pk_bf16_f32 v17, v98, v99
    v_cvt_pk_bf16_f32 v18, v100, v101
    v_cvt_pk_bf16_f32 v19, v102, v103
    v_cvt_pk_bf16_f32 v20, v104, v105
    v_cvt_pk_bf16_f32 v21, v106, v107
    buffer_store_dwordx4 v[16:19], v236, s[16:19], s46 offen sc1
    buffer_store_dwordx2 v[20:21], v237, s[16:19], s46 offen sc1
    s_add_u32 s46, s46, 606208
    s_cmp_gt_u32 s1, 3
    s_cbranch_scc1 KF_O5
    v_add_f32 v124, 0x358637bd, v124
    v_rcp_f32 v124, v124
    s_nop 0
    v_mul_f32 v112, v124, v112
    v_mul_f32 v113, v124, v113
    v_mul_f32 v114, v124, v114
    v_mul_f32 v115, v124, v115
    v_mul_f32 v116, v124, v116
    v_mul_f32 v117, v124, v117
    v_mul_f32 v118, v124, v118
    v_mul_f32 v119, v124, v119
    v_mul_f32 v120, v124, v120
    v_mul_f32 v121, v124, v121
    v_mul_f32 v122, v124, v122
    v_mul_f32 v123, v124, v123
    v_cvt_pk_bf16_f32 v22, v112, v113
    v_cvt_pk_bf16_f32 v23, v114, v115
    v_cvt_pk_bf16_f32 v24, v116, v117
    v_cvt_pk_bf16_f32 v25, v118, v119
    v_cvt_pk_bf16_f32 v26, v120, v121
    v_cvt_pk_bf16_f32 v27, v122, v123
    buffer_store_dwordx4 v[22:25], v236, s[16:19], s46 offen sc1
    buffer_store_dwordx2 v[26:27], v237, s[16:19], s46 offen sc1
    s_add_u32 s46, s46, 606208
    s_branch KF_O4
KF_O5:
    v_mfma_f32_32x32x16_bf16 v[128:143], v[0:3], v[70:73], 0
    v_mfma_f32_32x32x16_bf16 v[128:143], v[4:7], v[74:77], v[128:143]
    v_mfma_f32_32x32x8_bf16 v[128:143], v[8:9], v[78:79], v[128:143]
    v_add_f32 v124, 0x358637bd, v124
    v_rcp_f32 v124, v124
    s_nop 0
    v_mul_f32 v112, v124, v112
    v_mul_f32 v113, v124, v113
    v_mul_f32 v114, v124, v114
    v_mul_f32 v115, v124, v115
    v_mul_f32 v116, v124, v116
    v_mul_f32 v117, v124, v117
    v_mul_f32 v118, v124, v118
    v_mul_f32 v119, v124, v119
    v_mul_f32 v120, v124, v120
    v_mul_f32 v121, v124, v121
    v_mul_f32 v122, v124, v122
    v_mul_f32 v123, v124, v123
    v_cvt_pk_bf16_f32 v22, v112, v113
    v_cvt_pk_bf16_f32 v23, v114, v115
    v_cvt_pk_bf16_f32 v24, v116, v117
    v_cvt_pk_bf16_f32 v25, v118, v119
    v_cvt_pk_bf16_f32 v26, v120, v121
    v_cvt_pk_bf16_f32 v27, v122, v123
    buffer_store_dwordx4 v[22:25], v236, s[16:19], s46 offen sc1
    buffer_store_dwordx2 v[26:27], v237, s[16:19], s46 offen sc1
    s_add_u32 s46, s46, 606208
    v_add_f32 v140, 0x358637bd, v140
    v_rcp_f32 v140, v140
    s_nop 0
    v_mul_f32 v128, v140, v128
    v_mul_f32 v129, v140, v129
    v_mul_f32 v130, v140, v130
    v_mul_f32 v131, v140, v131
    v_mul_f32 v132, v140, v132
    v_mul_f32 v133, v140, v133
    v_mul_f32 v134, v140, v134
    v_mul_f32 v135, v140, v135
    v_mul_f32 v136, v140, v136
    v_mul_f32 v137, v140, v137
    v_mul_f32 v138, v140, v138
    v_mul_f32 v139, v140, v139
    v_cvt_pk_bf16_f32 v28, v128, v129
    v_cvt_pk_bf16_f32 v29, v130, v131
    v_cvt_pk_bf16_f32 v30, v132, v133
    v_cvt_pk_bf16_f32 v31, v134, v135
    v_cvt_pk_bf16_f32 v32, v136, v137
    v_cvt_pk_bf16_f32 v33, v138, v139
    buffer_store_dwordx4 v[28:31], v236, s[16:19], s46 offen sc1
    buffer_store_dwordx2 v[32:33], v237, s[16:19], s46 offen sc1
    s_add_u32 s46, s46, 606208
KF_O4:
    s_lshl_b32 s5, s31, 5
    s_add_u32 s5, s5, s30
    s_add_u32 s5, s5, 256
    s_lshl_b32 s5, s5, 7
    s_add_u32 s5, s5, 20021248
    s_waitcnt vmcnt(0)
    v_mov_b32 v246, 163596
    s_mov_b64 exec, 1
    ds_add_rtn_u32 v247, v246, v253
    s_mov_b64 exec, -1
    s_waitcnt lgkmcnt(0)
    v_readfirstlane_b32 s3, v247
    s_nop 3
    s_cmp_lg_u32 s3, 3
    s_cbranch_scc1 KF_WAITO
    v_lshlrev_b32 v246, 2, v250
    v_mov_b32 v247, s65
    s_mov_b32 exec_hi, 0
    buffer_store_dword v247, v246, s[16:19], s5 offen sc1
    s_mov_b32 exec_hi, -1
    s_branch KF_WAITO
KF_NOITEM:
    s_cmp_lg_u32 s24, 2
    s_cbranch_scc1 KF_NQW3
    buffer_load_dwordx4 v[206:209], v251, s[16:19], s75 offen offset:0 sc1
    s_waitcnt vmcnt(12)
    buffer_load_dwordx4 v[210:213], v251, s[16:19], s75 offen offset:1024 sc1
    s_waitcnt vmcnt(12)
    buffer_load_dwordx4 v[214:217], v251, s[16:19], s75 offen offset:2048 sc1
    s_waitcnt vmcnt(12)
    buffer_load_dwordx4 v[218:221], v251, s[16:19], s75 offen offset:3072 sc1
    s_waitcnt vmcnt(12)
    buffer_load_dwordx4 v[222:225], v252, s[16:19], s75 offen sc1
    s_add_u32 s75, s75, 40960
    s_waitcnt vmcnt(12)
    buffer_load_dwordx4 v[146:149], v251, s[16:19], s75 offen offset:0 sc1
    s_waitcnt vmcnt(12)
    buffer_load_dwordx4 v[150:153], v251, s[16:19], s75 offen offset:1024 sc1
    s_waitcnt vmcnt(12)
    buffer_load_dwordx4 v[154:157], v251, s[16:19], s75 offen offset:2048 sc1
    s_waitcnt vmcnt(12)
    buffer_load_dwordx4 v[158:161], v251, s[16:19], s75 offen offset:3072 sc1
    s_waitcnt vmcnt(12)
    buffer_load_dwordx4 v[162:165], v252, s[16:19], s75 offen sc1
    s_add_u32 s75, s75, 40960
    s_waitcnt vmcnt(12)
KF_NQW3:
KF_WAITO:
    s_setprio 0
    s_mov_b32 s32, s68
    s_mov_b32 s33, s69
    s_mov_b32 s34, 2621440
    s_mov_b32 s35, 0x00020000
    v_and_b32 v244, 15, v250
    v_mul_u32_u24 v244, 1280, v244
    v_lshrrev_b32 v243, 4, v250
    v_lshl_add_u32 v244, v243, 3, v244
    s_lshl_b32 s3, s28, 2
    s_add_u32 s3, s3, s40
    s_sub_u32 s3, s3, 4
    s_mul_i32 s3, s3, 20480
    s_mul_i32 s4, s29, 160
    s_add_u32 s45, s3, s4
    s_and_b32 s3, s0, 0xff
    s_add_u32 s3, s3, 8
    s_lshl_b32 s3, s3, 12
    s_add_u32 s44, s3, 20021248
    s_mov_b32 s6, -1
    s_mov_b32 s7, 0
    v_lshlrev_b32 v243, 3, v250
    v_sub_u32 v236, v232, v243
    v_sub_u32 v237, v233, v243
    v_sub_u32 v238, v234, v243
    v_sub_u32 v239, v235, v243
    s_sub_u32 s3, s40, 1
    s_and_b32 s3, s3, 3
    s_mul_i32 s3, s3, 20480
    s_add_u32 s3, s3, 81920
    v_add_u32 v240, s3, v251
    s_sub_u32 s3, s40, 2
    s_and_b32 s3, s3, 3
    s_mul_i32 s3, s3, 20480
    s_add_u32 s3, s3, 87040
    v_add_u32 v241, s3, v251
    s_sub_u32 s3, s40, 3
    s_and_b32 s3, s3, 3
    s_mul_i32 s3, s3, 20480
    s_add_u32 s3, s3, 92160
    v_add_u32 v242, s3, v251
    v_subrev_u32 v245, 66560, v249
    v_mov_b32 v246, 163620
KF_PG:
    ds_read_b32 v247, v246
    s_waitcnt lgkmcnt(0)
    v_readfirstlane_b32 s3, v247
    s_add_u32 s77, s77, 1
    s_cmp_gt_u32 s77, 6400000
    s_cbranch_scc1 KF_PG_X
    s_nop 0
    s_cmp_ge_u32 s3, 4
    s_cbranch_scc1 KF_PG_X
    s_sleep 1
    s_branch KF_PG
KF_PG_X:
    s_setprio 3
    s_add_u32 m0, s48, 0
    s_nop 0
    buffer_load_dwordx4 v251, s[16:19], s75 offen offset:0 sc1 lds
    s_add_u32 m0, s48, 0
    s_nop 0
    buffer_load_dwordx4 v251, s[16:19], s75 offen offset:1024 sc1 lds
    s_add_u32 m0, s48, 0
    s_nop 0
    buffer_load_dwordx4 v251, s[16:19], s75 offen offset:2048 sc1 lds
    s_add_u32 m0, s48, 0
    s_nop 0
    buffer_load_dwordx4 v251, s[16:19], s75 offen offset:3072 sc1 lds
    s_add_u32 m0, s48, 4096
    s_nop 0
    buffer_load_dwordx4 v252, s[16:19], s75 offen sc1 lds
    s_add_u32 s75, s75, 40960
    v_mov_b32 v246, 163588
    s_cmp_lg_u32 s40, 4
    s_cbranch_scc1 KF_WO_F
    s_mov_b64 exec, s[6:7]
KF_WO_L:
    buffer_load_dword v247, v248, s[16:19], s44 offen sc1
    s_waitcnt vmcnt(0)
    v_cmp_ne_u32 vcc, s65, v247
    s_add_u32 s77, s77, 1
    s_cmp_gt_u32 s77, 100000
    s_cbranch_scc1 KF_WO_X
    s_nop 2
    s_cbranch_vccz KF_WO_X
    s_mov_b64 exec, vcc
    s_sleep 2
    s_branch KF_WO_L
KF_WO_X:
    s_mov_b64 exec, -1
    v_mov_b32 v247, 3
    ds_write_b32 v246, v247
    s_branch KF_WO_D
KF_WO_F:
KF_WO_S:
    ds_read_b32 v247, v246
    s_waitcnt lgkmcnt(0)
    v_readfirstlane_b32 s3, v247
    s_add_u32 s77, s77, 1
    s_cmp_gt_u32 s77, 6400000
    s_cbranch_scc1 KF_WO_S_X
    s_nop 0
    s_cmp_ge_u32 s3, 3
    s_cbranch_scc1 KF_WO_S_X
    s_sleep 1
    s_branch KF_WO_S
KF_WO_S_X:
KF_WO_D:
    v_mov_b32 v246, 163620
KF_DG:
    ds_read_b32 v247, v246
    s_waitcnt lgkmcnt(0)
    v_readfirstlane_b32 s3, v247
    s_add_u32 s77, s77, 1
    s_cmp_gt_u32 s77, 6400000
    s_cbranch_scc1 KF_DG_X
    s_nop 0
    s_cmp_ge_u32 s3, 8
    s_cbranch_scc1 KF_DG_X
    s_sleep 1
    s_branch KF_DG
KF_DG_X:
    buffer_load_dwordx4 v[80:83], v232, s[36:39], s41 offen sc1
    buffer_load_dwordx4 v[84:87], v233, s[36:39], s41 offen sc1
    buffer_load_dwordx4 v[88:91], v234, s[36:39], s41 offen sc1
    buffer_load_dwordx4 v[92:95], v235, s[36:39], s41 offen sc1
    s_add_u32 s41, s41, 4096
    buffer_load_dwordx4 v[96:99], v232, s[36:39], s41 offen sc1
    buffer_load_dwordx4 v[100:103], v233, s[36:39], s41 offen sc1
    buffer_load_dwordx4 v[104:107], v234, s[36:39], s41 offen sc1
    buffer_load_dwordx4 v[108:111], v235, s[36:39], s41 offen sc1
    s_add_u32 s41, s41, 4096
    buffer_load_dwordx4 v[112:115], v232, s[36:39], s41 offen sc1
    buffer_load_dwordx4 v[116:119], v233, s[36:39], s41 offen sc1
    buffer_load_dwordx4 v[120:123], v234, s[36:39], s41 offen sc1
    buffer_load_dwordx4 v[124:127], v235, s[36:39], s41 offen sc1
    s_add_u32 s41, s41, 4096
    buffer_load_dwordx4 v[128:131], v232, s[36:39], s41 offen sc1
    buffer_load_dwordx4 v[132:135], v233, s[36:39], s41 offen sc1
    buffer_load_dwordx4 v[136:139], v234, s[36:39], s41 offen sc1
    buffer_load_dwordx4 v[140:143], v235, s[36:39], s41 offen sc1
    s_add_u32 s41, s41, 4096
    s_setprio 1
    s_waitcnt vmcnt(15)
    v_mfma_f32_16x16x32_bf16 v[0:3], v[166:169], v[80:83], 0
    v_mfma_f32_16x16x32_bf16 v[4:7], v[170:173], v[80:83], 0
    v_mfma_f32_16x16x32_bf16 v[8:11], v[174:177], v[80:83], 0
    v_mfma_f32_16x16x32_bf16 v[12:15], v[178:181], v[80:83], 0
    v_mfma_f32_16x16x32_bf16 v[16:19], v[182:185], v[80:83], 0
    s_waitcnt vmcnt(14)
    v_mfma_f32_16x16x32_bf16 v[20:23], v[166:169], v[84:87], 0
    v_mfma_f32_16x16x32_bf16 v[24:27], v[170:173], v[84:87], 0
    v_mfma_f32_16x16x32_bf16 v[28:31], v[174:177], v[84:87], 0
    v_mfma_f32_16x16x32_bf16 v[32:35], v[178:181], v[84:87], 0
    v_mfma_f32_16x16x32_bf16 v[36:39], v[182:185], v[84:87], 0
    s_waitcnt vmcnt(13)
    v_mfma_f32_16x16x32_bf16 v[40:43], v[166:169], v[88:91], 0
    v_mfma_f32_16x16x32_bf16 v[44:47], v[170:173], v[88:91], 0
    v_mfma_f32_16x16x32_bf16 v[48:51], v[174:177], v[88:91], 0
    v_mfma_f32_16x16x32_bf16 v[52:55], v[178:181], v[88:91], 0
    v_mfma_f32_16x16x32_bf16 v[56:59], v[182:185], v[88:91], 0
    s_waitcnt vmcnt(12)
    v_mfma_f32_16x16x32_bf16 v[60:63], v[166:169], v[92:95], 0
    v_mfma_f32_16x16x32_bf16 v[64:67], v[170:173], v[92:95], 0
    v_mfma_f32_16x16x32_bf16 v[68:71], v[174:177], v[92:95], 0
    v_mfma_f32_16x16x32_bf16 v[72:75], v[178:181], v[92:95], 0
    v_mfma_f32_16x16x32_bf16 v[76:79], v[182:185], v[92:95], 0
    buffer_load_dwordx2 v[80:81], v236, s[36:39], s41 offen offset:0 sc1
    buffer_load_dwordx2 v[82:83], v236, s[36:39], s41 offen offset:512 sc1
    buffer_load_dwordx2 v[84:85], v237, s[36:39], s41 offen offset:0 sc1
    buffer_load_dwordx2 v[86:87], v237, s[36:39], s41 offen offset:512 sc1
    buffer_load_dwordx2 v[88:89], v238, s[36:39], s41 offen offset:0 sc1
    buffer_load_dwordx2 v[90:91], v238, s[36:39], s41 offen offset:512 sc1
    buffer_load_dwordx2 v[92:93], v239, s[36:39], s41 offen offset:0 sc1
    buffer_load_dwordx2 v[94:95], v239, s[36:39], s41 offen offset:512 sc1
    s_waitcnt vmcnt(19)
    v_mfma_f32_16x16x32_bf16 v[0:3], v[186:189], v[96:99], v[0:3]
    v_mfma_f32_16x16x32_bf16 v[4:7], v[190:193], v[96:99], v[4:7]
    ds_read_b128 v[166:169], v249 offset:0
    v_mfma_f32_16x16x32_bf16 v[8:11], v[194:197], v[96:99], v[8:11]
    v_mfma_f32_16x16x32_bf16 v[12:15], v[198:201], v[96:99], v[12:15]
    ds_read_b128 v[170:173], v249 offset:1024
    v_mfma_f32_16x16x32_bf16 v[16:19], v[202:205], v[96:99], v[16:19]
    s_waitcnt vmcnt(18)
    v_mfma_f32_16x16x32_bf16 v[20:23], v[186:189], v[100:103], v[20:23]
    ds_read_b128 v[174:177], v249 offset:2048
    v_mfma_f32_16x16x32_bf16 v[24:27], v[190:193], v[100:103], v[24:27]
    v_mfma_f32_16x16x32_bf16 v[28:31], v[194:197], v[100:103], v[28:31]
    ds_read_b128 v[178:181], v249 offset:3072
    v_mfma_f32_16x16x32_bf16 v[32:35], v[198:201], v[100:103], v[32:35]
    v_mfma_f32_16x16x32_bf16 v[36:39], v[202:205], v[100:103], v[36:39]
    ds_read_b128 v[182:185], v249 offset:4096
    s_waitcnt vmcnt(17)
    v_mfma_f32_16x16x32_bf16 v[40:43], v[186:189], v[104:107], v[40:43]
    v_mfma_f32_16x16x32_bf16 v[44:47], v[190:193], v[104:107], v[44:47]
    v_mfma_f32_16x16x32_bf16 v[48:51], v[194:197], v[104:107], v[48:51]
    v_mfma_f32_16x16x32_bf16 v[52:55], v[198:201], v[104:107], v[52:55]
    v_mfma_f32_16x16x32_bf16 v[56:59], v[202:205], v[104:107], v[56:59]
    s_waitcnt vmcnt(16)
    v_mfma_f32_16x16x32_bf16 v[60:63], v[186:189], v[108:111], v[60:63]
    v_mfma_f32_16x16x32_bf16 v[64:67], v[190:193], v[108:111], v[64:67]
    v_mfma_f32_16x16x32_bf16 v[68:71], v[194:197], v[108:111], v[68:71]
    v_mfma_f32_16x16x32_bf16 v[72:75], v[198:201], v[108:111], v[72:75]
    v_mfma_f32_16x16x32_bf16 v[76:79], v[202:205], v[108:111], v[76:79]
    buffer_load_dwordx2 v[186:187], v244, s[8:11], s45 offen offset:0
    buffer_load_dwordx2 v[188:189], v244, s[8:11], s45 offen offset:32
    buffer_load_dwordx2 v[190:191], v244, s[8:11], s45 offen offset:64
    buffer_load_dwordx2 v[192:193], v244, s[8:11], s45 offen offset:96
    buffer_load_dwordx2 v[194:195], v244, s[8:11], s45 offen offset:128
    s_waitcnt vmcnt(20)
    v_mfma_f32_16x16x32_bf16 v[0:3], v[206:209], v[112:115], v[0:3]
    v_mfma_f32_16x16x32_bf16 v[4:7], v[210:213], v[112:115], v[4:7]
    v_mfma_f32_16x16x32_bf16 v[8:11], v[214:217], v[112:115], v[8:11]
    v_mfma_f32_16x16x32_bf16 v[12:15], v[218:221], v[112:115], v[12:15]
    v_mfma_f32_16x16x32_bf16 v[16:19], v[222:225], v[112:115], v[16:19]
    s_waitcnt vmcnt(19)
    v_mfma_f32_16x16x32_bf16 v[20:23], v[206:209], v[116:119], v[20:23]
    v_mfma_f32_16x16x32_bf16 v[24:27], v[210:213], v[116:119], v[24:27]
    v_mfma_f32_16x16x32_bf16 v[28:31], v[214:217], v[116:119], v[28:31]
    v_mfma_f32_16x16x32_bf16 v[32:35], v[218:221], v[116:119], v[32:35]
    v_mfma_f32_16x16x32_bf16 v[36:39], v[222:225], v[116:119], v[36:39]
    s_waitcnt vmcnt(18)
    v_mfma_f32_16x16x32_bf16 v[40:43], v[206:209], v[120:123], v[40:43]
    v_mfma_f32_16x16x32_bf16 v[44:47], v[210:213], v[120:123], v[44:47]
    v_mfma_f32_16x16x32_bf16 v[48:51], v[214:217], v[120:123], v[48:51]
    v_mfma_f32_16x16x32_bf16 v[52:55], v[218:221], v[120:123], v[52:55]
    v_mfma_f32_16x16x32_bf16 v[56:59], v[222:225], v[120:123], v[56:59]
    s_waitcnt vmcnt(17)
    v_mfma_f32_16x16x32_bf16 v[60:63], v[206:209], v[124:127], v[60:63]
    v_mfma_f32_16x16x32_bf16 v[64:67], v[210:213], v[124:127], v[64:67]
    v_mfma_f32_16x16x32_bf16 v[68:71], v[214:217], v[124:127], v[68:71]
    v_mfma_f32_16x16x32_bf16 v[72:75], v[218:221], v[124:127], v[72:75]
    v_mfma_f32_16x16x32_bf16 v[76:79], v[222:225], v[124:127], v[76:79]
    s_waitcnt vmcnt(16)
    v_mfma_f32_16x16x32_bf16 v[0:3], v[146:149], v[128:131], v[0:3]
    v_mfma_f32_16x16x32_bf16 v[4:7], v[150:153], v[128:131], v[4:7]
    v_mov_b32 v246, 163600
    v_mfma_f32_16x16x32_bf16 v[8:11], v[154:157], v[128:131], v[8:11]
    v_mfma_f32_16x16x32_bf16 v[12:15], v[158:161], v[128:131], v[12:15]
    ds_read_b32 v247, v246
    v_mfma_f32_16x16x32_bf16 v[16:19], v[162:165], v[128:131], v[16:19]
    s_waitcnt vmcnt(15)
    v_mfma_f32_16x16x32_bf16 v[20:23], v[146:149], v[132:135], v[20:23]
    v_mfma_f32_16x16x32_bf16 v[24:27], v[150:153], v[132:135], v[24:27]
    v_mfma_f32_16x16x32_bf16 v[28:31], v[154:157], v[132:135], v[28:31]
    v_mfma_f32_16x16x32_bf16 v[32:35], v[158:161], v[132:135], v[32:35]
    v_mfma_f32_16x16x32_bf16 v[36:39], v[162:165], v[132:135], v[36:39]
    s_waitcnt vmcnt(14)
    v_mfma_f32_16x16x32_bf16 v[40:43], v[146:149], v[136:139], v[40:43]
    v_mfma_f32_16x16x32_bf16 v[44:47], v[150:153], v[136:139], v[44:47]
    v_mfma_f32_16x16x32_bf16 v[48:51], v[154:157], v[136:139], v[48:51]
    v_mfma_f32_16x16x32_bf16 v[52:55], v[158:161], v[136:139], v[52:55]
    v_mfma_f32_16x16x32_bf16 v[56:59], v[162:165], v[136:139], v[56:59]
    s_waitcnt vmcnt(13)
    v_mfma_f32_16x16x32_bf16 v[60:63], v[146:149], v[140:143], v[60:63]
    v_mfma_f32_16x16x32_bf16 v[64:67], v[150:153], v[140:143], v[64:67]
    v_mfma_f32_16x16x32_bf16 v[68:71], v[154:157], v[140:143], v[68:71]
    v_mfma_f32_16x16x32_bf16 v[72:75], v[158:161], v[140:143], v[72:75]
    v_mfma_f32_16x16x32_bf16 v[76:79], v[162:165], v[140:143], v[76:79]
    s_waitcnt lgkmcnt(0)
    v_readfirstlane_b32 s3, v247
    s_nop 3
    s_cmp_ge_u32 s3, 4
    s_cbranch_scc1 KF_FD_X
KF_FD:
    ds_read_b32 v247, v246
    s_waitcnt lgkmcnt(0)
    v_readfirstlane_b32 s3, v247
    s_add_u32 s77, s77, 1
    s_cmp_gt_u32 s77, 6400000
    s_cbranch_scc1 KF_FD_X
    s_nop 0
    s_cmp_ge_u32 s3, 4
    s_cbranch_scc1 KF_FD_X
    s_sleep 1
    s_branch KF_FD
KF_FD_X:
    s_waitcnt vmcnt(5)
    v_mfma_f32_16x16x32_bf16 v[20:23], v[166:169], v[84:87], v[20:23]
    v_mfma_f32_16x16x32_bf16 v[24:27], v[170:173], v[84:87], v[24:27]
    v_mfma_f32_16x16x32_bf16 v[28:31], v[174:177], v[84:87], v[28:31]
    v_mfma_f32_16x16x32_bf16 v[32:35], v[178:181], v[84:87], v[32:35]
    v_mfma_f32_16x16x32_bf16 v[36:39], v[182:185], v[84:87], v[36:39]
    v_mfma_f32_16x16x32_bf16 v[40:43], v[166:169], v[88:91], v[40:43]
    s_nop 2
    ds_write_b128 v249, v[20:23] offset:0
    v_mfma_f32_16x16x32_bf16 v[44:47], v[170:173], v[88:91], v[44:47]
    ds_write_b128 v249, v[24:27] offset:1024
    v_mfma_f32_16x16x32_bf16 v[48:51], v[174:177], v[88:91], v[48:51]
    ds_write_b128 v249, v[28:31] offset:2048
    v_mfma_f32_16x16x32_bf16 v[52:55], v[178:181], v[88:91], v[52:55]
    ds_write_b128 v249, v[32:35] offset:3072
    v_mfma_f32_16x16x32_bf16 v[56:59], v[182:185], v[88:91], v[56:59]
    ds_write_b128 v249, v[36:39] offset:4096
    v_mfma_f32_16x16x32_bf16 v[60:63], v[166:169], v[92:95], v[60:63]
    ds_write_b128 v249, v[40:43] offset:5120
    v_mfma_f32_16x16x32_bf16 v[64:67], v[170:173], v[92:95], v[64:67]
    ds_write_b128 v249, v[44:47] offset:6144
    v_mfma_f32_16x16x32_bf16 v[68:71], v[174:177], v[92:95], v[68:71]
    ds_write_b128 v249, v[48:51] offset:7168
    v_mfma_f32_16x16x32_bf16 v[72:75], v[178:181], v[92:95], v[72:75]
    ds_write_b128 v249, v[52:55] offset:8192
    v_mfma_f32_16x16x32_bf16 v[76:79], v[182:185], v[92:95], v[76:79]
    ds_write_b128 v249, v[56:59] offset:9216
    v_mfma_f32_16x16x32_bf16 v[0:3], v[166:169], v[80:83], v[0:3]
    ds_write_b128 v249, v[60:63] offset:10240
    v_mfma_f32_16x16x32_bf16 v[4:7], v[170:173], v[80:83], v[4:7]
    ds_write_b128 v249, v[64:67] offset:11264
    v_mfma_f32_16x16x32_bf16 v[8:11], v[174:177], v[80:83], v[8:11]
    ds_write_b128 v249, v[68:71] offset:12288
    v_mfma_f32_16x16x32_bf16 v[12:15], v[178:181], v[80:83], v[12:15]
    ds_write_b128 v249, v[72:75] offset:13312
    v_mfma_f32_16x16x32_bf16 v[16:19], v[182:185], v[80:83], v[16:19]
    ds_write_b128 v249, v[76:79] offset:14336
    v_mov_b32 v246, 163608
    s_mov_b64 exec, 1
    ds_add_u32 v246, v253
    s_mov_b64 exec, -1
    s_waitcnt vmcnt(0)
    v_lshlrev_b32 v206, 16, v186
    v_and_b32 v207, 0xffff0000, v186
    v_lshlrev_b32 v208, 16, v187
    v_and_b32 v209, 0xffff0000, v187
    v_lshlrev_b32 v210, 16, v188
    v_and_b32 v211, 0xffff0000, v188
    v_lshlrev_b32 v212, 16, v189
    v_and_b32 v213, 0xffff0000, v189
    v_lshlrev_b32 v214, 16, v190
    v_and_b32 v215, 0xffff0000, v190
    v_lshlrev_b32 v216, 16, v191
    v_and_b32 v217, 0xffff0000, v191
    v_lshlrev_b32 v218, 16, v192
    v_and_b32 v219, 0xffff0000, v192
    v_lshlrev_b32 v220, 16, v193
    v_and_b32 v221, 0xffff0000, v193
    v_lshlrev_b32 v222, 16, v194
    v_and_b32 v223, 0xffff0000, v194
    v_lshlrev_b32 v224, 16, v195
    v_and_b32 v225, 0xffff0000, v195
KF_FG:
    ds_read_b32 v247, v246
    s_waitcnt lgkmcnt(0)
    v_readfirstlane_b32 s3, v247
    s_add_u32 s77, s77, 1
    s_cmp_gt_u32 s77, 6400000
    s_cbranch_scc1 KF_FG_X
    s_nop 0
    s_cmp_ge_u32 s3, 8
    s_cbranch_scc1 KF_FG_X
    s_sleep 0
    s_branch KF_FG
KF_FG_X:
    ds_read_b128 v[146:149], v245 offset:0
    ds_read_b128 v[150:153], v245 offset:1024
    ds_read_b128 v[154:157], v245 offset:2048
    ds_read_b128 v[158:161], v245 offset:3072
    ds_read_b128 v[162:165], v245 offset:4096
    ds_read_b128 v[80:83], v240 offset:0
    ds_read_b128 v[84:87], v241 offset:0
    ds_read_b128 v[88:91], v242 offset:0
    ds_read_b128 v[92:95], v240 offset:1024
    ds_read_b128 v[96:99], v241 offset:1024
    ds_read_b128 v[100:103], v242 offset:1024
    ds_read_b128 v[104:107], v240 offset:2048
    ds_read_b128 v[108:111], v241 offset:2048
    ds_read_b128 v[112:115], v242 offset:2048
    ds_read_b128 v[116:119], v240 offset:3072
    ds_read_b128 v[120:123], v241 offset:3072
    ds_read_b128 v[124:127], v242 offset:3072
    ds_read_b128 v[128:131], v240 offset:4096
    ds_read_b128 v[132:135], v241 offset:4096
    ds_read_b128 v[136:139], v242 offset:4096
    s_waitcnt lgkmcnt(12)
    v_pk_add_f32 v[0:1], v[0:1], v[80:81]
    v_pk_add_f32 v[84:85], v[84:85], v[88:89]
    v_pk_add_f32 v[2:3], v[2:3], v[82:83]
    v_pk_add_f32 v[86:87], v[86:87], v[90:91]
    v_pk_add_f32 v[0:1], v[0:1], v[84:85]
    v_pk_add_f32 v[2:3], v[2:3], v[86:87]
    v_pk_fma_f32 v[0:1], v[0:1], v[146:147], v[206:207]
    v_pk_fma_f32 v[2:3], v[2:3], v[148:149], v[208:209]
    v_cvt_pk_bf16_f32 v20, v0, v1
    v_cvt_pk_bf16_f32 v21, v2, v3
    buffer_store_dwordx2 v[20:21], v244, s[32:35], s45 offen offset:0
    s_waitcnt lgkmcnt(9)
    v_pk_add_f32 v[4:5], v[4:5], v[92:93]
    v_pk_add_f32 v[96:97], v[96:97], v[100:101]
    v_pk_add_f32 v[6:7], v[6:7], v[94:95]
    v_pk_add_f32 v[98:99], v[98:99], v[102:103]
    v_pk_add_f32 v[4:5], v[4:5], v[96:97]
    v_pk_add_f32 v[6:7], v[6:7], v[98:99]
    v_pk_fma_f32 v[4:5], v[4:5], v[150:151], v[210:211]
    v_pk_fma_f32 v[6:7], v[6:7], v[152:153], v[212:213]
    v_cvt_pk_bf16_f32 v22, v4, v5
    v_cvt_pk_bf16_f32 v23, v6, v7
    buffer_store_dwordx2 v[22:23], v244, s[32:35], s45 offen offset:32
    s_waitcnt lgkmcnt(6)
    v_pk_add_f32 v[8:9], v[8:9], v[104:105]
    v_pk_add_f32 v[108:109], v[108:109], v[112:113]
    v_pk_add_f32 v[10:11], v[10:11], v[106:107]
    v_pk_add_f32 v[110:111], v[110:111], v[114:115]
    v_pk_add_f32 v[8:9], v[8:9], v[108:109]
    v_pk_add_f32 v[10:11], v[10:11], v[110:111]
    v_pk_fma_f32 v[8:9], v[8:9], v[154:155], v[214:215]
    v_pk_fma_f32 v[10:11], v[10:11], v[156:157], v[216:217]
    v_cvt_pk_bf16_f32 v24, v8, v9
    v_cvt_pk_bf16_f32 v25, v10, v11
    buffer_store_dwordx2 v[24:25], v244, s[32:35], s45 offen offset:64
    s_waitcnt lgkmcnt(3)
    v_pk_add_f32 v[12:13], v[12:13], v[116:117]
    v_pk_add_f32 v[120:121], v[120:121], v[124:125]
    v_pk_add_f32 v[14:15], v[14:15], v[118:119]
    v_pk_add_f32 v[122:123], v[122:123], v[126:127]
    v_pk_add_f32 v[12:13], v[12:13], v[120:121]
    v_pk_add_f32 v[14:15], v[14:15], v[122:123]
    v_pk_fma_f32 v[12:13], v[12:13], v[158:159], v[218:219]
    v_pk_fma_f32 v[14:15], v[14:15], v[160:161], v[220:221]
    v_cvt_pk_bf16_f32 v26, v12, v13
    v_cvt_pk_bf16_f32 v27, v14, v15
    buffer_store_dwordx2 v[26:27], v244, s[32:35], s45 offen offset:96
    s_waitcnt lgkmcnt(0)
    v_pk_add_f32 v[16:17], v[16:17], v[128:129]
    v_pk_add_f32 v[132:133], v[132:133], v[136:137]
    v_pk_add_f32 v[18:19], v[18:19], v[130:131]
    v_pk_add_f32 v[134:135], v[134:135], v[138:139]
    v_pk_add_f32 v[16:17], v[16:17], v[132:133]
    v_pk_add_f32 v[18:19], v[18:19], v[134:135]
    v_pk_fma_f32 v[16:17], v[16:17], v[162:163], v[222:223]
    v_pk_fma_f32 v[18:19], v[18:19], v[164:165], v[224:225]
    v_cvt_pk_bf16_f32 v28, v16, v17
    v_cvt_pk_bf16_f32 v29, v18, v19
    buffer_store_dwordx2 v[28:29], v244, s[32:35], s45 offen offset:128
KF_FIN:
KF_END:
    s_endpgm
.p2align 5
.type KF_TAB,@object
KF_TAB:
.long 1, 0, 327680, 589826, 0, 0, 0, 261894
.long 1, 8, 327680, 589826, 0, 4, 4, 261894
.long 1, 0, 409601, 655360, 8, 256, 8, 261894
.long 1, 8, 409601, 655360, 8, 260, 12, 261894
.long 1, 0, 491522, 720898, 16, 768, 16, 261894
.long 1, 8, 491522, 720898, 16, 772, 20, 261894
.long 1, 0, 573443, 786432, 24, 1024, 24, 261894
.long 1, 8, 573443, 786432, 24, 1028, 28, 261894
.long 1, 1, 327680, 589827, 0, 1, 1, 261894
.long 1, 9, 327680, 589827, 0, 5, 5, 261894
.long 1, 1, 409601, 655361, 8, 257, 9, 261894
.long 1, 9, 409601, 655361, 8, 261, 13, 261894
.long 1, 1, 491522, 720899, 16, 769, 17, 261894
.long 1, 9, 491522, 720899, 16, 773, 21, 261894
.long 1, 1, 573443, 786433, 24, 1025, 25, 261894
.long 1, 9, 573443, 786433, 24, 1029, 29, 261894
.long 1, 2, 327680, 589824, 0, 2, 2, 261894
.long 1, 10, 327680, 589824, 0, 6, 6, 261894
.long 1, 2, 409601, 655362, 8, 258, 10, 261894
.long 1, 10, 409601, 655362, 8, 262, 14, 261894
.long 1, 2, 491522, 720896, 16, 770, 18, 261894
.long 1, 10, 491522, 720896, 16, 774, 22, 261894
.long 1, 2, 573443, 786434, 24, 1026, 26, 261894
.long 1, 10, 573443, 786434, 24, 1030, 30, 261894
.long 1, 3, 327680, 589825, 0, 3, 3, 261894
.long 1, 11, 327680, 589825, 0, 7, 7, 261894
.long 1, 3, 409601, 655363, 8, 259, 11, 261894
.long 1, 11, 409601, 655363, 8, 263, 15, 261894
.long 1, 3, 491522, 720897, 16, 771, 19, 261894
.long 1, 11, 491522, 720897, 16, 775, 23, 261894
.long 1, 3, 573443, 786435, 24, 1027, 27, 261894
.long 1, 11, 573443, 786435, 24, 1031, 31, 261894
.long 1, 4, 327680, 589826, 1, 0, 0, 261895
.long 1, 12, 327680, 589826, 1, 4, 4, 261895
.long 1, 4, 409601, 655360, 9, 256, 8, 261895
.long 1, 12, 409601, 655360, 9, 260, 12, 261895
.long 1, 4, 491522, 720898, 17, 768, 16, 261895
.long 1, 12, 491522, 720898, 17, 772, 20, 261895
.long 1, 4, 573443, 786432, 25, 1024, 24, 261895
.long 1, 12, 573443, 786432, 25, 1028, 28, 261895
.long 1, 5, 327680, 589827, 1, 1, 1, 261895
.long 1, 13, 327680, 589827, 1, 5, 5, 261895
.long 1, 5, 409601, 655361, 9, 257, 9, 261895
.long 1, 13, 409601, 655361, 9, 261, 13, 261895
.long 1, 5, 491522, 720899, 17, 769, 17, 261895
.long 1, 13, 491522, 720899, 17, 773, 21, 261895
.long 1, 5, 573443, 786433, 25, 1025, 25, 261895
.long 1, 13, 573443, 786433, 25, 1029, 29, 261895
.long 1, 6, 327680, 589824, 1, 2, 2, 261895
.long 1, 14, 327680, 589824, 1, 6, 6, 261895
.long 1, 6, 409601, 655362, 9, 258, 10, 261895
.long 1, 14, 409601, 655362, 9, 262, 14, 261895
.long 1, 6, 491522, 720896, 17, 770, 18, 261895
.long 1, 14, 491522, 720896, 17, 774, 22, 261895
.long 1, 6, 573443, 786434, 25, 1026, 26, 261895
.long 1, 14, 573443, 786434, 25, 1030, 30, 261895
.long 1, 7, 327680, 589825, 1, 3, 3, 261895
.long 1, 15, 327680, 589825, 1, 7, 7, 261895
.long 1, 7, 409601, 655363, 9, 259, 11, 261895
.long 1, 15, 409601, 655363, 9, 263, 15, 261895
.long 1, 7, 491522, 720897, 17, 771, 19, 261895
.long 1, 15, 491522, 720897, 17, 775, 23, 261895
.long 1, 7, 573443, 786435, 25, 1027, 27, 261895
.long 1, 15, 573443, 786435, 25, 1031, 31, 261895
.long 2, 0, 0, 851970, 2, 34471936, 0, 5
.long 2, 8, 0, 851970, 2, 34471940, 4, 1797
.long 2, 4, 0, 851970, 10, 34472448, 8, 3589
.long 2, 12, 0, 851970, 10, 34472452, 12, 5381
.long 2, 0, 163841, 917504, 18, 34472704, 16, 7173
.long 2, 8, 163841, 917504, 18, 34472708, 20, 8965
.long 2, 4, 163841, 917504, 26, 34472960, 24, 10757
.long 2, 12, 163841, 917504, 26, 34472964, 28, 12549
.long 2, 1, 0, 851971, 2, 34471937, 1, 14341
.long 2, 9, 0, 851971, 2, 34471941, 5, 16133
.long 2, 5, 0, 851971, 10, 34472449, 9, 17925
.long 2, 13, 0, 851971, 10, 34472453, 13, 19717
.long 2, 1, 163841, 917505, 18, 34472705, 17, 21509
.long 2, 9, 163841, 917505, 18, 34472709, 21, 23301
.long 2, 5, 163841, 917505, 26, 34472961, 25, 25093
.long 2, 13, 163841, 917505, 26, 34472965, 29, 26885
.long 2, 2, 0, 851968, 2, 34471938, 2, 28677
.long 2, 10, 0, 851968, 2, 34471942, 6, 30469
.long 2, 6, 0, 851968, 10, 34472450, 10, 32261
.long 2, 14, 0, 851968, 10, 34472454, 14, 34053
.long 2, 2, 163841, 917506, 18, 34472706, 18, 35845
.long 2, 10, 163841, 917506, 18, 34472710, 22, 37637
.long 2, 6, 163841, 917506, 26, 34472962, 26, 39429
.long 2, 14, 163841, 917506, 26, 34472966, 30, 41221
.long 2, 3, 0, 851969, 2, 34471939, 3, 43013
.long 2, 11, 0, 851969, 2, 34471943, 7, 44805
.long 2, 7, 0, 851969, 10, 34472451, 11, 46597
.long 2, 15, 0, 851969, 10, 34472455, 15, 48389
.long 2, 3, 163841, 917507, 18, 34472707, 19, 50181
.long 2, 11, 163841, 917507, 18, 34472711, 23, 51973
.long 2, 7, 163841, 917507, 26, 34472963, 27, 53765
.long 2, 15, 163841, 917507, 26, 34472967, 31, 55557
.long 3, 0, 0, 983042, 3, 33554432, 0, 261888
.long 3, 8, 4, 983042, 3, 33554436, 4, 261888
.long 3, 2, 2, 983040, 11, 33554944, 8, 261888
.long 3, 10, 10, 983040, 11, 33554948, 12, 261888
.long 3, 4, 5, 983042, 19, 33555200, 16, 261888
.long 3, 12, 12, 983042, 19, 33555204, 20, 261888
.long 3, 6, 7, 983040, 27, 33555456, 24, 261888
.long 3, 14, 14, 983040, 27, 33555460, 28, 261888
.long 3, 1, 1, 983043, 3, 33554433, 1, 261888
.long 3, 9, 9, 983043, 3, 33554437, 5, 261888
.long 3, 3, 3, 983041, 11, 33554945, 9, 261888
.long 3, 11, 11, 983041, 11, 33554949, 13, 261888
.long 3, 5, 6, 983043, 19, 33555201, 17, 261888
.long 3, 13, 13, 983043, 19, 33555205, 21, 261888
.long 3, 7, 8, 983041, 27, 33555457, 25, 261888
.long 3, 15, 15, 983041, 27, 33555461, 29, 261888
.long 0, 0, 0, 67110912, 3, 33554434, 2, 0
.long 0, 8, 0, 1024, 3, 33554438, 6, 1024
.long 0, 2, 196610, 100796418, 11, 33554946, 10, 2048
.long 0, 10, 196610, 33686530, 11, 33554950, 14, 3072
.long 0, 4, 393220, 67373056, 19, 33555202, 18, 4096
.long 0, 12, 393220, 263168, 19, 33555206, 22, 5120
.long 0, 6, 589830, 101058562, 27, 33555458, 26, 6144
.long 0, 14, 589830, 33948674, 27, 33555462, 30, 7168
.long 0, 1, 0, 83888129, 3, 33554435, 3, 8192
.long 0, 9, 0, 16778241, 3, 33554439, 7, 9216
.long 0, 3, 196610, 117573635, 11, 33554947, 11, 10240
.long 0, 11, 196610, 50463747, 11, 33554951, 15, 11264
.long 0, 5, 393220, 84150273, 19, 33555203, 19, 12288
.long 0, 13, 393220, 17040385, 19, 33555207, 23, 13312
.long 0, 7, 589830, 117835779, 27, 33555459, 27, 14336
.long 0, 15, 589830, 50725891, 27, 33555463, 31, 15360
.long 0, 2, 0, 100665346, 4, 50462976, 0, 16385
.long 0, 10, 0, 33555458, 4, 50462980, 4, 17409
.long 0, 4, 196610, 67241984, 12, 50463232, 8, 18433
.long 0, 12, 196610, 132096, 12, 50463236, 12, 19457
.long 0, 6, 393220, 100927490, 20, 50463488, 16, 20481
.long 0, 14, 393220, 33817602, 20, 50463492, 20, 21505
.long 0, 0, 688135, 101124098, 28, 50464000, 24, 22529
.long 0, 8, 688135, 34014210, 28, 50464004, 28, 23553
.long 0, 3, 0, 117442563, 4, 50462977, 1, 24577
.long 0, 11, 0, 50332675, 4, 50462981, 5, 25601
.long 0, 5, 196610, 84019201, 12, 50463233, 9, 26625
.long 0, 13, 196610, 16909313, 12, 50463237, 13, 27649
.long 0, 7, 393220, 117704707, 20, 50463489, 17, 28673
.long 0, 15, 393220, 50594819, 20, 50463493, 21, 29697
.long 0, 1, 688135, 117901315, 28, 50464001, 25, 30721
.long 0, 9, 688135, 50791427, 28, 50464005, 29, 31745
.long 0, 4, 0, 0, 4, 50462978, 2, 32769
.long 0, 12, 0, 0, 4, 50462982, 6, 33793
.long 0, 6, 196610, 131074, 12, 50463234, 10, 34817
.long 0, 14, 196610, 131074, 12, 50463238, 14, 35841
.long 0, 0, 491525, 100993026, 20, 50463490, 18, 36865
.long 0, 8, 491525, 33883138, 20, 50463494, 22, 37889
.long 0, 2, 688135, 67569664, 28, 50464002, 26, 38913
.long 0, 10, 688135, 459776, 28, 50464006, 30, 39937
.long 0, 5, 0, 1, 4, 50462979, 3, 40961
.long 0, 13, 0, 1, 4, 50462983, 7, 41985
.long 0, 7, 196610, 131075, 12, 50463235, 11, 43009
.long 0, 15, 196610, 131075, 12, 50463239, 15, 44033
.long 0, 1, 491525, 117770243, 20, 50463491, 19, 45057
.long 0, 9, 491525, 50660355, 20, 50463495, 23, 46081
.long 0, 3, 688135, 84346881, 28, 50464003, 27, 47105
.long 0, 11, 688135, 17236993, 28, 50464007, 31, 48129
.long 0, 6, 0, 2, 5, 50659584, 0, 49154
.long 0, 14, 0, 2, 5, 50659588, 4, 50178
.long 0, 0, 294915, 100861954, 13, 50659840, 8, 51202
.long 0, 8, 294915, 33752066, 13, 50659844, 12, 52226
.long 0, 2, 491525, 67438592, 21, 50660096, 16, 53250
.long 0, 10, 491525, 328704, 21, 50660100, 20, 54274
.long 0, 4, 688135, 458754, 29, 50660608, 24, 55298
.long 0, 12, 688135, 458754, 29, 50660612, 28, 56322
.long 0, 7, 0, 3, 5, 50659585, 1, 57346
.long 0, 15, 0, 3, 5, 50659589, 5, 58370
.long 0, 1, 294915, 117639171, 13, 50659841, 9, 59394
.long 0, 9, 294915, 50529283, 13, 50659845, 13, 60418
.long 0, 3, 491525, 84215809, 21, 50660097, 17, 61442
.long 0, 11, 491525, 17105921, 21, 50660101, 21, 62466
.long 0, 5, 688135, 458755, 29, 50660609, 25, 63490
.long 0, 13, 688135, 458755, 29, 50660613, 29, 64514
.long 0, 0, 98305, 100730882, 5, 50659586, 2, 65538
.long 0, 8, 98305, 33620994, 5, 50659590, 6, 66562
.long 0, 2, 294915, 67307520, 13, 50659842, 10, 67586
.long 0, 10, 294915, 197632, 13, 50659846, 14, 68610
.long 0, 4, 491525, 327682, 21, 50660098, 18, 69634
.long 0, 12, 491525, 327682, 21, 50660102, 22, 70658
.long 0, 6, 688135, 458752, 29, 50660610, 26, 71682
.long 0, 14, 688135, 458752, 29, 50660614, 30, 72706
.long 0, 1, 98305, 117508099, 5, 50659587, 3, 73730
.long 0, 9, 98305, 50398211, 5, 50659591, 7, 74754
.long 0, 3, 294915, 84084737, 13, 50659843, 11, 75778
.long 0, 11, 294915, 16974849, 13, 50659847, 15, 76802
.long 0, 5, 491525, 327683, 21, 50660099, 19, 77826
.long 0, 13, 491525, 327683, 21, 50660103, 23, 78850
.long 0, 7, 688135, 458753, 29, 50660611, 27, 79874
.long 0, 15, 688135, 458753, 29, 50660615, 31, 80898
.long 0, 2, 98305, 67176448, 6, 50856192, 0, 81923
.long 0, 10, 98305, 66560, 6, 50856196, 4, 82947
.long 0, 4, 294915, 196610, 14, 50856448, 8, 83971
.long 0, 12, 294915, 196610, 14, 50856452, 12, 84995
.long 0, 6, 491525, 327680, 22, 50856960, 16, 86019
.long 0, 14, 491525, 327680, 22, 50856964, 20, 87043
.long 0, 0, 786440, 67635200, 30, 50857216, 24, 88067
.long 0, 8, 786440, 525312, 30, 50857220, 28, 89091
.long 0, 3, 98305, 83953665, 6, 50856193, 1, 90115
.long 0, 11, 98305, 16843777, 6, 50856197, 5, 91139
.long 0, 5, 294915, 196611, 14, 50856449, 9, 92163
.long 0, 13, 294915, 196611, 14, 50856453, 13, 93187
.long 0, 7, 491525, 327681, 22, 50856961, 17, 94211
.long 0, 15, 491525, 327681, 22, 50856965, 21, 95235
.long 0, 1, 786440, 84412417, 30, 50857217, 25, 96259
.long 0, 9, 786440, 17302529, 30, 50857221, 29, 97283
.long 0, 4, 98305, 65538, 6, 50856194, 2, 98307
.long 0, 12, 98305, 65538, 6, 50856198, 6, 99331
.long 0, 6, 294915, 196608, 14, 50856450, 10, 100355
.long 0, 14, 294915, 196608, 14, 50856454, 14, 101379
.long 0, 0, 589830, 67504128, 22, 50856962, 18, 102403
.long 0, 8, 589830, 394240, 22, 50856966, 22, 103427
.long 0, 2, 786440, 101189634, 30, 50857218, 26, 104451
.long 0, 10, 786440, 34079746, 30, 50857222, 30, 105475
.long 0, 5, 98305, 65539, 6, 50856195, 3, 106499
.long 0, 13, 98305, 65539, 6, 50856199, 7, 107523
.long 0, 7, 294915, 196609, 14, 50856451, 11, 108547
.long 0, 15, 294915, 196609, 14, 50856455, 15, 109571
.long 0, 1, 589830, 84281345, 22, 50856963, 19, 110595
.long 0, 9, 589830, 17171457, 22, 50856967, 23, 111619
.long 0, 3, 786440, 117966851, 30, 50857219, 27, 112643
.long 0, 11, 786440, 50856963, 30, 50857223, 31, 113667
.long 0, 6, 98305, 65536, 7, 51052800, 0, 114692
.long 0, 14, 98305, 65536, 7, 51052804, 4, 115716
.long 0, 0, 393220, 262144, 15, 51053056, 8, 116740
.long 0, 8, 393220, 262144, 15, 51053060, 12, 117764
.long 0, 2, 589830, 393218, 23, 51053568, 16, 118788
.long 0, 10, 589830, 393218, 23, 51053572, 20, 119812
.long 0, 4, 786440, 524288, 31, 51053824, 24, 120836
.long 0, 12, 786440, 524288, 31, 51053828, 28, 121860
.long 0, 7, 98305, 65537, 7, 51052801, 1, 122884
.long 0, 15, 98305, 65537, 7, 51052805, 5, 123908
.long 0, 1, 393220, 262145, 15, 51053057, 9, 124932
.long 0, 9, 393220, 262145, 15, 51053061, 13, 125956
.long 0, 3, 589830, 393219, 23, 51053569, 17, 126980
.long 0, 11, 589830, 393219, 23, 51053573, 21, 128004
.long 0, 5, 786440, 524289, 31, 51053825, 25, 129028
.long 0, 13, 786440, 524289, 31, 51053829, 29, 130052
.long 0, 0, 196610, 131072, 7, 51052802, 2, 131076
.long 0, 8, 196610, 131072, 7, 51052806, 6, 132100
.long 0, 2, 393220, 262146, 15, 51053058, 10, 133124
.long 0, 10, 393220, 262146, 15, 51053062, 14, 134148
.long 0, 4, 589830, 393216, 23, 51053570, 18, 135172
.long 0, 12, 589830, 393216, 23, 51053574, 22, 136196
.long 0, 6, 786440, 524290, 31, 51053826, 26, 137220
.long 0, 14, 786440, 524290, 31, 51053830, 30, 138244
.long 0, 1, 196610, 131073, 7, 51052803, 3, 139268
.long 0, 9, 196610, 131073, 7, 51052807, 7, 140292
.long 0, 3, 393220, 262147, 15, 51053059, 11, 141316
.long 0, 11, 393220, 262147, 15, 51053063, 15, 142340
.long 0, 5, 589830, 393217, 23, 51053571, 19, 143364
.long 0, 13, 589830, 393217, 23, 51053575, 23, 144388
.long 0, 7, 786440, 524291, 31, 51053827, 27, 145412
.long 0, 15, 786440, 524291, 31, 51053831, 31, 146436
.section .rodata,"a"
.p2align 6
.amdhsa_kernel recurrent_scan__linear_kernel_hedgehog__glu_gated_geglu__prompt_kernel
  .amdhsa_next_free_vgpr 256
  .amdhsa_next_free_sgpr 102
  .amdhsa_accum_offset 256
  .amdhsa_group_segment_fixed_size 0
  .amdhsa_kernarg_size 88
  .amdhsa_user_sgpr_count 2
  .amdhsa_user_sgpr_kernarg_segment_ptr 1
  .amdhsa_system_sgpr_workgroup_id_x 1
.end_amdhsa_kernel
```
